```python
import torch

def _softmax(x, axis=-1):
    return torch.softmax(x, dim=axis)
def _gelu(x):
    return torch.nn.functional.gelu(x, approximate="tanh")
def _silu(x):
    return torch.nn.functional.silu(x)
def _sigmoid(x):
    return torch.sigmoid(x)
def _layernorm(x, axis=-1, eps=1e-5):
    m = x.mean(dim=axis, keepdim=True)
    v = x.var(dim=axis, keepdim=True, unbiased=False)
    return (x - m) / torch.sqrt(v + eps)
def _scatter_add(tgt, idx, src, axis=0):
    return tgt.clone().index_add_(axis, idx, src)
def _segment_sum(src, seg, n):
    out = torch.zeros((n,) + src.shape[1:], dtype=src.dtype)
    return out.index_add_(0, seg, src)
def _pad(x, pw):
    flat = tuple(v for pair in reversed(pw) for v in pair)
    return torch.nn.functional.pad(x, flat)

kernel_name = 'sequential_preLN__softmax_full_mha__geglu_ffn__prompt'

def setup_inputs():

    _w = (lambda a: (lambda t: t.to(torch.bfloat16) if t.is_floating_point() else t)(torch.as_tensor(a)))
    def _A_setup():
        B, S, D = 1, 2048, 640
        return {
            "x": _w((lambda *s: torch.randn(*s, dtype=torch.bfloat16) * 0.05)(B, S, D)),
            "wqkv": _w((lambda *s: torch.randn(*s, dtype=torch.bfloat16) * 0.05)(D, 3 * D)),
            "wo": _w((lambda *s: torch.randn(*s, dtype=torch.bfloat16) * 0.05)(D, D)),
        }
    _A_in = _A_setup()

    def _B_setup():
        B, S, D, F = 1, 2048, 640, 1728
        return {
            "x": _w((lambda *s: torch.randn(*s, dtype=torch.bfloat16) * 0.05)(B, S, D)),
            "w_gate": _w((lambda *s: torch.randn(*s, dtype=torch.bfloat16) * 0.05)(D, F)),
            "w_up": _w((lambda *s: torch.randn(*s, dtype=torch.bfloat16) * 0.05)(D, F)),
            "w_down": _w((lambda *s: torch.randn(*s, dtype=torch.bfloat16) * 0.05)(F, D)),
        }
    _B_in = _B_setup()

    return {
        "A_x": _A_in["x"],
        "A_wqkv": _A_in["wqkv"],
        "A_wo": _A_in["wo"],
        "B_x": _B_in["x"],
        "B_w_gate": _B_in["w_gate"],
        "B_w_up": _B_in["w_up"],
        "B_w_down": _B_in["w_down"],
    }

def reference(A_x, A_wqkv, A_wo, B_x, B_w_gate, B_w_up, B_w_down):
    def _A_ref(x, wqkv, wo):
        B, S, D = x.shape
        H = 32; Dh = D // H
        qkv = (lambda x, *d: x.permute(*d))((x @ wqkv).reshape(B, S, 3, H, Dh), 2, 0, 3, 1, 4)
        q, k, v = qkv[0], qkv[1], qkv[2]
        scale = Dh ** -0.5
        scores = torch.einsum("bhqd,bhkd->bhqk", q, k) * scale
        p = _softmax(scores, axis=-1)
        o = torch.einsum("bhqk,bhkd->bhqd", p, v)
        return (lambda x, *d: x.permute(*d))(o, 0, 2, 1, 3).reshape(B, S, D) @ wo

    def _B_ref(x, w_gate, w_up, w_down):
        return (_gelu(x @ w_gate) * (x @ w_up)) @ w_down

    x = A_x
    h = x + _A_ref(_layernorm(x, axis=-1), A_wqkv, A_wo)
    h2 = h + _B_ref(_layernorm(h, axis=-1), B_w_gate, B_w_up, B_w_down)
    return h2
```

```asm
; @launch grid=(256,1,1) block=(512,1,1) lds=158784
.amdgcn_target "amdgcn-amd-amdhsa--gfx950"
.text
.globl sequential_preLN__softmax_full_mha__geglu_ffn__prompt_kernel
.p2align 8
.type sequential_preLN__softmax_full_mha__geglu_ffn__prompt_kernel,@function
sequential_preLN__softmax_full_mha__geglu_ffn__prompt_kernel:
    s_cmp_ge_u32 s2, 256
    s_cbranch_scc1 Lqkv_end
    s_load_dwordx4 s[20:23], s[0:1], 0
    s_load_dwordx4 s[24:27], s[0:1], 64
    s_load_dwordx2 s[68:69], s[0:1], 56
    s_and_b32 s30, s2, 7
    s_lshr_b32 s31, s2, 3
    s_and_b32 s17, s30, 3
    s_lshl_b32 s17, s17, 2
    s_and_b32 s32, s31, 3
    s_add_u32 s17, s17, s32
    s_lshr_b32 s18, s30, 2
    s_mul_i32 s18, s18, 7
    s_lshr_b32 s32, s31, 2
    s_add_u32 s18, s18, s32
    v_lshrrev_b32 v1, 6, v0
    v_and_b32 v2, 63, v0
    v_readfirstlane_b32 s16, v1
    s_cmp_ge_u32 s30, 4
    s_cselect_b32 s19, 1, 0
    s_cmp_eq_u32 s32, 0
    s_cselect_b32 s19, s19, 0
    s_waitcnt lgkmcnt(0)
    s_mov_b32 s4, s20
    s_and_b32 s5, s21, 0xffff
    s_mov_b32 s6, 2621440
    s_mov_b32 s7, 0x20000
    s_mov_b32 s8, s22
    s_and_b32 s9, s23, 0xffff
    s_mov_b32 s10, 2457600
    s_mov_b32 s11, 0x20000
    s_mov_b32 s12, s26
    s_and_b32 s13, s27, 0xffff
    s_mov_b32 s14, 33554432
    s_mov_b32 s15, 0x20000
    s_add_u32 s66, s18, 72
    v_lshlrev_b32 v3, 4, v2
    s_cmp_eq_u32 s19, 1
    s_cbranch_scc1 Lqkv_aux
    s_cmp_lt_u32 s16, 4
    s_cbranch_scc1 Lqkv_cons
    s_sub_u32 s16, s16, 4
    v_lshrrev_b32 v3, 4, v2
    v_mul_u32_u24 v4, 15360, v3
    v_and_b32 v26, 15, v2
    v_lshl_add_u32 v4, v26, 4, v4
    v_add_u32 v5, 2752, v4
    v_add_u32 v6, 5504, v4
    v_add_u32 v7, 8256, v4
    s_lshr_b32 s56, s31, 2
    s_xor_b32 s56, s56, s31
    s_and_b32 s56, s56, 1
    s_lshr_b32 s60, s31, 2
    s_and_b32 s57, s31, 3
    s_mul_i32 s57, s57, 3
    s_add_u32 s60, s60, s57
    s_sub_u32 s57, s60, 10
    s_cmp_ge_u32 s60, 10
    s_cselect_b32 s60, s57, s60
    s_nop 0
    s_mul_i32 s61, s56, 4294475776
    s_add_u32 s61, s61, 245760
    s_mul_i32 s62, s56, 491520
    s_add_u32 s62, s62, 245760
    s_mul_i32 s63, s56, 4294967040
    s_add_u32 s63, s63, 128
    s_lshl_b32 s64, s56, 8
    s_add_u32 s64, s64, 128
    s_mul_i32 s33, s16, 61440
    s_lshl_b32 s32, s18, 8
    s_add_u32 s33, s33, s32
    s_add_u32 s58, s33, 2457600
    s_mul_i32 s32, s56, 245760
    s_add_u32 s33, s33, s32
    s_mul_i32 s35, s16, 4352
    s_add_u32 m0, s35, 0
    s_nop 0
    buffer_load_dwordx4 v4, s[8:11], s33 offen offset:0 lds
    buffer_load_dwordx4 v5, s[8:11], s33 offen offset:1088 lds
    buffer_load_dwordx4 v6, s[8:11], s33 offen offset:2176 lds
    buffer_load_dwordx4 v7, s[8:11], s33 offen offset:3264 lds
    s_add_u32 s33, s33, s61
    v_lshrrev_b32 v26, 3, v2
    v_mul_u32_u24 v26, 1280, v26
    v_and_b32 v27, 7, v2
    v_xor_b32 v28, v27, v3
    v_lshl_add_u32 v8, v28, 4, v26
    v_xor_b32 v28, 4, v28
    v_lshl_add_u32 v9, v28, 4, v26
    v_add_u32 v10, 18432, v8
    v_add_u32 v11, 27648, v9
    v_add_u32 v9, 9216, v9
    s_lshl_b32 s34, s17, 2
    s_add_u32 s34, s34, s16
    s_mul_i32 s34, s34, 40960
    s_add_u32 s59, s34, 1280
    s_lshl_b32 s32, s56, 7
    s_add_u32 s34, s34, s32
    s_lshl_b32 s36, s16, 12
    s_add_u32 s36, s36, 17408
    s_add_u32 m0, s36, 0
    s_nop 0
    buffer_load_dwordx4 v8, s[4:7], s34 offen offset:0 lds
    buffer_load_dwordx4 v9, s[4:7], s34 offen offset:1024 lds
    buffer_load_dwordx4 v10, s[4:7], s34 offen offset:2048 lds
    buffer_load_dwordx4 v11, s[4:7], s34 offen offset:3072 lds
    s_add_u32 s34, s34, s63
    s_add_u32 m0, s35, 33792
    s_nop 0
    buffer_load_dwordx4 v4, s[8:11], s33 offen offset:0 lds
    buffer_load_dwordx4 v5, s[8:11], s33 offen offset:1088 lds
    buffer_load_dwordx4 v6, s[8:11], s33 offen offset:2176 lds
    buffer_load_dwordx4 v7, s[8:11], s33 offen offset:3264 lds
    s_add_u32 s33, s33, s62
    s_add_u32 m0, s36, 33792
    s_nop 0
    buffer_load_dwordx4 v8, s[4:7], s34 offen offset:0 lds
    buffer_load_dwordx4 v9, s[4:7], s34 offen offset:1024 lds
    buffer_load_dwordx4 v10, s[4:7], s34 offen offset:2048 lds
    buffer_load_dwordx4 v11, s[4:7], s34 offen offset:3072 lds
    s_add_u32 s34, s34, s64
    v_lshrrev_b32 v26, 5, v2
    v_and_b32 v27, 31, v2
    v_bfe_u32 v28, v2, 1, 3
    v_xor_b32 v28, v28, v26
    v_lshlrev_b32 v28, 4, v28
    v_lshl_add_u32 v28, v27, 7, v28
    s_mov_b32 s44, 0xffff0000
    v_mov_b32 v30, 0x3f803f80
    v_xor_b32 v29, 0, v28
    v_add_u32 v14, s36, v29
    v_add_u32 v44, 67584, v14
    v_mov_b32 v20, 0
    v_xor_b32 v29, 32, v28
    v_add_u32 v15, s36, v29
    v_add_u32 v45, 67584, v15
    v_mov_b32 v21, 0
    v_xor_b32 v29, 64, v28
    v_add_u32 v16, s36, v29
    v_add_u32 v46, 67584, v16
    v_mov_b32 v22, 0
    v_xor_b32 v29, 96, v28
    v_add_u32 v17, s36, v29
    v_add_u32 v47, 67584, v17
    v_mov_b32 v23, 0
    s_waitcnt vmcnt(8)
    s_barrier
    ds_read_b128 v[48:51], v14 offset:0
    ds_read_b128 v[52:55], v15 offset:0
    ds_read_b128 v[56:59], v16 offset:0
    ds_read_b128 v[60:63], v17 offset:0
    s_add_u32 m0, s35, 67584
    s_nop 0
    buffer_load_dwordx4 v4, s[8:11], s33 offen offset:0 lds
    buffer_load_dwordx4 v5, s[8:11], s33 offen offset:1088 lds
    buffer_load_dwordx4 v6, s[8:11], s33 offen offset:2176 lds
    buffer_load_dwordx4 v7, s[8:11], s33 offen offset:3264 lds
    s_add_u32 s33, s33, s61
    s_add_u32 m0, s36, 67584
    s_nop 0
    buffer_load_dwordx4 v8, s[4:7], s34 offen offset:0 lds
    buffer_load_dwordx4 v9, s[4:7], s34 offen offset:1024 lds
    buffer_load_dwordx4 v10, s[4:7], s34 offen offset:2048 lds
    buffer_load_dwordx4 v11, s[4:7], s34 offen offset:3072 lds
    s_add_u32 s34, s34, s63
    s_waitcnt lgkmcnt(0)
    v_dot2c_f32_bf16 v20, v48, v30
    v_dot2c_f32_bf16 v22, v48, v48
    v_dot2c_f32_bf16 v21, v49, v30
    v_dot2c_f32_bf16 v23, v49, v49
    v_dot2c_f32_bf16 v20, v50, v30
    v_dot2c_f32_bf16 v22, v50, v50
    v_dot2c_f32_bf16 v21, v51, v30
    v_dot2c_f32_bf16 v23, v51, v51
    v_dot2c_f32_bf16 v20, v52, v30
    v_dot2c_f32_bf16 v22, v52, v52
    v_dot2c_f32_bf16 v21, v53, v30
    v_dot2c_f32_bf16 v23, v53, v53
    v_dot2c_f32_bf16 v20, v54, v30
    v_dot2c_f32_bf16 v22, v54, v54
    v_dot2c_f32_bf16 v21, v55, v30
    v_dot2c_f32_bf16 v23, v55, v55
    v_dot2c_f32_bf16 v20, v56, v30
    v_dot2c_f32_bf16 v22, v56, v56
    v_dot2c_f32_bf16 v21, v57, v30
    v_dot2c_f32_bf16 v23, v57, v57
    v_dot2c_f32_bf16 v20, v58, v30
    v_dot2c_f32_bf16 v22, v58, v58
    v_dot2c_f32_bf16 v21, v59, v30
    v_dot2c_f32_bf16 v23, v59, v59
    v_dot2c_f32_bf16 v20, v60, v30
    v_dot2c_f32_bf16 v22, v60, v60
    v_dot2c_f32_bf16 v21, v61, v30
    v_dot2c_f32_bf16 v23, v61, v61
    v_dot2c_f32_bf16 v20, v62, v30
    v_dot2c_f32_bf16 v22, v62, v62
    v_dot2c_f32_bf16 v21, v63, v30
    v_dot2c_f32_bf16 v23, v63, v63
    s_waitcnt vmcnt(8)
    s_barrier
    ds_read_b128 v[48:51], v14 offset:33792
    ds_read_b128 v[52:55], v15 offset:33792
    ds_read_b128 v[56:59], v16 offset:33792
    ds_read_b128 v[60:63], v17 offset:33792
    s_add_u32 m0, s35, 101376
    s_nop 0
    buffer_load_dwordx4 v4, s[8:11], s33 offen offset:0 lds
    buffer_load_dwordx4 v5, s[8:11], s33 offen offset:1088 lds
    buffer_load_dwordx4 v6, s[8:11], s33 offen offset:2176 lds
    buffer_load_dwordx4 v7, s[8:11], s33 offen offset:3264 lds
    s_add_u32 s33, s33, s62
    s_add_u32 m0, s36, 101376
    s_nop 0
    buffer_load_dwordx4 v8, s[4:7], s34 offen offset:0 lds
    buffer_load_dwordx4 v9, s[4:7], s34 offen offset:1024 lds
    buffer_load_dwordx4 v10, s[4:7], s34 offen offset:2048 lds
    buffer_load_dwordx4 v11, s[4:7], s34 offen offset:3072 lds
    s_add_u32 s34, s34, s64
    s_waitcnt lgkmcnt(0)
    v_dot2c_f32_bf16 v20, v48, v30
    v_dot2c_f32_bf16 v22, v48, v48
    v_dot2c_f32_bf16 v21, v49, v30
    v_dot2c_f32_bf16 v23, v49, v49
    v_dot2c_f32_bf16 v20, v50, v30
    v_dot2c_f32_bf16 v22, v50, v50
    v_dot2c_f32_bf16 v21, v51, v30
    v_dot2c_f32_bf16 v23, v51, v51
    v_dot2c_f32_bf16 v20, v52, v30
    v_dot2c_f32_bf16 v22, v52, v52
    v_dot2c_f32_bf16 v21, v53, v30
    v_dot2c_f32_bf16 v23, v53, v53
    v_dot2c_f32_bf16 v20, v54, v30
    v_dot2c_f32_bf16 v22, v54, v54
    v_dot2c_f32_bf16 v21, v55, v30
    v_dot2c_f32_bf16 v23, v55, v55
    v_dot2c_f32_bf16 v20, v56, v30
    v_dot2c_f32_bf16 v22, v56, v56
    v_dot2c_f32_bf16 v21, v57, v30
    v_dot2c_f32_bf16 v23, v57, v57
    v_dot2c_f32_bf16 v20, v58, v30
    v_dot2c_f32_bf16 v22, v58, v58
    v_dot2c_f32_bf16 v21, v59, v30
    v_dot2c_f32_bf16 v23, v59, v59
    v_dot2c_f32_bf16 v20, v60, v30
    v_dot2c_f32_bf16 v22, v60, v60
    v_dot2c_f32_bf16 v21, v61, v30
    v_dot2c_f32_bf16 v23, v61, v61
    v_dot2c_f32_bf16 v20, v62, v30
    v_dot2c_f32_bf16 v22, v62, v62
    v_dot2c_f32_bf16 v21, v63, v30
    v_dot2c_f32_bf16 v23, v63, v63
    s_waitcnt vmcnt(8)
    s_barrier
    ds_read_b128 v[48:51], v44 offset:0
    ds_read_b128 v[52:55], v45 offset:0
    ds_read_b128 v[56:59], v46 offset:0
    ds_read_b128 v[60:63], v47 offset:0
    s_add_u32 m0, s35, 0
    s_nop 0
    buffer_load_dwordx4 v4, s[8:11], s33 offen offset:0 lds
    buffer_load_dwordx4 v5, s[8:11], s33 offen offset:1088 lds
    buffer_load_dwordx4 v6, s[8:11], s33 offen offset:2176 lds
    buffer_load_dwordx4 v7, s[8:11], s33 offen offset:3264 lds
    s_add_u32 s33, s33, s61
    s_add_u32 m0, s36, 0
    s_nop 0
    buffer_load_dwordx4 v8, s[4:7], s34 offen offset:0 lds
    buffer_load_dwordx4 v9, s[4:7], s34 offen offset:1024 lds
    buffer_load_dwordx4 v10, s[4:7], s34 offen offset:2048 lds
    buffer_load_dwordx4 v11, s[4:7], s34 offen offset:3072 lds
    s_add_u32 s34, s34, s63
    s_waitcnt lgkmcnt(0)
    v_dot2c_f32_bf16 v20, v48, v30
    v_dot2c_f32_bf16 v22, v48, v48
    v_dot2c_f32_bf16 v21, v49, v30
    v_dot2c_f32_bf16 v23, v49, v49
    v_dot2c_f32_bf16 v20, v50, v30
    v_dot2c_f32_bf16 v22, v50, v50
    v_dot2c_f32_bf16 v21, v51, v30
    v_dot2c_f32_bf16 v23, v51, v51
    v_dot2c_f32_bf16 v20, v52, v30
    v_dot2c_f32_bf16 v22, v52, v52
    v_dot2c_f32_bf16 v21, v53, v30
    v_dot2c_f32_bf16 v23, v53, v53
    v_dot2c_f32_bf16 v20, v54, v30
    v_dot2c_f32_bf16 v22, v54, v54
    v_dot2c_f32_bf16 v21, v55, v30
    v_dot2c_f32_bf16 v23, v55, v55
    v_dot2c_f32_bf16 v20, v56, v30
    v_dot2c_f32_bf16 v22, v56, v56
    v_dot2c_f32_bf16 v21, v57, v30
    v_dot2c_f32_bf16 v23, v57, v57
    v_dot2c_f32_bf16 v20, v58, v30
    v_dot2c_f32_bf16 v22, v58, v58
    v_dot2c_f32_bf16 v21, v59, v30
    v_dot2c_f32_bf16 v23, v59, v59
    v_dot2c_f32_bf16 v20, v60, v30
    v_dot2c_f32_bf16 v22, v60, v60
    v_dot2c_f32_bf16 v21, v61, v30
    v_dot2c_f32_bf16 v23, v61, v61
    v_dot2c_f32_bf16 v20, v62, v30
    v_dot2c_f32_bf16 v22, v62, v62
    v_dot2c_f32_bf16 v21, v63, v30
    v_dot2c_f32_bf16 v23, v63, v63
    s_waitcnt vmcnt(8)
    s_barrier
    ds_read_b128 v[48:51], v44 offset:33792
    ds_read_b128 v[52:55], v45 offset:33792
    ds_read_b128 v[56:59], v46 offset:33792
    ds_read_b128 v[60:63], v47 offset:33792
    s_add_u32 m0, s35, 33792
    s_nop 0
    buffer_load_dwordx4 v4, s[8:11], s33 offen offset:0 lds
    buffer_load_dwordx4 v5, s[8:11], s33 offen offset:1088 lds
    buffer_load_dwordx4 v6, s[8:11], s33 offen offset:2176 lds
    buffer_load_dwordx4 v7, s[8:11], s33 offen offset:3264 lds
    s_add_u32 s33, s33, s62
    s_add_u32 m0, s36, 33792
    s_nop 0
    buffer_load_dwordx4 v8, s[4:7], s34 offen offset:0 lds
    buffer_load_dwordx4 v9, s[4:7], s34 offen offset:1024 lds
    buffer_load_dwordx4 v10, s[4:7], s34 offen offset:2048 lds
    buffer_load_dwordx4 v11, s[4:7], s34 offen offset:3072 lds
    s_add_u32 s34, s34, s64
    s_waitcnt lgkmcnt(0)
    v_dot2c_f32_bf16 v20, v48, v30
    v_dot2c_f32_bf16 v22, v48, v48
    v_dot2c_f32_bf16 v21, v49, v30
    v_dot2c_f32_bf16 v23, v49, v49
    v_dot2c_f32_bf16 v20, v50, v30
    v_dot2c_f32_bf16 v22, v50, v50
    v_dot2c_f32_bf16 v21, v51, v30
    v_dot2c_f32_bf16 v23, v51, v51
    v_dot2c_f32_bf16 v20, v52, v30
    v_dot2c_f32_bf16 v22, v52, v52
    v_dot2c_f32_bf16 v21, v53, v30
    v_dot2c_f32_bf16 v23, v53, v53
    v_dot2c_f32_bf16 v20, v54, v30
    v_dot2c_f32_bf16 v22, v54, v54
    v_dot2c_f32_bf16 v21, v55, v30
    v_dot2c_f32_bf16 v23, v55, v55
    v_dot2c_f32_bf16 v20, v56, v30
    v_dot2c_f32_bf16 v22, v56, v56
    v_dot2c_f32_bf16 v21, v57, v30
    v_dot2c_f32_bf16 v23, v57, v57
    v_dot2c_f32_bf16 v20, v58, v30
    v_dot2c_f32_bf16 v22, v58, v58
    v_dot2c_f32_bf16 v21, v59, v30
    v_dot2c_f32_bf16 v23, v59, v59
    v_dot2c_f32_bf16 v20, v60, v30
    v_dot2c_f32_bf16 v22, v60, v60
    v_dot2c_f32_bf16 v21, v61, v30
    v_dot2c_f32_bf16 v23, v61, v61
    v_dot2c_f32_bf16 v20, v62, v30
    v_dot2c_f32_bf16 v22, v62, v62
    v_dot2c_f32_bf16 v21, v63, v30
    v_dot2c_f32_bf16 v23, v63, v63
    s_waitcnt vmcnt(8)
    s_barrier
    ds_read_b128 v[48:51], v14 offset:0
    ds_read_b128 v[52:55], v15 offset:0
    ds_read_b128 v[56:59], v16 offset:0
    ds_read_b128 v[60:63], v17 offset:0
    s_add_u32 m0, s35, 67584
    s_nop 0
    buffer_load_dwordx4 v4, s[8:11], s33 offen offset:0 lds
    buffer_load_dwordx4 v5, s[8:11], s33 offen offset:1088 lds
    buffer_load_dwordx4 v6, s[8:11], s33 offen offset:2176 lds
    buffer_load_dwordx4 v7, s[8:11], s33 offen offset:3264 lds
    s_add_u32 s33, s33, s61
    s_add_u32 m0, s36, 67584
    s_nop 0
    buffer_load_dwordx4 v8, s[4:7], s34 offen offset:0 lds
    buffer_load_dwordx4 v9, s[4:7], s34 offen offset:1024 lds
    buffer_load_dwordx4 v10, s[4:7], s34 offen offset:2048 lds
    buffer_load_dwordx4 v11, s[4:7], s34 offen offset:3072 lds
    s_add_u32 s34, s34, s63
    s_waitcnt lgkmcnt(0)
    v_dot2c_f32_bf16 v20, v48, v30
    v_dot2c_f32_bf16 v22, v48, v48
    v_dot2c_f32_bf16 v21, v49, v30
    v_dot2c_f32_bf16 v23, v49, v49
    v_dot2c_f32_bf16 v20, v50, v30
    v_dot2c_f32_bf16 v22, v50, v50
    v_dot2c_f32_bf16 v21, v51, v30
    v_dot2c_f32_bf16 v23, v51, v51
    v_dot2c_f32_bf16 v20, v52, v30
    v_dot2c_f32_bf16 v22, v52, v52
    v_dot2c_f32_bf16 v21, v53, v30
    v_dot2c_f32_bf16 v23, v53, v53
    v_dot2c_f32_bf16 v20, v54, v30
    v_dot2c_f32_bf16 v22, v54, v54
    v_dot2c_f32_bf16 v21, v55, v30
    v_dot2c_f32_bf16 v23, v55, v55
    v_dot2c_f32_bf16 v20, v56, v30
    v_dot2c_f32_bf16 v22, v56, v56
    v_dot2c_f32_bf16 v21, v57, v30
    v_dot2c_f32_bf16 v23, v57, v57
    v_dot2c_f32_bf16 v20, v58, v30
    v_dot2c_f32_bf16 v22, v58, v58
    v_dot2c_f32_bf16 v21, v59, v30
    v_dot2c_f32_bf16 v23, v59, v59
    v_dot2c_f32_bf16 v20, v60, v30
    v_dot2c_f32_bf16 v22, v60, v60
    v_dot2c_f32_bf16 v21, v61, v30
    v_dot2c_f32_bf16 v23, v61, v61
    v_dot2c_f32_bf16 v20, v62, v30
    v_dot2c_f32_bf16 v22, v62, v62
    v_dot2c_f32_bf16 v21, v63, v30
    v_dot2c_f32_bf16 v23, v63, v63
    s_waitcnt vmcnt(8)
    s_barrier
    ds_read_b128 v[48:51], v14 offset:33792
    ds_read_b128 v[52:55], v15 offset:33792
    ds_read_b128 v[56:59], v16 offset:33792
    ds_read_b128 v[60:63], v17 offset:33792
    s_add_u32 m0, s35, 101376
    s_nop 0
    buffer_load_dwordx4 v4, s[8:11], s33 offen offset:0 lds
    buffer_load_dwordx4 v5, s[8:11], s33 offen offset:1088 lds
    buffer_load_dwordx4 v6, s[8:11], s33 offen offset:2176 lds
    buffer_load_dwordx4 v7, s[8:11], s33 offen offset:3264 lds
    s_add_u32 s33, s33, s62
    s_add_u32 m0, s36, 101376
    s_nop 0
    buffer_load_dwordx4 v8, s[4:7], s34 offen offset:0 lds
    buffer_load_dwordx4 v9, s[4:7], s34 offen offset:1024 lds
    buffer_load_dwordx4 v10, s[4:7], s34 offen offset:2048 lds
    buffer_load_dwordx4 v11, s[4:7], s34 offen offset:3072 lds
    s_add_u32 s34, s34, s64
    s_waitcnt lgkmcnt(0)
    v_dot2c_f32_bf16 v20, v48, v30
    v_dot2c_f32_bf16 v22, v48, v48
    v_dot2c_f32_bf16 v21, v49, v30
    v_dot2c_f32_bf16 v23, v49, v49
    v_dot2c_f32_bf16 v20, v50, v30
    v_dot2c_f32_bf16 v22, v50, v50
    v_dot2c_f32_bf16 v21, v51, v30
    v_dot2c_f32_bf16 v23, v51, v51
    v_dot2c_f32_bf16 v20, v52, v30
    v_dot2c_f32_bf16 v22, v52, v52
    v_dot2c_f32_bf16 v21, v53, v30
    v_dot2c_f32_bf16 v23, v53, v53
    v_dot2c_f32_bf16 v20, v54, v30
    v_dot2c_f32_bf16 v22, v54, v54
    v_dot2c_f32_bf16 v21, v55, v30
    v_dot2c_f32_bf16 v23, v55, v55
    v_dot2c_f32_bf16 v20, v56, v30
    v_dot2c_f32_bf16 v22, v56, v56
    v_dot2c_f32_bf16 v21, v57, v30
    v_dot2c_f32_bf16 v23, v57, v57
    v_dot2c_f32_bf16 v20, v58, v30
    v_dot2c_f32_bf16 v22, v58, v58
    v_dot2c_f32_bf16 v21, v59, v30
    v_dot2c_f32_bf16 v23, v59, v59
    v_dot2c_f32_bf16 v20, v60, v30
    v_dot2c_f32_bf16 v22, v60, v60
    v_dot2c_f32_bf16 v21, v61, v30
    v_dot2c_f32_bf16 v23, v61, v61
    v_dot2c_f32_bf16 v20, v62, v30
    v_dot2c_f32_bf16 v22, v62, v62
    v_dot2c_f32_bf16 v21, v63, v30
    v_dot2c_f32_bf16 v23, v63, v63
    s_waitcnt vmcnt(8)
    s_barrier
    ds_read_b128 v[48:51], v44 offset:0
    ds_read_b128 v[52:55], v45 offset:0
    ds_read_b128 v[56:59], v46 offset:0
    ds_read_b128 v[60:63], v47 offset:0
    s_add_u32 m0, s35, 0
    s_nop 0
    buffer_load_dwordx4 v4, s[8:11], s33 offen offset:0 lds
    buffer_load_dwordx4 v5, s[8:11], s33 offen offset:1088 lds
    buffer_load_dwordx4 v6, s[8:11], s33 offen offset:2176 lds
    buffer_load_dwordx4 v7, s[8:11], s33 offen offset:3264 lds
    s_add_u32 s33, s33, s61
    s_add_u32 m0, s36, 0
    s_nop 0
    buffer_load_dwordx4 v8, s[4:7], s34 offen offset:0 lds
    buffer_load_dwordx4 v9, s[4:7], s34 offen offset:1024 lds
    buffer_load_dwordx4 v10, s[4:7], s34 offen offset:2048 lds
    buffer_load_dwordx4 v11, s[4:7], s34 offen offset:3072 lds
    s_add_u32 s34, s34, s63
    s_waitcnt lgkmcnt(0)
    v_dot2c_f32_bf16 v20, v48, v30
    v_dot2c_f32_bf16 v22, v48, v48
    v_dot2c_f32_bf16 v21, v49, v30
    v_dot2c_f32_bf16 v23, v49, v49
    v_dot2c_f32_bf16 v20, v50, v30
    v_dot2c_f32_bf16 v22, v50, v50
    v_dot2c_f32_bf16 v21, v51, v30
    v_dot2c_f32_bf16 v23, v51, v51
    v_dot2c_f32_bf16 v20, v52, v30
    v_dot2c_f32_bf16 v22, v52, v52
    v_dot2c_f32_bf16 v21, v53, v30
    v_dot2c_f32_bf16 v23, v53, v53
    v_dot2c_f32_bf16 v20, v54, v30
    v_dot2c_f32_bf16 v22, v54, v54
    v_dot2c_f32_bf16 v21, v55, v30
    v_dot2c_f32_bf16 v23, v55, v55
    v_dot2c_f32_bf16 v20, v56, v30
    v_dot2c_f32_bf16 v22, v56, v56
    v_dot2c_f32_bf16 v21, v57, v30
    v_dot2c_f32_bf16 v23, v57, v57
    v_dot2c_f32_bf16 v20, v58, v30
    v_dot2c_f32_bf16 v22, v58, v58
    v_dot2c_f32_bf16 v21, v59, v30
    v_dot2c_f32_bf16 v23, v59, v59
    v_dot2c_f32_bf16 v20, v60, v30
    v_dot2c_f32_bf16 v22, v60, v60
    v_dot2c_f32_bf16 v21, v61, v30
    v_dot2c_f32_bf16 v23, v61, v61
    v_dot2c_f32_bf16 v20, v62, v30
    v_dot2c_f32_bf16 v22, v62, v62
    v_dot2c_f32_bf16 v21, v63, v30
    v_dot2c_f32_bf16 v23, v63, v63
    s_waitcnt vmcnt(8)
    s_barrier
    ds_read_b128 v[48:51], v44 offset:33792
    ds_read_b128 v[52:55], v45 offset:33792
    ds_read_b128 v[56:59], v46 offset:33792
    ds_read_b128 v[60:63], v47 offset:33792
    s_add_u32 m0, s35, 33792
    s_nop 0
    buffer_load_dwordx4 v4, s[8:11], s33 offen offset:0 lds
    buffer_load_dwordx4 v5, s[8:11], s33 offen offset:1088 lds
    buffer_load_dwordx4 v6, s[8:11], s33 offen offset:2176 lds
    buffer_load_dwordx4 v7, s[8:11], s33 offen offset:3264 lds
    s_add_u32 s33, s33, s62
    s_add_u32 m0, s36, 33792
    s_nop 0
    buffer_load_dwordx4 v8, s[4:7], s34 offen offset:0 lds
    buffer_load_dwordx4 v9, s[4:7], s34 offen offset:1024 lds
    buffer_load_dwordx4 v10, s[4:7], s34 offen offset:2048 lds
    buffer_load_dwordx4 v11, s[4:7], s34 offen offset:3072 lds
    s_add_u32 s34, s34, s64
    s_waitcnt lgkmcnt(0)
    v_dot2c_f32_bf16 v20, v48, v30
    v_dot2c_f32_bf16 v22, v48, v48
    v_dot2c_f32_bf16 v21, v49, v30
    v_dot2c_f32_bf16 v23, v49, v49
    v_dot2c_f32_bf16 v20, v50, v30
    v_dot2c_f32_bf16 v22, v50, v50
    v_dot2c_f32_bf16 v21, v51, v30
    v_dot2c_f32_bf16 v23, v51, v51
    v_dot2c_f32_bf16 v20, v52, v30
    v_dot2c_f32_bf16 v22, v52, v52
    v_dot2c_f32_bf16 v21, v53, v30
    v_dot2c_f32_bf16 v23, v53, v53
    v_dot2c_f32_bf16 v20, v54, v30
    v_dot2c_f32_bf16 v22, v54, v54
    v_dot2c_f32_bf16 v21, v55, v30
    v_dot2c_f32_bf16 v23, v55, v55
    v_dot2c_f32_bf16 v20, v56, v30
    v_dot2c_f32_bf16 v22, v56, v56
    v_dot2c_f32_bf16 v21, v57, v30
    v_dot2c_f32_bf16 v23, v57, v57
    v_dot2c_f32_bf16 v20, v58, v30
    v_dot2c_f32_bf16 v22, v58, v58
    v_dot2c_f32_bf16 v21, v59, v30
    v_dot2c_f32_bf16 v23, v59, v59
    v_dot2c_f32_bf16 v20, v60, v30
    v_dot2c_f32_bf16 v22, v60, v60
    v_dot2c_f32_bf16 v21, v61, v30
    v_dot2c_f32_bf16 v23, v61, v61
    v_dot2c_f32_bf16 v20, v62, v30
    v_dot2c_f32_bf16 v22, v62, v62
    v_dot2c_f32_bf16 v21, v63, v30
    v_dot2c_f32_bf16 v23, v63, v63
    s_waitcnt vmcnt(8)
    s_barrier
    ds_read_b128 v[48:51], v14 offset:0
    ds_read_b128 v[52:55], v15 offset:0
    ds_read_b128 v[56:59], v16 offset:0
    ds_read_b128 v[60:63], v17 offset:0
    s_waitcnt lgkmcnt(0)
    v_dot2c_f32_bf16 v20, v48, v30
    v_dot2c_f32_bf16 v22, v48, v48
    v_dot2c_f32_bf16 v21, v49, v30
    v_dot2c_f32_bf16 v23, v49, v49
    v_dot2c_f32_bf16 v20, v50, v30
    v_dot2c_f32_bf16 v22, v50, v50
    v_dot2c_f32_bf16 v21, v51, v30
    v_dot2c_f32_bf16 v23, v51, v51
    v_dot2c_f32_bf16 v20, v52, v30
    v_dot2c_f32_bf16 v22, v52, v52
    v_dot2c_f32_bf16 v21, v53, v30
    v_dot2c_f32_bf16 v23, v53, v53
    v_dot2c_f32_bf16 v20, v54, v30
    v_dot2c_f32_bf16 v22, v54, v54
    v_dot2c_f32_bf16 v21, v55, v30
    v_dot2c_f32_bf16 v23, v55, v55
    v_dot2c_f32_bf16 v20, v56, v30
    v_dot2c_f32_bf16 v22, v56, v56
    v_dot2c_f32_bf16 v21, v57, v30
    v_dot2c_f32_bf16 v23, v57, v57
    v_dot2c_f32_bf16 v20, v58, v30
    v_dot2c_f32_bf16 v22, v58, v58
    v_dot2c_f32_bf16 v21, v59, v30
    v_dot2c_f32_bf16 v23, v59, v59
    v_dot2c_f32_bf16 v20, v60, v30
    v_dot2c_f32_bf16 v22, v60, v60
    v_dot2c_f32_bf16 v21, v61, v30
    v_dot2c_f32_bf16 v23, v61, v61
    v_dot2c_f32_bf16 v20, v62, v30
    v_dot2c_f32_bf16 v22, v62, v62
    v_dot2c_f32_bf16 v21, v63, v30
    v_dot2c_f32_bf16 v23, v63, v63
    s_waitcnt vmcnt(0)
    s_lshl_b32 s32, s16, 6
    v_add_u32 v24, s32, v2
    s_getpc_b64 s[70:71]
Lpc_q:
    s_add_u32 s70, s70, (Lqkv_end-Lpc_q)&0xffffffff
    s_addc_u32 s71, s71, ((Lqkv_end-Lpc_q)>>32)&0xffffffff
    v_lshlrev_b32 v25, 7, v24
    v_min_u32 v255, Lcode_end-Lqkv_end-4, v25
    global_load_dword v254, v255, s[70:71]
    v_add_u32 v25, 32768, v25
    v_min_u32 v255, Lcode_end-Lqkv_end-4, v25
    global_load_dword v254, v255, s[70:71]
    s_barrier
    ds_read_b128 v[48:51], v14 offset:33792
    ds_read_b128 v[52:55], v15 offset:33792
    ds_read_b128 v[56:59], v16 offset:33792
    ds_read_b128 v[60:63], v17 offset:33792
    s_waitcnt lgkmcnt(0)
    v_dot2c_f32_bf16 v20, v48, v30
    v_dot2c_f32_bf16 v22, v48, v48
    v_dot2c_f32_bf16 v21, v49, v30
    v_dot2c_f32_bf16 v23, v49, v49
    v_dot2c_f32_bf16 v20, v50, v30
    v_dot2c_f32_bf16 v22, v50, v50
    v_dot2c_f32_bf16 v21, v51, v30
    v_dot2c_f32_bf16 v23, v51, v51
    v_dot2c_f32_bf16 v20, v52, v30
    v_dot2c_f32_bf16 v22, v52, v52
    v_dot2c_f32_bf16 v21, v53, v30
    v_dot2c_f32_bf16 v23, v53, v53
    v_dot2c_f32_bf16 v20, v54, v30
    v_dot2c_f32_bf16 v22, v54, v54
    v_dot2c_f32_bf16 v21, v55, v30
    v_dot2c_f32_bf16 v23, v55, v55
    v_dot2c_f32_bf16 v20, v56, v30
    v_dot2c_f32_bf16 v22, v56, v56
    v_dot2c_f32_bf16 v21, v57, v30
    v_dot2c_f32_bf16 v23, v57, v57
    v_dot2c_f32_bf16 v20, v58, v30
    v_dot2c_f32_bf16 v22, v58, v58
    v_dot2c_f32_bf16 v21, v59, v30
    v_dot2c_f32_bf16 v23, v59, v59
    v_dot2c_f32_bf16 v20, v60, v30
    v_dot2c_f32_bf16 v22, v60, v60
    v_dot2c_f32_bf16 v21, v61, v30
    v_dot2c_f32_bf16 v23, v61, v61
    v_dot2c_f32_bf16 v20, v62, v30
    v_dot2c_f32_bf16 v22, v62, v62
    v_dot2c_f32_bf16 v21, v63, v30
    v_dot2c_f32_bf16 v23, v63, v63
    s_barrier
    s_nop 2
    v_add_f32 v20, v20, v21
    v_add_f32 v22, v22, v23
    v_mov_b32 v32, v20
    v_mov_b32 v33, v22
    v_lshlrev_b32 v27, 2, v27
    s_lshl_b32 s32, s16, 7
    v_permlane32_swap_b32 v20, v32
    v_permlane32_swap_b32 v22, v33
    s_add_u32 s32, s32, 135168
    v_add_f32 v20, v20, v32
    v_add_f32 v22, v22, v33
    v_mul_f32 v20, 0x3acccccd, v20
    v_mul_f32 v22, 0x3acccccd, v22
    v_fma_f32 v22, -v20, v20, v22
    v_max_f32 v22, 0, v22
    v_add_f32 v22, 0x3727c5ac, v22
    v_rsq_f32 v22, v22
    v_add_u32 v27, s32, v27
    ds_write2_b32 v27, v20, v22 offset0:0 offset1:128
    s_waitcnt lgkmcnt(0)
    s_barrier
    s_branch Lone_help
Lqkv_cons:
    s_cmp_lg_u32 s16, 0
    s_cbranch_scc1 Lqkv_c1
    s_mul_i32 s32, s31, 12
    v_add_u32 v3, s32, v2
    s_mov_b64 exec, 0xfff
    s_getpc_b64 s[70:71]
Lpc_q0:
    s_add_u32 s70, s70, (sequential_preLN__softmax_full_mha__geglu_ffn__prompt_kernel-Lpc_q0)&0xffffffff
    s_addc_u32 s71, s71, ((sequential_preLN__softmax_full_mha__geglu_ffn__prompt_kernel-Lpc_q0)>>32)&0xffffffff
    v_lshlrev_b32 v3, 7, v3
    v_min_u32 v255, Lcode_end-sequential_preLN__softmax_full_mha__geglu_ffn__prompt_kernel-4, v3
    global_load_dword v254, v255, s[70:71]
    s_mov_b64 exec, -1
Lqkv_c1:
    s_and_b32 s41, s16, 1
    s_lshr_b32 s42, s16, 1
    v_bfe_u32 v26, v2, 2, 2
    v_mul_u32_u24 v12, 1088, v26
    v_lshrrev_b32 v26, 5, v2
    v_lshl_add_u32 v12, v26, 9, v12
    v_bfe_u32 v27, v2, 4, 1
    v_lshl_add_u32 v12, v27, 5, v12
    v_and_b32 v27, 3, v2
    v_lshl_add_u32 v12, v27, 3, v12
    s_lshl_b32 s32, s42, 7
    s_lshl_b32 s43, s41, 6
    s_add_u32 s44, s32, s43
    s_xor_b32 s43, s43, 64
    s_add_u32 s45, s32, s43
    v_add_u32 v13, s45, v12
    v_add_u32 v12, s44, v12
    v_and_b32 v27, 31, v2
    v_bfe_u32 v28, v2, 1, 3
    v_xor_b32 v28, v28, v26
    v_lshlrev_b32 v28, 4, v28
    v_lshl_add_u32 v28, v27, 7, v28
    s_lshl_b32 s32, s41, 13
    s_add_u32 s44, s32, 17408
    v_xor_b32 v29, 0, v28
    v_add_u32 v14, s44, v29
    v_xor_b32 v29, 32, v28
    v_add_u32 v15, s44, v29
    v_xor_b32 v29, 64, v28
    v_add_u32 v16, s44, v29
    v_xor_b32 v29, 96, v28
    v_add_u32 v17, s44, v29
    v_mov_b32 v128, v12
    v_mov_b32 v129, v13
    v_mov_b32 v130, v14
    v_mov_b32 v131, v15
    v_mov_b32 v132, v16
    v_mov_b32 v133, v17
    v_mov_b32 v64, 0
    v_mov_b32 v65, 0
    v_mov_b32 v66, 0
    v_mov_b32 v67, 0
    v_mov_b32 v68, 0
    v_mov_b32 v69, 0
    v_mov_b32 v70, 0
    v_mov_b32 v71, 0
    v_mov_b32 v72, 0
    v_mov_b32 v73, 0
    v_mov_b32 v74, 0
    v_mov_b32 v75, 0
    v_mov_b32 v76, 0
    v_mov_b32 v77, 0
    v_mov_b32 v78, 0
    v_mov_b32 v79, 0
    v_mov_b32 v80, 0
    v_mov_b32 v81, 0
    v_mov_b32 v82, 0
    v_mov_b32 v83, 0
    v_mov_b32 v84, 0
    v_mov_b32 v85, 0
    v_mov_b32 v86, 0
    v_mov_b32 v87, 0
    v_mov_b32 v88, 0
    v_mov_b32 v89, 0
    v_mov_b32 v90, 0
    v_mov_b32 v91, 0
    v_mov_b32 v92, 0
    v_mov_b32 v93, 0
    v_mov_b32 v94, 0
    v_mov_b32 v95, 0
    v_mov_b32 v96, 0
    v_mov_b32 v97, 0
    v_mov_b32 v98, 0
    v_mov_b32 v99, 0
    v_mov_b32 v100, 0
    v_mov_b32 v101, 0
    v_mov_b32 v102, 0
    v_mov_b32 v103, 0
    v_mov_b32 v104, 0
    v_mov_b32 v105, 0
    v_mov_b32 v106, 0
    v_mov_b32 v107, 0
    v_mov_b32 v108, 0
    v_mov_b32 v109, 0
    v_mov_b32 v110, 0
    v_mov_b32 v111, 0
    v_mov_b32 v112, 0
    v_mov_b32 v113, 0
    v_mov_b32 v114, 0
    v_mov_b32 v115, 0
    v_mov_b32 v116, 0
    v_mov_b32 v117, 0
    v_mov_b32 v118, 0
    v_mov_b32 v119, 0
    v_mov_b32 v120, 0
    v_mov_b32 v121, 0
    v_mov_b32 v122, 0
    v_mov_b32 v123, 0
    v_mov_b32 v124, 0
    v_mov_b32 v125, 0
    v_mov_b32 v126, 0
    v_mov_b32 v127, 0
    v_and_b32 v29, 15, v2
    v_bfe_u32 v30, v2, 4, 1
    v_cmp_eq_u32 vcc, v29, v30
    v_mov_b32 v29, 0x3f803f80
    v_mov_b32 v22, 0
    v_cndmask_b32 v18, 0, v29, vcc
    v_mov_b32 v23, 0
    v_mov_b32 v24, 0
    v_mov_b32 v25, 0
    v_mov_b32 v19, v18
    v_mov_b32 v20, v18
    v_mov_b32 v21, v18
    s_mov_b32 s37, 0
    s_mov_b32 s38, 33792
    s_mul_i32 s47, s18, 52
    s_lshr_b32 s47, s47, 8
    s_mul_i32 s32, s47, 5
    s_sub_u32 s46, s18, s32
    s_lshl_b32 s48, s17, 2
    s_lshl_b32 s32, s41, 1
    s_add_u32 s48, s48, s32
    s_cmp_eq_u32 s47, 2
    s_cbranch_scc1 Lqkv_v
    s_mov_b32 s49, 172032
    s_mov_b32 s50, 2688
    s_cmp_eq_u32 s47, 0
    s_cselect_b32 s49, 81920, s49
    s_cselect_b32 s50, 1280, s50
    s_cselect_b32 s51, 0, 2621440
    s_cselect_b32 s52, 0x3ea52b5c, 1.0
    s_lshl_b32 s32, s46, 5
    s_lshl_b32 s43, s42, 4
    s_add_u32 s32, s32, s43
    v_add_u32 v29, s32, v26
    v_lshlrev_b32 v30, 4, v27
    v_lshlrev_b32 v31, 3, v27
    v_add_u32 v31, 1024, v31
    s_lshl_b32 s43, s41, 3
    v_add_u32 v32, s43, v29
    v_mul_u32_u24 v33, 205, v32
    v_lshrrev_b32 v33, 10, v33
    v_mad_i32_i24 v34, v33, -5, v32
    v_and_b32 v35, 1, v33
    v_sub_u32 v34, v34, v35
    v_min_u32 v34, 4, v34
    v_lshrrev_b32 v35, 1, v34
    v_lshl_add_u32 v35, v35, 9, v30
    v_and_b32 v36, 1, v34
    v_cmp_eq_u32 vcc, 4, v34
    v_lshl_add_u32 v35, v36, 3, v35
    s_nop 0
    v_cndmask_b32 v35, v35, v31, vcc
    v_mad_u32_u24 v140, v33, s49, v35
    v_add_u32 v32, s43, v29
    v_add_u32 v32, 2, v32
    v_mul_u32_u24 v33, 205, v32
    v_lshrrev_b32 v33, 10, v33
    v_mad_i32_i24 v34, v33, -5, v32
    v_and_b32 v35, 1, v33
    v_sub_u32 v34, v34, v35
    v_min_u32 v34, 4, v34
    v_lshrrev_b32 v35, 1, v34
    v_lshl_add_u32 v35, v35, 9, v30
    v_and_b32 v36, 1, v34
    v_cmp_eq_u32 vcc, 4, v34
    v_lshl_add_u32 v35, v36, 3, v35
    s_nop 0
    v_cndmask_b32 v35, v35, v31, vcc
    v_mad_u32_u24 v141, v33, s49, v35
    v_add_u32 v32, s43, v29
    v_add_u32 v32, 4, v32
    v_mul_u32_u24 v33, 205, v32
    v_lshrrev_b32 v33, 10, v33
    v_mad_i32_i24 v34, v33, -5, v32
    v_and_b32 v35, 1, v33
    v_sub_u32 v34, v34, v35
    v_min_u32 v34, 4, v34
    v_lshrrev_b32 v35, 1, v34
    v_lshl_add_u32 v35, v35, 9, v30
    v_and_b32 v36, 1, v34
    v_cmp_eq_u32 vcc, 4, v34
    v_lshl_add_u32 v35, v36, 3, v35
    s_nop 0
    v_cndmask_b32 v35, v35, v31, vcc
    v_mad_u32_u24 v142, v33, s49, v35
    v_add_u32 v32, s43, v29
    v_add_u32 v32, 6, v32
    v_mul_u32_u24 v33, 205, v32
    v_lshrrev_b32 v33, 10, v33
    v_mad_i32_i24 v34, v33, -5, v32
    v_and_b32 v35, 1, v33
    v_sub_u32 v34, v34, v35
    v_min_u32 v34, 4, v34
    v_lshrrev_b32 v35, 1, v34
    v_lshl_add_u32 v35, v35, 9, v30
    v_and_b32 v36, 1, v34
    v_cmp_eq_u32 vcc, 4, v34
    v_lshl_add_u32 v35, v36, 3, v35
    s_nop 0
    v_cndmask_b32 v35, v35, v31, vcc
    v_mad_u32_u24 v143, v33, s49, v35
    s_xor_b32 s43, s43, 8
    v_add_u32 v32, s43, v29
    v_mul_u32_u24 v33, 205, v32
    v_lshrrev_b32 v33, 10, v33
    v_mad_i32_i24 v34, v33, -5, v32
    v_and_b32 v35, 1, v33
    v_sub_u32 v34, v34, v35
    v_min_u32 v34, 4, v34
    v_lshrrev_b32 v35, 1, v34
    v_lshl_add_u32 v35, v35, 9, v30
    v_and_b32 v36, 1, v34
    v_cmp_eq_u32 vcc, 4, v34
    v_lshl_add_u32 v35, v36, 3, v35
    s_nop 0
    v_cndmask_b32 v35, v35, v31, vcc
    v_mad_u32_u24 v144, v33, s49, v35
    v_add_u32 v32, s43, v29
    v_add_u32 v32, 2, v32
    v_mul_u32_u24 v33, 205, v32
    v_lshrrev_b32 v33, 10, v33
    v_mad_i32_i24 v34, v33, -5, v32
    v_and_b32 v35, 1, v33
    v_sub_u32 v34, v34, v35
    v_min_u32 v34, 4, v34
    v_lshrrev_b32 v35, 1, v34
    v_lshl_add_u32 v35, v35, 9, v30
    v_and_b32 v36, 1, v34
    v_cmp_eq_u32 vcc, 4, v34
    v_lshl_add_u32 v35, v36, 3, v35
    s_nop 0
    v_cndmask_b32 v35, v35, v31, vcc
    v_mad_u32_u24 v145, v33, s49, v35
    v_add_u32 v32, s43, v29
    v_add_u32 v32, 4, v32
    v_mul_u32_u24 v33, 205, v32
    v_lshrrev_b32 v33, 10, v33
    v_mad_i32_i24 v34, v33, -5, v32
    v_and_b32 v35, 1, v33
    v_sub_u32 v34, v34, v35
    v_min_u32 v34, 4, v34
    v_lshrrev_b32 v35, 1, v34
    v_lshl_add_u32 v35, v35, 9, v30
    v_and_b32 v36, 1, v34
    v_cmp_eq_u32 vcc, 4, v34
    v_lshl_add_u32 v35, v36, 3, v35
    s_nop 0
    v_cndmask_b32 v35, v35, v31, vcc
    v_mad_u32_u24 v146, v33, s49, v35
    v_add_u32 v32, s43, v29
    v_add_u32 v32, 6, v32
    v_mul_u32_u24 v33, 205, v32
    v_lshrrev_b32 v33, 10, v33
    v_mad_i32_i24 v34, v33, -5, v32
    v_and_b32 v35, 1, v33
    v_sub_u32 v34, v34, v35
    v_min_u32 v34, 4, v34
    v_lshrrev_b32 v35, 1, v34
    v_lshl_add_u32 v35, v35, 9, v30
    v_and_b32 v36, 1, v34
    v_cmp_eq_u32 vcc, 4, v34
    v_lshl_add_u32 v35, v36, 3, v35
    s_nop 0
    v_cndmask_b32 v35, v35, v31, vcc
    v_mad_u32_u24 v147, v33, s49, v35
    s_mul_i32 s53, s48, s50
    s_add_u32 s53, s53, s51
    s_add_u32 s54, s53, s50
    s_barrier
    ds_read_b64_tr_b16 v[32:33], v128 offset:0
    ds_read_b64_tr_b16 v[34:35], v128 offset:256
    ds_read_b128 v[48:51], v130 offset:0
    ds_read_b128 v[52:55], v130 offset:4096
    ds_read_b64_tr_b16 v[36:37], v129 offset:0
    ds_read_b64_tr_b16 v[38:39], v129 offset:256
Lqkv_loopa:
    s_waitcnt lgkmcnt(3)
    v_mfma_f32_32x32x16_bf16 v[64:79], v[32:35], v[48:51], v[64:79]
    ds_read_b64_tr_b16 v[40:41], v128 offset:4352
    ds_read_b64_tr_b16 v[42:43], v128 offset:4608
    ds_read_b128 v[56:59], v131 offset:0
    s_waitcnt lgkmcnt(5)
    v_mfma_f32_32x32x16_bf16 v[80:95], v[32:35], v[52:55], v[80:95]
    ds_read_b128 v[60:63], v131 offset:4096
    ds_read_b64_tr_b16 v[44:45], v129 offset:4352
    ds_read_b64_tr_b16 v[46:47], v129 offset:4608
    v_mfma_f32_16x16x32_bf16 v[22:25], v[18:21], v[32:35], v[22:25]
    s_waitcnt lgkmcnt(6)
    v_mfma_f32_32x32x16_bf16 v[96:111], v[36:39], v[48:51], v[96:111]
    v_mfma_f32_32x32x16_bf16 v[112:127], v[36:39], v[52:55], v[112:127]
    s_waitcnt lgkmcnt(3)
    v_mfma_f32_32x32x16_bf16 v[64:79], v[40:43], v[56:59], v[64:79]
    ds_read_b64_tr_b16 v[32:33], v128 offset:8704
    ds_read_b64_tr_b16 v[34:35], v128 offset:8960
    ds_read_b128 v[48:51], v132 offset:0
    s_waitcnt lgkmcnt(5)
    v_mfma_f32_32x32x16_bf16 v[80:95], v[40:43], v[60:63], v[80:95]
    ds_read_b128 v[52:55], v132 offset:4096
    ds_read_b64_tr_b16 v[36:37], v129 offset:8704
    ds_read_b64_tr_b16 v[38:39], v129 offset:8960
    v_mfma_f32_16x16x32_bf16 v[22:25], v[18:21], v[40:43], v[22:25]
    s_waitcnt lgkmcnt(6)
    v_mfma_f32_32x32x16_bf16 v[96:111], v[44:47], v[56:59], v[96:111]
    v_mfma_f32_32x32x16_bf16 v[112:127], v[44:47], v[60:63], v[112:127]
    s_waitcnt lgkmcnt(3)
    v_mfma_f32_32x32x16_bf16 v[64:79], v[32:35], v[48:51], v[64:79]
    ds_read_b64_tr_b16 v[40:41], v128 offset:13056
    ds_read_b64_tr_b16 v[42:43], v128 offset:13312
    ds_read_b128 v[56:59], v133 offset:0
    s_waitcnt lgkmcnt(5)
    v_mfma_f32_32x32x16_bf16 v[80:95], v[32:35], v[52:55], v[80:95]
    ds_read_b128 v[60:63], v133 offset:4096
    ds_read_b64_tr_b16 v[44:45], v129 offset:13056
    ds_read_b64_tr_b16 v[46:47], v129 offset:13312
    v_mfma_f32_16x16x32_bf16 v[22:25], v[18:21], v[32:35], v[22:25]
    s_waitcnt lgkmcnt(6)
    v_mfma_f32_32x32x16_bf16 v[96:111], v[36:39], v[48:51], v[96:111]
    v_mfma_f32_32x32x16_bf16 v[112:127], v[36:39], v[52:55], v[112:127]
    s_waitcnt lgkmcnt(0)
    s_barrier
    v_add_u32 v128, s38, v12
    v_add_u32 v129, s38, v13
    v_add_u32 v130, s38, v14
    v_add_u32 v131, s38, v15
    v_add_u32 v132, s38, v16
    v_add_u32 v133, s38, v17
    v_mfma_f32_32x32x16_bf16 v[64:79], v[40:43], v[56:59], v[64:79]
    ds_read_b64_tr_b16 v[32:33], v128 offset:0
    ds_read_b64_tr_b16 v[34:35], v128 offset:256
    ds_read_b128 v[48:51], v130 offset:0
    v_mfma_f32_32x32x16_bf16 v[80:95], v[40:43], v[60:63], v[80:95]
    ds_read_b128 v[52:55], v130 offset:4096
    ds_read_b64_tr_b16 v[36:37], v129 offset:0
    ds_read_b64_tr_b16 v[38:39], v129 offset:256
    v_mfma_f32_16x16x32_bf16 v[22:25], v[18:21], v[40:43], v[22:25]
    v_mfma_f32_32x32x16_bf16 v[96:111], v[44:47], v[56:59], v[96:111]
    s_add_u32 s38, s38, 33792
    s_cmp_eq_u32 s38, 135168
    s_cselect_b32 s38, 0, s38
    s_add_u32 s37, s37, 1
    s_cmp_lt_u32 s37, 10
    v_mfma_f32_32x32x16_bf16 v[112:127], v[44:47], v[60:63], v[112:127]
    s_cbranch_scc1 Lqkv_loopa
    s_waitcnt lgkmcnt(0)
    v_and_b32 v32, 31, v2
    v_lshlrev_b32 v32, 2, v32
    s_lshl_b32 s32, s42, 8
    s_lshl_b32 s43, s41, 7
    s_add_u32 s32, s32, s43
    s_add_u32 s32, s32, 136192
    v_add_u32 v34, s32, v32
    s_mov_b64 exec, 0xffff
    s_nop 2
    ds_write2_b32 v34, v22, v23 offset0:0 offset1:16
    s_mov_b64 exec, -1
    s_waitcnt lgkmcnt(0)
    s_barrier
    s_lshl_b32 s32, s41, 8
    s_add_u32 s32, s32, 135168
    v_add_u32 v33, s32, v32
    ds_read2_b32 v[22:23], v33 offset0:0 offset1:128
    ds_read2_b32 v[30:31], v33 offset0:32 offset1:160
    s_lshl_b32 s32, s42, 8
    s_lshl_b32 s43, s41, 7
    s_add_u32 s44, s32, s43
    s_xor_b32 s43, s43, 128
    s_add_u32 s45, s32, s43
    v_lshlrev_b32 v34, 4, v26
    v_add_u32 v34, 135168, v34
    v_add_u32 v35, s45, v34
    v_add_u32 v34, s44, v34
    ds_read_b128 v[148:151], v34 offset:1024
    ds_read_b128 v[152:155], v34 offset:1056
    ds_read_b128 v[156:159], v34 offset:1088
    ds_read_b128 v[160:163], v34 offset:1120
    ds_read_b128 v[164:167], v35 offset:1024
    ds_read_b128 v[168:171], v35 offset:1056
    ds_read_b128 v[172:175], v35 offset:1088
    ds_read_b128 v[176:179], v35 offset:1120
    s_waitcnt lgkmcnt(8)
    v_mul_f32 v36, s52, v23
    v_mul_f32 v38, s52, v31
    s_waitcnt lgkmcnt(7)
    v_pk_fma_f32 v[64:65], v[148:149], v[22:23], v[64:65] op_sel_hi:[1,0,1] neg_lo:[0,1,0] neg_hi:[0,1,0]
    v_pk_fma_f32 v[66:67], v[150:151], v[22:23], v[66:67] op_sel_hi:[1,0,1] neg_lo:[0,1,0] neg_hi:[0,1,0]
    v_pk_mul_f32 v[64:65], v[64:65], v[36:37] op_sel_hi:[1,0]
    v_pk_mul_f32 v[66:67], v[66:67], v[36:37] op_sel_hi:[1,0]
    v_cvt_pk_bf16_f32 v64, v64, v65
    v_cvt_pk_bf16_f32 v65, v66, v67
    buffer_store_dwordx2 v[64:65], v140, s[12:15], s53 offen sc1
    v_pk_fma_f32 v[80:81], v[148:149], v[30:31], v[80:81] op_sel_hi:[1,0,1] neg_lo:[0,1,0] neg_hi:[0,1,0]
    v_pk_fma_f32 v[82:83], v[150:151], v[30:31], v[82:83] op_sel_hi:[1,0,1] neg_lo:[0,1,0] neg_hi:[0,1,0]
    v_pk_mul_f32 v[80:81], v[80:81], v[38:39] op_sel_hi:[1,0]
    v_pk_mul_f32 v[82:83], v[82:83], v[38:39] op_sel_hi:[1,0]
    v_cvt_pk_bf16_f32 v80, v80, v81
    v_cvt_pk_bf16_f32 v81, v82, v83
    buffer_store_dwordx2 v[80:81], v140, s[12:15], s54 offen sc1
    s_waitcnt lgkmcnt(6)
    v_pk_fma_f32 v[68:69], v[152:153], v[22:23], v[68:69] op_sel_hi:[1,0,1] neg_lo:[0,1,0] neg_hi:[0,1,0]
    v_pk_fma_f32 v[70:71], v[154:155], v[22:23], v[70:71] op_sel_hi:[1,0,1] neg_lo:[0,1,0] neg_hi:[0,1,0]
    v_pk_mul_f32 v[68:69], v[68:69], v[36:37] op_sel_hi:[1,0]
    v_pk_mul_f32 v[70:71], v[70:71], v[36:37] op_sel_hi:[1,0]
    v_cvt_pk_bf16_f32 v68, v68, v69
    v_cvt_pk_bf16_f32 v69, v70, v71
    buffer_store_dwordx2 v[68:69], v141, s[12:15], s53 offen sc1
    v_pk_fma_f32 v[84:85], v[152:153], v[30:31], v[84:85] op_sel_hi:[1,0,1] neg_lo:[0,1,0] neg_hi:[0,1,0]
    v_pk_fma_f32 v[86:87], v[154:155], v[30:31], v[86:87] op_sel_hi:[1,0,1] neg_lo:[0,1,0] neg_hi:[0,1,0]
    v_pk_mul_f32 v[84:85], v[84:85], v[38:39] op_sel_hi:[1,0]
    v_pk_mul_f32 v[86:87], v[86:87], v[38:39] op_sel_hi:[1,0]
    v_cvt_pk_bf16_f32 v84, v84, v85
    v_cvt_pk_bf16_f32 v85, v86, v87
    buffer_store_dwordx2 v[84:85], v141, s[12:15], s54 offen sc1
    s_waitcnt lgkmcnt(5)
    v_pk_fma_f32 v[72:73], v[156:157], v[22:23], v[72:73] op_sel_hi:[1,0,1] neg_lo:[0,1,0] neg_hi:[0,1,0]
    v_pk_fma_f32 v[74:75], v[158:159], v[22:23], v[74:75] op_sel_hi:[1,0,1] neg_lo:[0,1,0] neg_hi:[0,1,0]
    v_pk_mul_f32 v[72:73], v[72:73], v[36:37] op_sel_hi:[1,0]
    v_pk_mul_f32 v[74:75], v[74:75], v[36:37] op_sel_hi:[1,0]
    v_cvt_pk_bf16_f32 v72, v72, v73
    v_cvt_pk_bf16_f32 v73, v74, v75
    buffer_store_dwordx2 v[72:73], v142, s[12:15], s53 offen sc1
    v_pk_fma_f32 v[88:89], v[156:157], v[30:31], v[88:89] op_sel_hi:[1,0,1] neg_lo:[0,1,0] neg_hi:[0,1,0]
    v_pk_fma_f32 v[90:91], v[158:159], v[30:31], v[90:91] op_sel_hi:[1,0,1] neg_lo:[0,1,0] neg_hi:[0,1,0]
    v_pk_mul_f32 v[88:89], v[88:89], v[38:39] op_sel_hi:[1,0]
    v_pk_mul_f32 v[90:91], v[90:91], v[38:39] op_sel_hi:[1,0]
    v_cvt_pk_bf16_f32 v88, v88, v89
    v_cvt_pk_bf16_f32 v89, v90, v91
    buffer_store_dwordx2 v[88:89], v142, s[12:15], s54 offen sc1
    s_waitcnt lgkmcnt(4)
    v_pk_fma_f32 v[76:77], v[160:161], v[22:23], v[76:77] op_sel_hi:[1,0,1] neg_lo:[0,1,0] neg_hi:[0,1,0]
    v_pk_fma_f32 v[78:79], v[162:163], v[22:23], v[78:79] op_sel_hi:[1,0,1] neg_lo:[0,1,0] neg_hi:[0,1,0]
    v_pk_mul_f32 v[76:77], v[76:77], v[36:37] op_sel_hi:[1,0]
    v_pk_mul_f32 v[78:79], v[78:79], v[36:37] op_sel_hi:[1,0]
    v_cvt_pk_bf16_f32 v76, v76, v77
    v_cvt_pk_bf16_f32 v77, v78, v79
    buffer_store_dwordx2 v[76:77], v143, s[12:15], s53 offen sc1
    v_pk_fma_f32 v[92:93], v[160:161], v[30:31], v[92:93] op_sel_hi:[1,0,1] neg_lo:[0,1,0] neg_hi:[0,1,0]
    v_pk_fma_f32 v[94:95], v[162:163], v[30:31], v[94:95] op_sel_hi:[1,0,1] neg_lo:[0,1,0] neg_hi:[0,1,0]
    v_pk_mul_f32 v[92:93], v[92:93], v[38:39] op_sel_hi:[1,0]
    v_pk_mul_f32 v[94:95], v[94:95], v[38:39] op_sel_hi:[1,0]
    v_cvt_pk_bf16_f32 v92, v92, v93
    v_cvt_pk_bf16_f32 v93, v94, v95
    buffer_store_dwordx2 v[92:93], v143, s[12:15], s54 offen sc1
    s_waitcnt lgkmcnt(3)
    v_pk_fma_f32 v[96:97], v[164:165], v[22:23], v[96:97] op_sel_hi:[1,0,1] neg_lo:[0,1,0] neg_hi:[0,1,0]
    v_pk_fma_f32 v[98:99], v[166:167], v[22:23], v[98:99] op_sel_hi:[1,0,1] neg_lo:[0,1,0] neg_hi:[0,1,0]
    v_pk_mul_f32 v[96:97], v[96:97], v[36:37] op_sel_hi:[1,0]
    v_pk_mul_f32 v[98:99], v[98:99], v[36:37] op_sel_hi:[1,0]
    v_cvt_pk_bf16_f32 v96, v96, v97
    v_cvt_pk_bf16_f32 v97, v98, v99
    buffer_store_dwordx2 v[96:97], v144, s[12:15], s53 offen sc1
    v_pk_fma_f32 v[112:113], v[164:165], v[30:31], v[112:113] op_sel_hi:[1,0,1] neg_lo:[0,1,0] neg_hi:[0,1,0]
    v_pk_fma_f32 v[114:115], v[166:167], v[30:31], v[114:115] op_sel_hi:[1,0,1] neg_lo:[0,1,0] neg_hi:[0,1,0]
    v_pk_mul_f32 v[112:113], v[112:113], v[38:39] op_sel_hi:[1,0]
    v_pk_mul_f32 v[114:115], v[114:115], v[38:39] op_sel_hi:[1,0]
    v_cvt_pk_bf16_f32 v112, v112, v113
    v_cvt_pk_bf16_f32 v113, v114, v115
    buffer_store_dwordx2 v[112:113], v144, s[12:15], s54 offen sc1
    s_waitcnt lgkmcnt(2)
    v_pk_fma_f32 v[100:101], v[168:169], v[22:23], v[100:101] op_sel_hi:[1,0,1] neg_lo:[0,1,0] neg_hi:[0,1,0]
    v_pk_fma_f32 v[102:103], v[170:171], v[22:23], v[102:103] op_sel_hi:[1,0,1] neg_lo:[0,1,0] neg_hi:[0,1,0]
    v_pk_mul_f32 v[100:101], v[100:101], v[36:37] op_sel_hi:[1,0]
    v_pk_mul_f32 v[102:103], v[102:103], v[36:37] op_sel_hi:[1,0]
    v_cvt_pk_bf16_f32 v100, v100, v101
    v_cvt_pk_bf16_f32 v101, v102, v103
    buffer_store_dwordx2 v[100:101], v145, s[12:15], s53 offen sc1
    v_pk_fma_f32 v[116:117], v[168:169], v[30:31], v[116:117] op_sel_hi:[1,0,1] neg_lo:[0,1,0] neg_hi:[0,1,0]
    v_pk_fma_f32 v[118:119], v[170:171], v[30:31], v[118:119] op_sel_hi:[1,0,1] neg_lo:[0,1,0] neg_hi:[0,1,0]
    v_pk_mul_f32 v[116:117], v[116:117], v[38:39] op_sel_hi:[1,0]
    v_pk_mul_f32 v[118:119], v[118:119], v[38:39] op_sel_hi:[1,0]
    v_cvt_pk_bf16_f32 v116, v116, v117
    v_cvt_pk_bf16_f32 v117, v118, v119
    buffer_store_dwordx2 v[116:117], v145, s[12:15], s54 offen sc1
    s_waitcnt lgkmcnt(1)
    v_pk_fma_f32 v[104:105], v[172:173], v[22:23], v[104:105] op_sel_hi:[1,0,1] neg_lo:[0,1,0] neg_hi:[0,1,0]
    v_pk_fma_f32 v[106:107], v[174:175], v[22:23], v[106:107] op_sel_hi:[1,0,1] neg_lo:[0,1,0] neg_hi:[0,1,0]
    v_pk_mul_f32 v[104:105], v[104:105], v[36:37] op_sel_hi:[1,0]
    v_pk_mul_f32 v[106:107], v[106:107], v[36:37] op_sel_hi:[1,0]
    v_cvt_pk_bf16_f32 v104, v104, v105
    v_cvt_pk_bf16_f32 v105, v106, v107
    buffer_store_dwordx2 v[104:105], v146, s[12:15], s53 offen sc1
    v_pk_fma_f32 v[120:121], v[172:173], v[30:31], v[120:121] op_sel_hi:[1,0,1] neg_lo:[0,1,0] neg_hi:[0,1,0]
    v_pk_fma_f32 v[122:123], v[174:175], v[30:31], v[122:123] op_sel_hi:[1,0,1] neg_lo:[0,1,0] neg_hi:[0,1,0]
    v_pk_mul_f32 v[120:121], v[120:121], v[38:39] op_sel_hi:[1,0]
    v_pk_mul_f32 v[122:123], v[122:123], v[38:39] op_sel_hi:[1,0]
    v_cvt_pk_bf16_f32 v120, v120, v121
    v_cvt_pk_bf16_f32 v121, v122, v123
    buffer_store_dwordx2 v[120:121], v146, s[12:15], s54 offen sc1
    s_waitcnt lgkmcnt(0)
    v_pk_fma_f32 v[108:109], v[176:177], v[22:23], v[108:109] op_sel_hi:[1,0,1] neg_lo:[0,1,0] neg_hi:[0,1,0]
    v_pk_fma_f32 v[110:111], v[178:179], v[22:23], v[110:111] op_sel_hi:[1,0,1] neg_lo:[0,1,0] neg_hi:[0,1,0]
    v_pk_mul_f32 v[108:109], v[108:109], v[36:37] op_sel_hi:[1,0]
    v_pk_mul_f32 v[110:111], v[110:111], v[36:37] op_sel_hi:[1,0]
    v_cvt_pk_bf16_f32 v108, v108, v109
    v_cvt_pk_bf16_f32 v109, v110, v111
    buffer_store_dwordx2 v[108:109], v147, s[12:15], s53 offen sc1
    v_pk_fma_f32 v[124:125], v[176:177], v[30:31], v[124:125] op_sel_hi:[1,0,1] neg_lo:[0,1,0] neg_hi:[0,1,0]
    v_pk_fma_f32 v[126:127], v[178:179], v[30:31], v[126:127] op_sel_hi:[1,0,1] neg_lo:[0,1,0] neg_hi:[0,1,0]
    v_pk_mul_f32 v[124:125], v[124:125], v[38:39] op_sel_hi:[1,0]
    v_pk_mul_f32 v[126:127], v[126:127], v[38:39] op_sel_hi:[1,0]
    v_cvt_pk_bf16_f32 v124, v124, v125
    v_cvt_pk_bf16_f32 v125, v126, v127
    buffer_store_dwordx2 v[124:125], v147, s[12:15], s54 offen sc1
    s_branch Lone_comp
Lqkv_v:
    s_lshl_b32 s32, s46, 7
    s_lshl_b32 s43, s42, 6
    s_add_u32 s32, s32, s43
    s_lshl_b32 s43, s41, 5
    s_mov_b32 s49, 172032
    s_mov_b32 s50, 52429
    s_mov_b32 s51, -20
    v_mul_u32_u24 v30, 352, v26
    v_add_u32 v30, 1280, v30
    v_add_u32 v29, s32, v27
    v_add_u32 v32, s43, v29
    v_mul_u32_u24 v33, s50, v32
    v_lshrrev_b32 v33, 20, v33
    v_mad_i32_i24 v34, v33, s51, v32
    v_lshl_add_u32 v34, v34, 4, v30
    v_mad_u32_u24 v140, v33, s49, v34
    s_xor_b32 s43, s43, 32
    v_add_u32 v32, s43, v29
    v_mul_u32_u24 v33, s50, v32
    v_lshrrev_b32 v33, 20, v33
    v_mad_i32_i24 v34, v33, s51, v32
    v_lshl_add_u32 v34, v34, 4, v30
    v_mad_u32_u24 v141, v33, s49, v34
    s_mul_i32 s53, s48, 2688
    s_add_u32 s53, s53, 2621440
    s_add_u32 s54, s53, 2688
    s_barrier
    ds_read_b64_tr_b16 v[32:33], v128 offset:0
    ds_read_b64_tr_b16 v[34:35], v128 offset:256
    ds_read_b128 v[48:51], v130 offset:0
    ds_read_b128 v[52:55], v130 offset:4096
    ds_read_b64_tr_b16 v[36:37], v129 offset:0
    ds_read_b64_tr_b16 v[38:39], v129 offset:256
Lqkv_loopb:
    s_waitcnt lgkmcnt(3)
    v_mfma_f32_32x32x16_bf16 v[64:79], v[48:51], v[32:35], v[64:79]
    ds_read_b64_tr_b16 v[40:41], v128 offset:4352
    ds_read_b64_tr_b16 v[42:43], v128 offset:4608
    ds_read_b128 v[56:59], v131 offset:0
    s_waitcnt lgkmcnt(5)
    v_mfma_f32_32x32x16_bf16 v[80:95], v[52:55], v[32:35], v[80:95]
    ds_read_b128 v[60:63], v131 offset:4096
    ds_read_b64_tr_b16 v[44:45], v129 offset:4352
    ds_read_b64_tr_b16 v[46:47], v129 offset:4608
    v_mfma_f32_16x16x32_bf16 v[22:25], v[18:21], v[32:35], v[22:25]
    s_waitcnt lgkmcnt(6)
    v_mfma_f32_32x32x16_bf16 v[96:111], v[48:51], v[36:39], v[96:111]
    v_mfma_f32_32x32x16_bf16 v[112:127], v[52:55], v[36:39], v[112:127]
    s_waitcnt lgkmcnt(3)
    v_mfma_f32_32x32x16_bf16 v[64:79], v[56:59], v[40:43], v[64:79]
    ds_read_b64_tr_b16 v[32:33], v128 offset:8704
    ds_read_b64_tr_b16 v[34:35], v128 offset:8960
    ds_read_b128 v[48:51], v132 offset:0
    s_waitcnt lgkmcnt(5)
    v_mfma_f32_32x32x16_bf16 v[80:95], v[60:63], v[40:43], v[80:95]
    ds_read_b128 v[52:55], v132 offset:4096
    ds_read_b64_tr_b16 v[36:37], v129 offset:8704
    ds_read_b64_tr_b16 v[38:39], v129 offset:8960
    v_mfma_f32_16x16x32_bf16 v[22:25], v[18:21], v[40:43], v[22:25]
    s_waitcnt lgkmcnt(6)
    v_mfma_f32_32x32x16_bf16 v[96:111], v[56:59], v[44:47], v[96:111]
    v_mfma_f32_32x32x16_bf16 v[112:127], v[60:63], v[44:47], v[112:127]
    s_waitcnt lgkmcnt(3)
    v_mfma_f32_32x32x16_bf16 v[64:79], v[48:51], v[32:35], v[64:79]
    ds_read_b64_tr_b16 v[40:41], v128 offset:13056
    ds_read_b64_tr_b16 v[42:43], v128 offset:13312
    ds_read_b128 v[56:59], v133 offset:0
    s_waitcnt lgkmcnt(5)
    v_mfma_f32_32x32x16_bf16 v[80:95], v[52:55], v[32:35], v[80:95]
    ds_read_b128 v[60:63], v133 offset:4096
    ds_read_b64_tr_b16 v[44:45], v129 offset:13056
    ds_read_b64_tr_b16 v[46:47], v129 offset:13312
    v_mfma_f32_16x16x32_bf16 v[22:25], v[18:21], v[32:35], v[22:25]
    s_waitcnt lgkmcnt(6)
    v_mfma_f32_32x32x16_bf16 v[96:111], v[48:51], v[36:39], v[96:111]
    v_mfma_f32_32x32x16_bf16 v[112:127], v[52:55], v[36:39], v[112:127]
    s_waitcnt lgkmcnt(0)
    s_barrier
    v_add_u32 v128, s38, v12
    v_add_u32 v129, s38, v13
    v_add_u32 v130, s38, v14
    v_add_u32 v131, s38, v15
    v_add_u32 v132, s38, v16
    v_add_u32 v133, s38, v17
    v_mfma_f32_32x32x16_bf16 v[64:79], v[56:59], v[40:43], v[64:79]
    ds_read_b64_tr_b16 v[32:33], v128 offset:0
    ds_read_b64_tr_b16 v[34:35], v128 offset:256
    ds_read_b128 v[48:51], v130 offset:0
    v_mfma_f32_32x32x16_bf16 v[80:95], v[60:63], v[40:43], v[80:95]
    ds_read_b128 v[52:55], v130 offset:4096
    ds_read_b64_tr_b16 v[36:37], v129 offset:0
    ds_read_b64_tr_b16 v[38:39], v129 offset:256
    v_mfma_f32_16x16x32_bf16 v[22:25], v[18:21], v[40:43], v[22:25]
    v_mfma_f32_32x32x16_bf16 v[96:111], v[56:59], v[44:47], v[96:111]
    s_add_u32 s38, s38, 33792
    s_cmp_eq_u32 s38, 135168
    s_cselect_b32 s38, 0, s38
    s_add_u32 s37, s37, 1
    s_cmp_lt_u32 s37, 10
    v_mfma_f32_32x32x16_bf16 v[112:127], v[60:63], v[44:47], v[112:127]
    s_cbranch_scc1 Lqkv_loopb
    s_waitcnt lgkmcnt(0)
    v_and_b32 v32, 31, v2
    v_lshlrev_b32 v32, 2, v32
    s_lshl_b32 s32, s42, 8
    s_lshl_b32 s43, s41, 7
    s_add_u32 s32, s32, s43
    s_add_u32 s32, s32, 136192
    v_add_u32 v34, s32, v32
    s_mov_b64 exec, 0xffff
    s_nop 2
    ds_write2_b32 v34, v22, v23 offset0:0 offset1:16
    s_mov_b64 exec, -1
    s_waitcnt lgkmcnt(0)
    s_barrier
    s_lshl_b32 s32, s42, 8
    s_xor_b32 s43, s41, 1
    s_lshl_b32 s43, s43, 7
    s_add_u32 s32, s32, s43
    s_add_u32 s32, s32, 136192
    v_add_u32 v33, s32, v32
    ds_read_b32 v30, v33
    ds_read_b32 v24, v34
    s_lshl_b32 s32, s41, 8
    s_add_u32 s32, s32, 135168
    v_lshlrev_b32 v35, 4, v26
    v_add_u32 v35, s32, v35
    ds_read_b128 v[148:151], v35 offset:0
    ds_read_b128 v[152:155], v35 offset:512
    ds_read_b128 v[156:159], v35 offset:32
    ds_read_b128 v[160:163], v35 offset:544
    ds_read_b128 v[164:167], v35 offset:64
    ds_read_b128 v[168:171], v35 offset:576
    ds_read_b128 v[172:175], v35 offset:96
    ds_read_b128 v[176:179], v35 offset:608
    s_waitcnt lgkmcnt(4)
    ds_read_b128 v[180:183], v35 offset:128
    ds_read_b128 v[184:187], v35 offset:640
    ds_read_b128 v[188:191], v35 offset:160
    ds_read_b128 v[192:195], v35 offset:672
    ds_read_b128 v[196:199], v35 offset:192
    ds_read_b128 v[200:203], v35 offset:704
    ds_read_b128 v[204:207], v35 offset:224
    ds_read_b128 v[208:211], v35 offset:736
    s_waitcnt lgkmcnt(12)
    v_pk_fma_f32 v[64:65], v[148:149], v[24:25], v[64:65] op_sel_hi:[1,0,1] neg_lo:[0,1,0] neg_hi:[0,1,0]
    v_pk_fma_f32 v[66:67], v[150:151], v[24:25], v[66:67] op_sel_hi:[1,0,1] neg_lo:[0,1,0] neg_hi:[0,1,0]
    v_pk_mul_f32 v[64:65], v[64:65], v[152:153]
    v_pk_mul_f32 v[66:67], v[66:67], v[154:155]
    v_pk_fma_f32 v[68:69], v[156:157], v[24:25], v[68:69] op_sel_hi:[1,0,1] neg_lo:[0,1,0] neg_hi:[0,1,0]
    v_pk_fma_f32 v[70:71], v[158:159], v[24:25], v[70:71] op_sel_hi:[1,0,1] neg_lo:[0,1,0] neg_hi:[0,1,0]
    v_pk_mul_f32 v[68:69], v[68:69], v[160:161]
    v_pk_mul_f32 v[70:71], v[70:71], v[162:163]
    v_cvt_pk_bf16_f32 v64, v64, v65
    v_cvt_pk_bf16_f32 v65, v66, v67
    v_cvt_pk_bf16_f32 v66, v68, v69
    v_cvt_pk_bf16_f32 v67, v70, v71
    buffer_store_dwordx4 v[64:67], v140, s[12:15], s53 offen offset:0 sc1
    v_pk_fma_f32 v[96:97], v[148:149], v[30:31], v[96:97] op_sel_hi:[1,0,1] neg_lo:[0,1,0] neg_hi:[0,1,0]
    v_pk_fma_f32 v[98:99], v[150:151], v[30:31], v[98:99] op_sel_hi:[1,0,1] neg_lo:[0,1,0] neg_hi:[0,1,0]
    v_pk_mul_f32 v[96:97], v[96:97], v[152:153]
    v_pk_mul_f32 v[98:99], v[98:99], v[154:155]
    v_pk_fma_f32 v[100:101], v[156:157], v[30:31], v[100:101] op_sel_hi:[1,0,1] neg_lo:[0,1,0] neg_hi:[0,1,0]
    v_pk_fma_f32 v[102:103], v[158:159], v[30:31], v[102:103] op_sel_hi:[1,0,1] neg_lo:[0,1,0] neg_hi:[0,1,0]
    v_pk_mul_f32 v[100:101], v[100:101], v[160:161]
    v_pk_mul_f32 v[102:103], v[102:103], v[162:163]
    v_cvt_pk_bf16_f32 v96, v96, v97
    v_cvt_pk_bf16_f32 v97, v98, v99
    v_cvt_pk_bf16_f32 v98, v100, v101
    v_cvt_pk_bf16_f32 v99, v102, v103
    buffer_store_dwordx4 v[96:99], v141, s[12:15], s53 offen offset:0 sc1
    s_waitcnt lgkmcnt(8)
    v_pk_fma_f32 v[72:73], v[164:165], v[24:25], v[72:73] op_sel_hi:[1,0,1] neg_lo:[0,1,0] neg_hi:[0,1,0]
    v_pk_fma_f32 v[74:75], v[166:167], v[24:25], v[74:75] op_sel_hi:[1,0,1] neg_lo:[0,1,0] neg_hi:[0,1,0]
    v_pk_mul_f32 v[72:73], v[72:73], v[168:169]
    v_pk_mul_f32 v[74:75], v[74:75], v[170:171]
    v_pk_fma_f32 v[76:77], v[172:173], v[24:25], v[76:77] op_sel_hi:[1,0,1] neg_lo:[0,1,0] neg_hi:[0,1,0]
    v_pk_fma_f32 v[78:79], v[174:175], v[24:25], v[78:79] op_sel_hi:[1,0,1] neg_lo:[0,1,0] neg_hi:[0,1,0]
    v_pk_mul_f32 v[76:77], v[76:77], v[176:177]
    v_pk_mul_f32 v[78:79], v[78:79], v[178:179]
    v_cvt_pk_bf16_f32 v72, v72, v73
    v_cvt_pk_bf16_f32 v73, v74, v75
    v_cvt_pk_bf16_f32 v74, v76, v77
    v_cvt_pk_bf16_f32 v75, v78, v79
    buffer_store_dwordx4 v[72:75], v140, s[12:15], s53 offen offset:704 sc1
    v_pk_fma_f32 v[104:105], v[164:165], v[30:31], v[104:105] op_sel_hi:[1,0,1] neg_lo:[0,1,0] neg_hi:[0,1,0]
    v_pk_fma_f32 v[106:107], v[166:167], v[30:31], v[106:107] op_sel_hi:[1,0,1] neg_lo:[0,1,0] neg_hi:[0,1,0]
    v_pk_mul_f32 v[104:105], v[104:105], v[168:169]
    v_pk_mul_f32 v[106:107], v[106:107], v[170:171]
    v_pk_fma_f32 v[108:109], v[172:173], v[30:31], v[108:109] op_sel_hi:[1,0,1] neg_lo:[0,1,0] neg_hi:[0,1,0]
    v_pk_fma_f32 v[110:111], v[174:175], v[30:31], v[110:111] op_sel_hi:[1,0,1] neg_lo:[0,1,0] neg_hi:[0,1,0]
    v_pk_mul_f32 v[108:109], v[108:109], v[176:177]
    v_pk_mul_f32 v[110:111], v[110:111], v[178:179]
    v_cvt_pk_bf16_f32 v104, v104, v105
    v_cvt_pk_bf16_f32 v105, v106, v107
    v_cvt_pk_bf16_f32 v106, v108, v109
    v_cvt_pk_bf16_f32 v107, v110, v111
    buffer_store_dwordx4 v[104:107], v141, s[12:15], s53 offen offset:704 sc1
    s_waitcnt lgkmcnt(4)
    v_pk_fma_f32 v[80:81], v[180:181], v[24:25], v[80:81] op_sel_hi:[1,0,1] neg_lo:[0,1,0] neg_hi:[0,1,0]
    v_pk_fma_f32 v[82:83], v[182:183], v[24:25], v[82:83] op_sel_hi:[1,0,1] neg_lo:[0,1,0] neg_hi:[0,1,0]
    v_pk_mul_f32 v[80:81], v[80:81], v[184:185]
    v_pk_mul_f32 v[82:83], v[82:83], v[186:187]
    v_pk_fma_f32 v[84:85], v[188:189], v[24:25], v[84:85] op_sel_hi:[1,0,1] neg_lo:[0,1,0] neg_hi:[0,1,0]
    v_pk_fma_f32 v[86:87], v[190:191], v[24:25], v[86:87] op_sel_hi:[1,0,1] neg_lo:[0,1,0] neg_hi:[0,1,0]
    v_pk_mul_f32 v[84:85], v[84:85], v[192:193]
    v_pk_mul_f32 v[86:87], v[86:87], v[194:195]
    v_cvt_pk_bf16_f32 v80, v80, v81
    v_cvt_pk_bf16_f32 v81, v82, v83
    v_cvt_pk_bf16_f32 v82, v84, v85
    v_cvt_pk_bf16_f32 v83, v86, v87
    buffer_store_dwordx4 v[80:83], v140, s[12:15], s54 offen offset:0 sc1
    v_pk_fma_f32 v[112:113], v[180:181], v[30:31], v[112:113] op_sel_hi:[1,0,1] neg_lo:[0,1,0] neg_hi:[0,1,0]
    v_pk_fma_f32 v[114:115], v[182:183], v[30:31], v[114:115] op_sel_hi:[1,0,1] neg_lo:[0,1,0] neg_hi:[0,1,0]
    v_pk_mul_f32 v[112:113], v[112:113], v[184:185]
    v_pk_mul_f32 v[114:115], v[114:115], v[186:187]
    v_pk_fma_f32 v[116:117], v[188:189], v[30:31], v[116:117] op_sel_hi:[1,0,1] neg_lo:[0,1,0] neg_hi:[0,1,0]
    v_pk_fma_f32 v[118:119], v[190:191], v[30:31], v[118:119] op_sel_hi:[1,0,1] neg_lo:[0,1,0] neg_hi:[0,1,0]
    v_pk_mul_f32 v[116:117], v[116:117], v[192:193]
    v_pk_mul_f32 v[118:119], v[118:119], v[194:195]
    v_cvt_pk_bf16_f32 v112, v112, v113
    v_cvt_pk_bf16_f32 v113, v114, v115
    v_cvt_pk_bf16_f32 v114, v116, v117
    v_cvt_pk_bf16_f32 v115, v118, v119
    buffer_store_dwordx4 v[112:115], v141, s[12:15], s54 offen offset:0 sc1
    s_waitcnt lgkmcnt(0)
    v_pk_fma_f32 v[88:89], v[196:197], v[24:25], v[88:89] op_sel_hi:[1,0,1] neg_lo:[0,1,0] neg_hi:[0,1,0]
    v_pk_fma_f32 v[90:91], v[198:199], v[24:25], v[90:91] op_sel_hi:[1,0,1] neg_lo:[0,1,0] neg_hi:[0,1,0]
    v_pk_mul_f32 v[88:89], v[88:89], v[200:201]
    v_pk_mul_f32 v[90:91], v[90:91], v[202:203]
    v_pk_fma_f32 v[92:93], v[204:205], v[24:25], v[92:93] op_sel_hi:[1,0,1] neg_lo:[0,1,0] neg_hi:[0,1,0]
    v_pk_fma_f32 v[94:95], v[206:207], v[24:25], v[94:95] op_sel_hi:[1,0,1] neg_lo:[0,1,0] neg_hi:[0,1,0]
    v_pk_mul_f32 v[92:93], v[92:93], v[208:209]
    v_pk_mul_f32 v[94:95], v[94:95], v[210:211]
    v_cvt_pk_bf16_f32 v88, v88, v89
    v_cvt_pk_bf16_f32 v89, v90, v91
    v_cvt_pk_bf16_f32 v90, v92, v93
    v_cvt_pk_bf16_f32 v91, v94, v95
    buffer_store_dwordx4 v[88:91], v140, s[12:15], s54 offen offset:704 sc1
    v_pk_fma_f32 v[120:121], v[196:197], v[30:31], v[120:121] op_sel_hi:[1,0,1] neg_lo:[0,1,0] neg_hi:[0,1,0]
    v_pk_fma_f32 v[122:123], v[198:199], v[30:31], v[122:123] op_sel_hi:[1,0,1] neg_lo:[0,1,0] neg_hi:[0,1,0]
    v_pk_mul_f32 v[120:121], v[120:121], v[200:201]
    v_pk_mul_f32 v[122:123], v[122:123], v[202:203]
    v_pk_fma_f32 v[124:125], v[204:205], v[30:31], v[124:125] op_sel_hi:[1,0,1] neg_lo:[0,1,0] neg_hi:[0,1,0]
    v_pk_fma_f32 v[126:127], v[206:207], v[30:31], v[126:127] op_sel_hi:[1,0,1] neg_lo:[0,1,0] neg_hi:[0,1,0]
    v_pk_mul_f32 v[124:125], v[124:125], v[208:209]
    v_pk_mul_f32 v[126:127], v[126:127], v[210:211]
    v_cvt_pk_bf16_f32 v120, v120, v121
    v_cvt_pk_bf16_f32 v121, v122, v123
    v_cvt_pk_bf16_f32 v122, v124, v125
    v_cvt_pk_bf16_f32 v123, v126, v127
    buffer_store_dwordx4 v[120:123], v141, s[12:15], s54 offen offset:704 sc1
    s_branch Lone_comp
Lqkv_aux:
    v_bfe_u32 v10, v0, 2, 6
    v_mul_u32_u24 v10, 2688, v10
    v_and_b32 v11, 3, v0
    v_mul_u32_u24 v11, 352, v11
    v_lshrrev_b32 v12, 8, v0
    s_mov_b32 s34, 172032
    v_mul_lo_u32 v12, v12, s34
    v_add3_u32 v10, v10, v11, v12
    v_mov_b32 v4, 0x3f803f80
    v_mov_b32 v5, v4
    v_mov_b32 v6, v4
    v_mov_b32 v7, v4
    s_mul_i32 s32, s17, 344064
    s_add_u32 s32, s32, 2623040
    buffer_store_dwordx4 v[4:7], v10, s[12:15], s32 offen sc1
    v_mov_b32 v12, 0
    v_mov_b32 v13, 0
    v_mov_b32 v14, 0
    v_mov_b32 v15, 0
    buffer_store_dwordx4 v[12:15], v10, s[12:15], s32 offen offset:16 sc1
    s_lshl_b32 s32, s17, 11
    s_add_u32 s32, s32, 15073280
    v_lshlrev_b32 v10, 4, v0
    v_cmp_gt_u32 vcc, 128, v0
    s_and_saveexec_b64 s[44:45], vcc
    s_cbranch_execz Lqkv_aux2
    buffer_store_dwordx4 v[12:15], v10, s[12:15], s32 offen sc1
Lqkv_aux2:
    s_mov_b64 exec, s[44:45]
    s_mov_b32 s66, 127
    s_waitcnt vmcnt(0)
    s_barrier
    s_cmp_lg_u32 s16, 0
    s_cbranch_scc1 Lqkv_aux3
    v_mov_b32 v10, 4
    v_mov_b32 v11, 1
    s_mov_b64 exec, 1
    global_atomic_add v10, v11, s[24:25] sc1
    s_mov_b64 exec, -1
Lqkv_aux3:
    s_cmp_lt_u32 s16, 4
    s_cbranch_scc1 Lone_comp
    s_sub_u32 s16, s16, 4
    s_branch Lone_help
Lqkv_end:
    s_endpgm
Lone_comp:
    v_lshlrev_b32 v3, 4, v2
    s_lshl_b32 s17, s30, 2
    s_lshr_b32 s32, s31, 3
    s_add_u32 s17, s17, s32
    s_and_b32 s18, s31, 7
    s_mul_i32 s33, s17, 172032
    s_add_u32 s33, s33, 2621440
    s_mov_b32 s8, s68
    s_and_b32 s9, s69, 0xffff
    s_mov_b32 s10, 2621440
    s_mov_b32 s11, 0x20000
    v_and_b32 v7, 31, v2
    v_lshlrev_b32 v8, 3, v7
    s_lshl_b32 s34, s18, 2
    s_add_u32 s34, s34, s16
    s_lshl_b32 s34, s34, 1
    s_mul_i32 s35, s34, 1280
    s_mul_i32 s32, s17, 81920
    s_add_u32 s35, s35, s32
    s_add_u32 s35, s35, 0
    v_lshrrev_b32 v9, 5, v2
    v_cmp_gt_u32 vcc, 32, v2
    v_add_u32 v136, 1024, v8
    v_mov_b32 v12, 1600
    v_cndmask_b32 v136, v12, v136, vcc
    v_min_u32 v12, 21, v7
    v_mul_u32_u24 v137, 352, v9
    v_lshl_add_u32 v137, v12, 4, v137
    v_add_u32 v137, 1280, v137
    s_mov_b64 s[50:51], vcc
    s_mov_b32 s52, 10752
    s_mov_b32 s41, 0xffff0000
    s_mov_b32 s53, 0x07060302
    v_mov_b32 v4, v3
    v_mov_b32 v5, v136
    v_mov_b32 v6, v137
    v_mov_b32 v15, 156672
    s_mov_b32 s38, 0
    v_mov_b32 v64, 0
    v_mov_b32 v65, 0
    v_mov_b32 v66, 0
    v_mov_b32 v67, 0
    v_mov_b32 v68, 0
    v_mov_b32 v69, 0
    v_mov_b32 v70, 0
    v_mov_b32 v71, 0
    v_mov_b32 v72, 0
    v_mov_b32 v73, 0
    v_mov_b32 v74, 0
    v_mov_b32 v75, 0
    v_mov_b32 v76, 0
    v_mov_b32 v77, 0
    v_mov_b32 v78, 0
    v_mov_b32 v79, 0
    v_mov_b32 v80, 0
    v_mov_b32 v81, 0
    v_mov_b32 v82, 0
    v_mov_b32 v83, 0
    v_mov_b32 v84, 0
    v_mov_b32 v85, 0
    v_mov_b32 v86, 0
    v_mov_b32 v87, 0
    v_mov_b32 v88, 0
    v_mov_b32 v89, 0
    v_mov_b32 v90, 0
    v_mov_b32 v91, 0
    v_mov_b32 v92, 0
    v_mov_b32 v93, 0
    v_mov_b32 v94, 0
    v_mov_b32 v95, 0
    v_bfe_u32 v10, v2, 4, 1
    v_mul_u32_u24 v10, 20480, v10
    v_and_b32 v14, 15, v2
    v_lshl_add_u32 v10, v14, 4, v10
    s_lshl_b32 s46, s17, 9
    v_lshl_add_u32 v138, v9, 8, v10
    v_add_u32 v138, s46, v138
    s_lshr_b32 s46, s17, 1
    s_lshl_b32 s46, s46, 8
    s_and_b32 s47, s17, 1
    s_lshl_b32 s47, s47, 3
    s_add_u32 s46, s46, s47
    s_add_u32 s46, s46, 16384
    v_add_u32 v139, s46, v10
    s_mul_i32 s43, s34, 40960
    s_add_u32 s43, s43, 8650752
    s_add_u32 s44, s43, 40960
    s_mov_b32 s45, 0x7b800000
    s_cmp_lg_u32 s16, 0
    s_cbranch_scc1 Lone_c0
    v_mov_b32 v10, 4
    s_mov_b32 s57, 2097152
Lone_pz:
    global_load_dword v11, v10, s[24:25] sc1
    s_sub_u32 s57, s57, 1
    s_cbranch_scc1 Lone_c0
    s_waitcnt vmcnt(0)
    v_readfirstlane_b32 s58, v11
    s_cmp_lt_u32 s58, 16
    s_cbranch_scc1 Lone_pz
Lone_c0:
    s_waitcnt vmcnt(0)
    s_barrier
    s_cmp_lg_u32 s16, 0
    s_cbranch_scc1 Lone_c2
    s_lshl_b32 s32, s66, 8
    s_add_u32 s32, s32, 15073280
    v_mov_b32 v10, 0
    v_mov_b32 v11, 1
    s_mov_b64 exec, 1
    buffer_atomic_add v11, v10, s[12:15], s32 offen sc1
    s_mov_b64 exec, -1
Lone_c2:
    s_cmp_lg_u32 s16, 2
    s_cbranch_scc1 Lone_c3
    s_nop 0
    s_waitcnt vmcnt(0)
Lone_c3:
    s_cmp_lg_u32 s16, 1
    s_cbranch_scc1 Lone_c1
    s_mul_i32 s60, s17, 5
    s_lshr_b32 s61, s60, 5
    s_lshl_b32 s62, 1, s61
    s_add_u32 s60, s60, 4
    s_lshr_b32 s61, s60, 5
    s_lshl_b32 s61, 1, s61
    s_or_b32 s62, s62, s61
    s_mul_i32 s62, s62, 0x421
    s_mov_b32 s63, 0
    s_mov_b32 s57, 2097152
    s_mov_b32 s32, 15091712
    v_lshlrev_b32 v10, 8, v2
    s_mov_b64 exec, s[62:63]
Lone_pl:
    buffer_load_dword v11, v10, s[12:15], s32 offen sc1
    s_sub_u32 s57, s57, 1
    s_cbranch_scc1 Lone_pd
    s_waitcnt vmcnt(0)
    v_cmp_gt_u32 vcc, 16, v11
    s_cbranch_vccz Lone_pd
    s_sleep 2
    s_branch Lone_pl
Lone_pd:
    s_waitcnt vmcnt(0)
    s_mov_b64 exec, -1
Lone_c1:
    s_barrier
    buffer_load_dwordx4 v[108:111], v3, s[12:15], s33 offen sc1
    buffer_load_dwordx4 v[96:99], v3, s[12:15], s35 offen offset:0 sc1
    buffer_load_dwordx4 v[100:103], v3, s[12:15], s35 offen offset:1280 sc1
    buffer_load_dwordx2 v[116:117], v136, s[12:15], s33 offen sc1
    buffer_load_dwordx2 v[104:105], v8, s[12:15], s35 offen offset:1024 sc1
    buffer_load_dwordx2 v[106:107], v8, s[12:15], s35 offen offset:2304 sc1
    s_waitcnt vmcnt(3)
    v_mfma_f32_32x32x16_bf16 v[16:31], v[108:111], v[96:99], 0
    v_mfma_f32_32x32x16_bf16 v[32:47], v[108:111], v[100:103], 0
    s_waitcnt vmcnt(0)
    s_not_b64 exec, s[50:51]
    v_mov_b32 v104, 0
    v_mov_b32 v105, 0
    v_mov_b32 v106, 0
    v_mov_b32 v107, 0
    s_mov_b64 exec, -1
    s_nop 2
    v_mfma_f32_32x32x8_bf16 v[16:31], v[116:117], v[104:105], v[16:31]
    v_mfma_f32_32x32x8_bf16 v[32:47], v[116:117], v[106:107], v[32:47]
    s_nop 10
    v_max3_f32 v10, v16, v17, v18
    v_max3_f32 v10, v10, v19, v20
    v_max3_f32 v10, v10, v21, v22
    v_max3_f32 v10, v10, v23, v24
    v_max3_f32 v10, v10, v25, v26
    v_max3_f32 v10, v10, v27, v28
    v_max3_f32 v10, v10, v29, v30
    v_max_f32 v10, v10, v31
    v_max3_f32 v11, v32, v33, v34
    v_max3_f32 v11, v11, v35, v36
    v_max3_f32 v11, v11, v37, v38
    v_max3_f32 v11, v11, v39, v40
    v_max3_f32 v11, v11, v41, v42
    v_max3_f32 v11, v11, v43, v44
    v_max3_f32 v11, v11, v45, v46
    v_max_f32 v11, v11, v47
    v_mfma_f32_32x32x16_bf16 v[16:31], v[108:111], v[96:99], 0
    v_mov_b32 v12, v10
    s_nop 1
    v_permlane32_swap_b32 v10, v12
    v_max_f32 v10, v10, v12
    v_and_b32 v12, s41, v10
    v_sub_f32 v10, v10, v12
    v_and_b32 v13, s41, v10
    v_sub_f32 v10, v10, v13
    v_lshrrev_b32 v12, 16, v12
    v_or_b32 v12, v12, v13
    v_lshrrev_b32 v10, 16, v10
    s_not_b64 exec, s[50:51]
    v_xor_b32 v104, 0x80008000, v12
    v_xor_b32 v105, 0x8000, v10
    s_mov_b64 exec, -1
    v_mov_b32 v12, v11
    s_nop 1
    v_permlane32_swap_b32 v11, v12
    v_max_f32 v11, v11, v12
    v_and_b32 v12, s41, v11
    v_sub_f32 v11, v11, v12
    v_and_b32 v13, s41, v11
    v_sub_f32 v11, v11, v13
    v_lshrrev_b32 v12, 16, v12
    v_or_b32 v12, v12, v13
    v_lshrrev_b32 v11, 16, v11
    s_not_b64 exec, s[50:51]
    v_xor_b32 v106, 0x80008000, v12
    v_xor_b32 v107, 0x8000, v11
    s_mov_b64 exec, -1
    v_mfma_f32_32x32x8_bf16 v[16:31], v[116:117], v[104:105], v[16:31]
    s_nop 7
    s_barrier
    v_mov_b32 v56, 0
    v_mov_b32 v57, 0
    v_mov_b32 v58, 0
    v_mov_b32 v59, 0
    v_mov_b32 v60, 0
    v_mov_b32 v61, 0
    v_mov_b32 v62, 0
    v_mov_b32 v63, 0
    v_mov_b32 v124, 0
    v_mov_b32 v132, 0
    v_mov_b32 v125, 0
    v_mov_b32 v133, 0
    v_mov_b32 v126, 0
    v_mov_b32 v134, 0
    v_mov_b32 v127, 0
    v_mov_b32 v135, 0
    ds_read_b128 v[112:115], v4 offset:2688
    ds_read_b64 v[118:119], v5 offset:2688
    ds_read_b128 v[120:123], v6
    ds_read_b128 v[128:131], v6 offset:704
    s_mov_b32 s52, 43008
.p2align 6
Lat_loop:
    s_cmp_eq_u32 s38, 3
    s_cbranch_scc1 Lat_xd
Lat_rd:
    v_mfma_f32_32x32x16_bf16 v[32:47], v[108:111], v[100:103], 0
    v_exp_f32 v16, v16
    v_exp_f32 v17, v17
    v_exp_f32 v18, v18
    v_exp_f32 v19, v19
    v_cvt_pk_bf16_f32 v48, v16, v17
    v_cvt_pk_bf16_f32 v49, v18, v19
    v_mfma_f32_32x32x16_bf16 v[80:95], v[124:127], v[56:59], v[80:95]
    v_exp_f32 v20, v20
    v_exp_f32 v21, v21
    v_exp_f32 v22, v22
    v_exp_f32 v23, v23
    v_cvt_pk_bf16_f32 v50, v20, v21
    v_cvt_pk_bf16_f32 v51, v22, v23
    v_mfma_f32_32x32x8_bf16 v[32:47], v[116:117], v[106:107], v[32:47]
    v_exp_f32 v24, v24
    v_exp_f32 v25, v25
    v_exp_f32 v26, v26
    v_exp_f32 v27, v27
    v_cvt_pk_bf16_f32 v52, v24, v25
    v_cvt_pk_bf16_f32 v53, v26, v27
    v_mfma_f32_32x32x16_bf16 v[80:95], v[132:135], v[60:63], v[80:95]
    v_exp_f32 v28, v28
    v_exp_f32 v29, v29
    v_exp_f32 v30, v30
    v_exp_f32 v31, v31
    v_cvt_pk_bf16_f32 v54, v28, v29
    v_cvt_pk_bf16_f32 v55, v30, v31
    s_waitcnt lgkmcnt(0)
    v_mfma_f32_32x32x16_bf16 v[16:31], v[112:115], v[96:99], 0
    ds_read_b128 v[124:127], v6 offset:2688
    v_exp_f32 v32, v32
    v_exp_f32 v33, v33
    v_exp_f32 v34, v34
    v_exp_f32 v35, v35
    v_cvt_pk_bf16_f32 v56, v32, v33
    v_cvt_pk_bf16_f32 v57, v34, v35
    v_mfma_f32_32x32x16_bf16 v[64:79], v[120:123], v[48:51], v[64:79]
    ds_read_b128 v[132:135], v6 offset:3392
    v_exp_f32 v36, v36
    v_exp_f32 v37, v37
    v_exp_f32 v38, v38
    v_exp_f32 v39, v39
    v_cvt_pk_bf16_f32 v58, v36, v37
    v_cvt_pk_bf16_f32 v59, v38, v39
    v_mfma_f32_32x32x8_bf16 v[16:31], v[118:119], v[104:105], v[16:31]
    ds_read_b128 v[108:111], v4 offset:5376
    v_exp_f32 v40, v40
    v_exp_f32 v41, v41
    v_exp_f32 v42, v42
    v_exp_f32 v43, v43
    v_cvt_pk_bf16_f32 v60, v40, v41
    v_cvt_pk_bf16_f32 v61, v42, v43
    v_mfma_f32_32x32x16_bf16 v[64:79], v[128:131], v[52:55], v[64:79]
    ds_read_b64 v[116:117], v5 offset:5376
    v_exp_f32 v44, v44
    v_exp_f32 v45, v45
    v_exp_f32 v46, v46
    v_exp_f32 v47, v47
    v_cvt_pk_bf16_f32 v62, v44, v45
    v_cvt_pk_bf16_f32 v63, v46, v47
    v_mfma_f32_32x32x16_bf16 v[32:47], v[112:115], v[100:103], 0
    v_exp_f32 v16, v16
    v_exp_f32 v17, v17
    v_exp_f32 v18, v18
    v_exp_f32 v19, v19
    v_cvt_pk_bf16_f32 v48, v16, v17
    v_cvt_pk_bf16_f32 v49, v18, v19
    v_mfma_f32_32x32x16_bf16 v[80:95], v[120:123], v[56:59], v[80:95]
    v_exp_f32 v20, v20
    v_exp_f32 v21, v21
    v_exp_f32 v22, v22
    v_exp_f32 v23, v23
    v_cvt_pk_bf16_f32 v50, v20, v21
    v_cvt_pk_bf16_f32 v51, v22, v23
    v_mfma_f32_32x32x8_bf16 v[32:47], v[118:119], v[106:107], v[32:47]
    v_exp_f32 v24, v24
    v_exp_f32 v25, v25
    v_exp_f32 v26, v26
    v_exp_f32 v27, v27
    v_cvt_pk_bf16_f32 v52, v24, v25
    v_cvt_pk_bf16_f32 v53, v26, v27
    v_mfma_f32_32x32x16_bf16 v[80:95], v[128:131], v[60:63], v[80:95]
    v_exp_f32 v28, v28
    v_exp_f32 v29, v29
    v_exp_f32 v30, v30
    v_exp_f32 v31, v31
    v_cvt_pk_bf16_f32 v54, v28, v29
    v_cvt_pk_bf16_f32 v55, v30, v31
    s_waitcnt lgkmcnt(0)
    v_mfma_f32_32x32x16_bf16 v[16:31], v[108:111], v[96:99], 0
    ds_read_b128 v[120:123], v6 offset:5376
    v_exp_f32 v32, v32
    v_exp_f32 v33, v33
    v_exp_f32 v34, v34
    v_exp_f32 v35, v35
    v_cvt_pk_bf16_f32 v56, v32, v33
    v_cvt_pk_bf16_f32 v57, v34, v35
    v_mfma_f32_32x32x16_bf16 v[64:79], v[124:127], v[48:51], v[64:79]
    ds_read_b128 v[128:131], v6 offset:6080
    v_exp_f32 v36, v36
    v_exp_f32 v37, v37
    v_exp_f32 v38, v38
    v_exp_f32 v39, v39
    v_cvt_pk_bf16_f32 v58, v36, v37
    v_cvt_pk_bf16_f32 v59, v38, v39
    v_mfma_f32_32x32x8_bf16 v[16:31], v[116:117], v[104:105], v[16:31]
    ds_read_b128 v[112:115], v4 offset:8064
    v_exp_f32 v40, v40
    v_exp_f32 v41, v41
    v_exp_f32 v42, v42
    v_exp_f32 v43, v43
    v_cvt_pk_bf16_f32 v60, v40, v41
    v_cvt_pk_bf16_f32 v61, v42, v43
    v_mfma_f32_32x32x16_bf16 v[64:79], v[132:135], v[52:55], v[64:79]
    ds_read_b64 v[118:119], v5 offset:8064
    v_exp_f32 v44, v44
    v_exp_f32 v45, v45
    v_exp_f32 v46, v46
    v_exp_f32 v47, v47
    v_cvt_pk_bf16_f32 v62, v44, v45
    v_cvt_pk_bf16_f32 v63, v46, v47
    v_mfma_f32_32x32x16_bf16 v[32:47], v[108:111], v[100:103], 0
    v_exp_f32 v16, v16
    v_exp_f32 v17, v17
    v_exp_f32 v18, v18
    v_exp_f32 v19, v19
    v_cvt_pk_bf16_f32 v48, v16, v17
    v_cvt_pk_bf16_f32 v49, v18, v19
    v_mfma_f32_32x32x16_bf16 v[80:95], v[124:127], v[56:59], v[80:95]
    v_exp_f32 v20, v20
    v_exp_f32 v21, v21
    v_exp_f32 v22, v22
    v_exp_f32 v23, v23
    v_cvt_pk_bf16_f32 v50, v20, v21
    v_cvt_pk_bf16_f32 v51, v22, v23
    v_mfma_f32_32x32x8_bf16 v[32:47], v[116:117], v[106:107], v[32:47]
    v_exp_f32 v24, v24
    v_exp_f32 v25, v25
    v_exp_f32 v26, v26
    v_exp_f32 v27, v27
    v_cvt_pk_bf16_f32 v52, v24, v25
    v_cvt_pk_bf16_f32 v53, v26, v27
    v_mfma_f32_32x32x16_bf16 v[80:95], v[132:135], v[60:63], v[80:95]
    v_exp_f32 v28, v28
    v_exp_f32 v29, v29
    v_exp_f32 v30, v30
    v_exp_f32 v31, v31
    v_cvt_pk_bf16_f32 v54, v28, v29
    v_cvt_pk_bf16_f32 v55, v30, v31
    s_waitcnt lgkmcnt(0)
    v_mfma_f32_32x32x16_bf16 v[16:31], v[112:115], v[96:99], 0
    ds_read_b128 v[124:127], v6 offset:8064
    v_exp_f32 v32, v32
    v_exp_f32 v33, v33
    v_exp_f32 v34, v34
    v_exp_f32 v35, v35
    v_cvt_pk_bf16_f32 v56, v32, v33
    v_cvt_pk_bf16_f32 v57, v34, v35
    v_mfma_f32_32x32x16_bf16 v[64:79], v[120:123], v[48:51], v[64:79]
    ds_read_b128 v[132:135], v6 offset:8768
    v_exp_f32 v36, v36
    v_exp_f32 v37, v37
    v_exp_f32 v38, v38
    v_exp_f32 v39, v39
    v_cvt_pk_bf16_f32 v58, v36, v37
    v_cvt_pk_bf16_f32 v59, v38, v39
    v_mfma_f32_32x32x8_bf16 v[16:31], v[118:119], v[104:105], v[16:31]
    ds_read_b128 v[108:111], v4 offset:10752
    v_exp_f32 v40, v40
    v_exp_f32 v41, v41
    v_exp_f32 v42, v42
    v_exp_f32 v43, v43
    v_cvt_pk_bf16_f32 v60, v40, v41
    v_cvt_pk_bf16_f32 v61, v42, v43
    v_mfma_f32_32x32x16_bf16 v[64:79], v[128:131], v[52:55], v[64:79]
    ds_read_b64 v[116:117], v5 offset:10752
    v_exp_f32 v44, v44
    v_exp_f32 v45, v45
    v_exp_f32 v46, v46
    v_exp_f32 v47, v47
    v_cvt_pk_bf16_f32 v62, v44, v45
    v_cvt_pk_bf16_f32 v63, v46, v47
    s_cmp_eq_u32 s38, 1
    s_cbranch_scc1 Lat_xc
Lat_rc:
    v_mfma_f32_32x32x16_bf16 v[32:47], v[112:115], v[100:103], 0
    v_exp_f32 v16, v16
    v_exp_f32 v17, v17
    v_exp_f32 v18, v18
    v_exp_f32 v19, v19
    v_cvt_pk_bf16_f32 v48, v16, v17
    v_cvt_pk_bf16_f32 v49, v18, v19
    v_mfma_f32_32x32x16_bf16 v[80:95], v[120:123], v[56:59], v[80:95]
    v_exp_f32 v20, v20
    v_exp_f32 v21, v21
    v_exp_f32 v22, v22
    v_exp_f32 v23, v23
    v_cvt_pk_bf16_f32 v50, v20, v21
    v_cvt_pk_bf16_f32 v51, v22, v23
    v_mfma_f32_32x32x8_bf16 v[32:47], v[118:119], v[106:107], v[32:47]
    v_exp_f32 v24, v24
    v_exp_f32 v25, v25
    v_exp_f32 v26, v26
    v_exp_f32 v27, v27
    v_cvt_pk_bf16_f32 v52, v24, v25
    v_cvt_pk_bf16_f32 v53, v26, v27
    v_mfma_f32_32x32x16_bf16 v[80:95], v[128:131], v[60:63], v[80:95]
    v_exp_f32 v28, v28
    v_exp_f32 v29, v29
    v_exp_f32 v30, v30
    v_exp_f32 v31, v31
    v_cvt_pk_bf16_f32 v54, v28, v29
    v_cvt_pk_bf16_f32 v55, v30, v31
    s_waitcnt lgkmcnt(0)
    v_mfma_f32_32x32x16_bf16 v[16:31], v[108:111], v[96:99], 0
    ds_read_b128 v[120:123], v6 offset:10752
    v_exp_f32 v32, v32
    v_exp_f32 v33, v33
    v_exp_f32 v34, v34
    v_exp_f32 v35, v35
    v_cvt_pk_bf16_f32 v56, v32, v33
    v_cvt_pk_bf16_f32 v57, v34, v35
    v_mfma_f32_32x32x16_bf16 v[64:79], v[124:127], v[48:51], v[64:79]
    ds_read_b128 v[128:131], v6 offset:11456
    v_exp_f32 v36, v36
    v_exp_f32 v37, v37
    v_exp_f32 v38, v38
    v_exp_f32 v39, v39
    v_cvt_pk_bf16_f32 v58, v36, v37
    v_cvt_pk_bf16_f32 v59, v38, v39
    v_mfma_f32_32x32x8_bf16 v[16:31], v[116:117], v[104:105], v[16:31]
    ds_read_b128 v[112:115], v4 offset:13440
    v_exp_f32 v40, v40
    v_exp_f32 v41, v41
    v_exp_f32 v42, v42
    v_exp_f32 v43, v43
    v_cvt_pk_bf16_f32 v60, v40, v41
    v_cvt_pk_bf16_f32 v61, v42, v43
    v_mfma_f32_32x32x16_bf16 v[64:79], v[132:135], v[52:55], v[64:79]
    ds_read_b64 v[118:119], v5 offset:13440
    v_exp_f32 v44, v44
    v_exp_f32 v45, v45
    v_exp_f32 v46, v46
    v_exp_f32 v47, v47
    v_cvt_pk_bf16_f32 v62, v44, v45
    v_cvt_pk_bf16_f32 v63, v46, v47
    s_cmp_eq_u32 s38, 0
    s_cbranch_scc1 Lat_xb
Lat_rb:
    v_mfma_f32_32x32x16_bf16 v[32:47], v[108:111], v[100:103], 0
    v_exp_f32 v16, v16
    v_exp_f32 v17, v17
    v_exp_f32 v18, v18
    v_exp_f32 v19, v19
    v_cvt_pk_bf16_f32 v48, v16, v17
    v_cvt_pk_bf16_f32 v49, v18, v19
    v_mfma_f32_32x32x16_bf16 v[80:95], v[124:127], v[56:59], v[80:95]
    v_exp_f32 v20, v20
    v_exp_f32 v21, v21
    v_exp_f32 v22, v22
    v_exp_f32 v23, v23
    v_cvt_pk_bf16_f32 v50, v20, v21
    v_cvt_pk_bf16_f32 v51, v22, v23
    v_mfma_f32_32x32x8_bf16 v[32:47], v[116:117], v[106:107], v[32:47]
    v_exp_f32 v24, v24
    v_exp_f32 v25, v25
    v_exp_f32 v26, v26
    v_exp_f32 v27, v27
    v_cvt_pk_bf16_f32 v52, v24, v25
    v_cvt_pk_bf16_f32 v53, v26, v27
    v_mfma_f32_32x32x16_bf16 v[80:95], v[132:135], v[60:63], v[80:95]
    v_exp_f32 v28, v28
    v_exp_f32 v29, v29
    v_exp_f32 v30, v30
    v_exp_f32 v31, v31
    v_cvt_pk_bf16_f32 v54, v28, v29
    v_cvt_pk_bf16_f32 v55, v30, v31
    s_waitcnt lgkmcnt(0)
    v_mfma_f32_32x32x16_bf16 v[16:31], v[112:115], v[96:99], 0
    ds_read_b128 v[124:127], v6 offset:13440
    v_exp_f32 v32, v32
    v_exp_f32 v33, v33
    v_exp_f32 v34, v34
    v_exp_f32 v35, v35
    v_cvt_pk_bf16_f32 v56, v32, v33
    v_cvt_pk_bf16_f32 v57, v34, v35
    v_mfma_f32_32x32x16_bf16 v[64:79], v[120:123], v[48:51], v[64:79]
    ds_read_b128 v[132:135], v6 offset:14144
    v_exp_f32 v36, v36
    v_exp_f32 v37, v37
    v_exp_f32 v38, v38
    v_exp_f32 v39, v39
    v_cvt_pk_bf16_f32 v58, v36, v37
    v_cvt_pk_bf16_f32 v59, v38, v39
    v_mfma_f32_32x32x8_bf16 v[16:31], v[118:119], v[104:105], v[16:31]
    ds_read_b128 v[108:111], v4 offset:16128
    v_exp_f32 v40, v40
    v_exp_f32 v41, v41
    v_exp_f32 v42, v42
    v_exp_f32 v43, v43
    v_cvt_pk_bf16_f32 v60, v40, v41
    v_cvt_pk_bf16_f32 v61, v42, v43
    v_mfma_f32_32x32x16_bf16 v[64:79], v[128:131], v[52:55], v[64:79]
    ds_read_b64 v[116:117], v5 offset:16128
    v_exp_f32 v44, v44
    v_exp_f32 v45, v45
    v_exp_f32 v46, v46
    v_exp_f32 v47, v47
    v_cvt_pk_bf16_f32 v62, v44, v45
    v_cvt_pk_bf16_f32 v63, v46, v47
    v_mfma_f32_32x32x16_bf16 v[32:47], v[112:115], v[100:103], 0
    v_exp_f32 v16, v16
    v_exp_f32 v17, v17
    v_exp_f32 v18, v18
    v_exp_f32 v19, v19
    v_cvt_pk_bf16_f32 v48, v16, v17
    v_cvt_pk_bf16_f32 v49, v18, v19
    v_mfma_f32_32x32x16_bf16 v[80:95], v[120:123], v[56:59], v[80:95]
    v_exp_f32 v20, v20
    v_exp_f32 v21, v21
    v_exp_f32 v22, v22
    v_exp_f32 v23, v23
    v_cvt_pk_bf16_f32 v50, v20, v21
    v_cvt_pk_bf16_f32 v51, v22, v23
    v_mfma_f32_32x32x8_bf16 v[32:47], v[118:119], v[106:107], v[32:47]
    v_exp_f32 v24, v24
    v_exp_f32 v25, v25
    v_exp_f32 v26, v26
    v_exp_f32 v27, v27
    v_cvt_pk_bf16_f32 v52, v24, v25
    v_cvt_pk_bf16_f32 v53, v26, v27
    v_mfma_f32_32x32x16_bf16 v[80:95], v[128:131], v[60:63], v[80:95]
    v_exp_f32 v28, v28
    v_exp_f32 v29, v29
    v_exp_f32 v30, v30
    v_exp_f32 v31, v31
    v_cvt_pk_bf16_f32 v54, v28, v29
    v_cvt_pk_bf16_f32 v55, v30, v31
    s_waitcnt lgkmcnt(0)
    v_mfma_f32_32x32x16_bf16 v[16:31], v[108:111], v[96:99], 0
    ds_read_b128 v[120:123], v6 offset:16128
    v_exp_f32 v32, v32
    v_exp_f32 v33, v33
    v_exp_f32 v34, v34
    v_exp_f32 v35, v35
    v_cvt_pk_bf16_f32 v56, v32, v33
    v_cvt_pk_bf16_f32 v57, v34, v35
    v_mfma_f32_32x32x16_bf16 v[64:79], v[124:127], v[48:51], v[64:79]
    ds_read_b128 v[128:131], v6 offset:16832
    v_exp_f32 v36, v36
    v_exp_f32 v37, v37
    v_exp_f32 v38, v38
    v_exp_f32 v39, v39
    v_cvt_pk_bf16_f32 v58, v36, v37
    v_cvt_pk_bf16_f32 v59, v38, v39
    v_mfma_f32_32x32x8_bf16 v[16:31], v[116:117], v[104:105], v[16:31]
    ds_read_b128 v[112:115], v4 offset:18816
    v_exp_f32 v40, v40
    v_exp_f32 v41, v41
    v_exp_f32 v42, v42
    v_exp_f32 v43, v43
    v_cvt_pk_bf16_f32 v60, v40, v41
    v_cvt_pk_bf16_f32 v61, v42, v43
    v_mfma_f32_32x32x16_bf16 v[64:79], v[132:135], v[52:55], v[64:79]
    ds_read_b64 v[118:119], v5 offset:18816
    v_exp_f32 v44, v44
    v_exp_f32 v45, v45
    v_exp_f32 v46, v46
    v_exp_f32 v47, v47
    v_cvt_pk_bf16_f32 v62, v44, v45
    v_cvt_pk_bf16_f32 v63, v46, v47
    v_mfma_f32_32x32x16_bf16 v[32:47], v[108:111], v[100:103], 0
    v_exp_f32 v16, v16
    v_exp_f32 v17, v17
    v_exp_f32 v18, v18
    v_exp_f32 v19, v19
    v_cvt_pk_bf16_f32 v48, v16, v17
    v_cvt_pk_bf16_f32 v49, v18, v19
    v_mfma_f32_32x32x16_bf16 v[80:95], v[124:127], v[56:59], v[80:95]
    v_exp_f32 v20, v20
    v_exp_f32 v21, v21
    v_exp_f32 v22, v22
    v_exp_f32 v23, v23
    v_cvt_pk_bf16_f32 v50, v20, v21
    v_cvt_pk_bf16_f32 v51, v22, v23
    v_mfma_f32_32x32x8_bf16 v[32:47], v[116:117], v[106:107], v[32:47]
    v_exp_f32 v24, v24
    v_exp_f32 v25, v25
    v_exp_f32 v26, v26
    v_exp_f32 v27, v27
    v_cvt_pk_bf16_f32 v52, v24, v25
    v_cvt_pk_bf16_f32 v53, v26, v27
    v_mfma_f32_32x32x16_bf16 v[80:95], v[132:135], v[60:63], v[80:95]
    v_exp_f32 v28, v28
    v_exp_f32 v29, v29
    v_exp_f32 v30, v30
    v_exp_f32 v31, v31
    v_cvt_pk_bf16_f32 v54, v28, v29
    v_cvt_pk_bf16_f32 v55, v30, v31
    s_waitcnt lgkmcnt(0)
    v_mfma_f32_32x32x16_bf16 v[16:31], v[112:115], v[96:99], 0
    ds_read_b128 v[124:127], v6 offset:18816
    v_exp_f32 v32, v32
    v_exp_f32 v33, v33
    v_exp_f32 v34, v34
    v_exp_f32 v35, v35
    v_cvt_pk_bf16_f32 v56, v32, v33
    v_cvt_pk_bf16_f32 v57, v34, v35
    v_mfma_f32_32x32x16_bf16 v[64:79], v[120:123], v[48:51], v[64:79]
    ds_read_b128 v[132:135], v6 offset:19520
    v_exp_f32 v36, v36
    v_exp_f32 v37, v37
    v_exp_f32 v38, v38
    v_exp_f32 v39, v39
    v_cvt_pk_bf16_f32 v58, v36, v37
    v_cvt_pk_bf16_f32 v59, v38, v39
    v_mfma_f32_32x32x8_bf16 v[16:31], v[118:119], v[104:105], v[16:31]
    ds_read_b128 v[108:111], v4 offset:21504
    v_exp_f32 v40, v40
    v_exp_f32 v41, v41
    v_exp_f32 v42, v42
    v_exp_f32 v43, v43
    v_cvt_pk_bf16_f32 v60, v40, v41
    v_cvt_pk_bf16_f32 v61, v42, v43
    v_mfma_f32_32x32x16_bf16 v[64:79], v[128:131], v[52:55], v[64:79]
    ds_read_b64 v[116:117], v5 offset:21504
    v_exp_f32 v44, v44
    v_exp_f32 v45, v45
    v_exp_f32 v46, v46
    v_exp_f32 v47, v47
    v_cvt_pk_bf16_f32 v62, v44, v45
    v_cvt_pk_bf16_f32 v63, v46, v47
    v_mfma_f32_32x32x16_bf16 v[32:47], v[112:115], v[100:103], 0
    v_exp_f32 v16, v16
    v_exp_f32 v17, v17
    v_exp_f32 v18, v18
    v_exp_f32 v19, v19
    v_cvt_pk_bf16_f32 v48, v16, v17
    v_cvt_pk_bf16_f32 v49, v18, v19
    v_mfma_f32_32x32x16_bf16 v[80:95], v[120:123], v[56:59], v[80:95]
    v_exp_f32 v20, v20
    v_exp_f32 v21, v21
    v_exp_f32 v22, v22
    v_exp_f32 v23, v23
    v_cvt_pk_bf16_f32 v50, v20, v21
    v_cvt_pk_bf16_f32 v51, v22, v23
    v_mfma_f32_32x32x8_bf16 v[32:47], v[118:119], v[106:107], v[32:47]
    v_exp_f32 v24, v24
    v_exp_f32 v25, v25
    v_exp_f32 v26, v26
    v_exp_f32 v27, v27
    v_cvt_pk_bf16_f32 v52, v24, v25
    v_cvt_pk_bf16_f32 v53, v26, v27
    v_mfma_f32_32x32x16_bf16 v[80:95], v[128:131], v[60:63], v[80:95]
    v_exp_f32 v28, v28
    v_exp_f32 v29, v29
    v_exp_f32 v30, v30
    v_exp_f32 v31, v31
    v_cvt_pk_bf16_f32 v54, v28, v29
    v_cvt_pk_bf16_f32 v55, v30, v31
    s_waitcnt lgkmcnt(0)
    v_mfma_f32_32x32x16_bf16 v[16:31], v[108:111], v[96:99], 0
    ds_read_b128 v[120:123], v6 offset:21504
    v_exp_f32 v32, v32
    v_exp_f32 v33, v33
    v_exp_f32 v34, v34
    v_exp_f32 v35, v35
    v_cvt_pk_bf16_f32 v56, v32, v33
    v_cvt_pk_bf16_f32 v57, v34, v35
    v_mfma_f32_32x32x16_bf16 v[64:79], v[124:127], v[48:51], v[64:79]
    ds_read_b128 v[128:131], v6 offset:22208
    v_exp_f32 v36, v36
    v_exp_f32 v37, v37
    v_exp_f32 v38, v38
    v_exp_f32 v39, v39
    v_cvt_pk_bf16_f32 v58, v36, v37
    v_cvt_pk_bf16_f32 v59, v38, v39
    v_mfma_f32_32x32x8_bf16 v[16:31], v[116:117], v[104:105], v[16:31]
    ds_read_b128 v[112:115], v4 offset:24192
    v_exp_f32 v40, v40
    v_exp_f32 v41, v41
    v_exp_f32 v42, v42
    v_exp_f32 v43, v43
    v_cvt_pk_bf16_f32 v60, v40, v41
    v_cvt_pk_bf16_f32 v61, v42, v43
    v_mfma_f32_32x32x16_bf16 v[64:79], v[132:135], v[52:55], v[64:79]
    ds_read_b64 v[118:119], v5 offset:24192
    v_exp_f32 v44, v44
    v_exp_f32 v45, v45
    v_exp_f32 v46, v46
    v_exp_f32 v47, v47
    v_cvt_pk_bf16_f32 v62, v44, v45
    v_cvt_pk_bf16_f32 v63, v46, v47
    v_mfma_f32_32x32x16_bf16 v[32:47], v[108:111], v[100:103], 0
    v_exp_f32 v16, v16
    v_exp_f32 v17, v17
    v_exp_f32 v18, v18
    v_exp_f32 v19, v19
    v_cvt_pk_bf16_f32 v48, v16, v17
    v_cvt_pk_bf16_f32 v49, v18, v19
    v_mfma_f32_32x32x16_bf16 v[80:95], v[124:127], v[56:59], v[80:95]
    v_exp_f32 v20, v20
    v_exp_f32 v21, v21
    v_exp_f32 v22, v22
    v_exp_f32 v23, v23
    v_cvt_pk_bf16_f32 v50, v20, v21
    v_cvt_pk_bf16_f32 v51, v22, v23
    v_mfma_f32_32x32x8_bf16 v[32:47], v[116:117], v[106:107], v[32:47]
    v_exp_f32 v24, v24
    v_exp_f32 v25, v25
    v_exp_f32 v26, v26
    v_exp_f32 v27, v27
    v_cvt_pk_bf16_f32 v52, v24, v25
    v_cvt_pk_bf16_f32 v53, v26, v27
    v_mfma_f32_32x32x16_bf16 v[80:95], v[132:135], v[60:63], v[80:95]
    v_exp_f32 v28, v28
    v_exp_f32 v29, v29
    v_exp_f32 v30, v30
    v_exp_f32 v31, v31
    v_cvt_pk_bf16_f32 v54, v28, v29
    v_cvt_pk_bf16_f32 v55, v30, v31
    s_waitcnt lgkmcnt(0)
    v_mfma_f32_32x32x16_bf16 v[16:31], v[112:115], v[96:99], 0
    ds_read_b128 v[124:127], v6 offset:24192
    v_exp_f32 v32, v32
    v_exp_f32 v33, v33
    v_exp_f32 v34, v34
    v_exp_f32 v35, v35
    v_cvt_pk_bf16_f32 v56, v32, v33
    v_cvt_pk_bf16_f32 v57, v34, v35
    v_mfma_f32_32x32x16_bf16 v[64:79], v[120:123], v[48:51], v[64:79]
    ds_read_b128 v[132:135], v6 offset:24896
    v_exp_f32 v36, v36
    v_exp_f32 v37, v37
    v_exp_f32 v38, v38
    v_exp_f32 v39, v39
    v_cvt_pk_bf16_f32 v58, v36, v37
    v_cvt_pk_bf16_f32 v59, v38, v39
    v_mfma_f32_32x32x8_bf16 v[16:31], v[118:119], v[104:105], v[16:31]
    ds_read_b128 v[108:111], v4 offset:26880
    v_exp_f32 v40, v40
    v_exp_f32 v41, v41
    v_exp_f32 v42, v42
    v_exp_f32 v43, v43
    v_cvt_pk_bf16_f32 v60, v40, v41
    v_cvt_pk_bf16_f32 v61, v42, v43
    v_mfma_f32_32x32x16_bf16 v[64:79], v[128:131], v[52:55], v[64:79]
    ds_read_b64 v[116:117], v5 offset:26880
    v_exp_f32 v44, v44
    v_exp_f32 v45, v45
    v_exp_f32 v46, v46
    v_exp_f32 v47, v47
    v_cvt_pk_bf16_f32 v62, v44, v45
    v_cvt_pk_bf16_f32 v63, v46, v47
    v_mfma_f32_32x32x16_bf16 v[32:47], v[112:115], v[100:103], 0
    v_exp_f32 v16, v16
    v_exp_f32 v17, v17
    v_exp_f32 v18, v18
    v_exp_f32 v19, v19
    v_cvt_pk_bf16_f32 v48, v16, v17
    v_cvt_pk_bf16_f32 v49, v18, v19
    v_mfma_f32_32x32x16_bf16 v[80:95], v[120:123], v[56:59], v[80:95]
    v_exp_f32 v20, v20
    v_exp_f32 v21, v21
    v_exp_f32 v22, v22
    v_exp_f32 v23, v23
    v_cvt_pk_bf16_f32 v50, v20, v21
    v_cvt_pk_bf16_f32 v51, v22, v23
    v_mfma_f32_32x32x8_bf16 v[32:47], v[118:119], v[106:107], v[32:47]
    v_exp_f32 v24, v24
    v_exp_f32 v25, v25
    v_exp_f32 v26, v26
    v_exp_f32 v27, v27
    v_cvt_pk_bf16_f32 v52, v24, v25
    v_cvt_pk_bf16_f32 v53, v26, v27
    v_mfma_f32_32x32x16_bf16 v[80:95], v[128:131], v[60:63], v[80:95]
    v_exp_f32 v28, v28
    v_exp_f32 v29, v29
    v_exp_f32 v30, v30
    v_exp_f32 v31, v31
    v_cvt_pk_bf16_f32 v54, v28, v29
    v_cvt_pk_bf16_f32 v55, v30, v31
    s_waitcnt lgkmcnt(0)
    v_mfma_f32_32x32x16_bf16 v[16:31], v[108:111], v[96:99], 0
    ds_read_b128 v[120:123], v6 offset:26880
    v_exp_f32 v32, v32
    v_exp_f32 v33, v33
    v_exp_f32 v34, v34
    v_exp_f32 v35, v35
    v_cvt_pk_bf16_f32 v56, v32, v33
    v_cvt_pk_bf16_f32 v57, v34, v35
    v_mfma_f32_32x32x16_bf16 v[64:79], v[124:127], v[48:51], v[64:79]
    ds_read_b128 v[128:131], v6 offset:27584
    v_exp_f32 v36, v36
    v_exp_f32 v37, v37
    v_exp_f32 v38, v38
    v_exp_f32 v39, v39
    v_cvt_pk_bf16_f32 v58, v36, v37
    v_cvt_pk_bf16_f32 v59, v38, v39
    v_mfma_f32_32x32x8_bf16 v[16:31], v[116:117], v[104:105], v[16:31]
    ds_read_b128 v[112:115], v4 offset:29568
    v_exp_f32 v40, v40
    v_exp_f32 v41, v41
    v_exp_f32 v42, v42
    v_exp_f32 v43, v43
    v_cvt_pk_bf16_f32 v60, v40, v41
    v_cvt_pk_bf16_f32 v61, v42, v43
    v_mfma_f32_32x32x16_bf16 v[64:79], v[132:135], v[52:55], v[64:79]
    ds_read_b64 v[118:119], v5 offset:29568
    v_exp_f32 v44, v44
    v_exp_f32 v45, v45
    v_exp_f32 v46, v46
    v_exp_f32 v47, v47
    v_cvt_pk_bf16_f32 v62, v44, v45
    v_cvt_pk_bf16_f32 v63, v46, v47
    v_mfma_f32_32x32x16_bf16 v[32:47], v[108:111], v[100:103], 0
    v_exp_f32 v16, v16
    v_exp_f32 v17, v17
    v_exp_f32 v18, v18
    v_exp_f32 v19, v19
    v_cvt_pk_bf16_f32 v48, v16, v17
    v_cvt_pk_bf16_f32 v49, v18, v19
    v_mfma_f32_32x32x16_bf16 v[80:95], v[124:127], v[56:59], v[80:95]
    v_exp_f32 v20, v20
    v_exp_f32 v21, v21
    v_exp_f32 v22, v22
    v_exp_f32 v23, v23
    v_cvt_pk_bf16_f32 v50, v20, v21
    v_cvt_pk_bf16_f32 v51, v22, v23
    v_mfma_f32_32x32x8_bf16 v[32:47], v[116:117], v[106:107], v[32:47]
    v_exp_f32 v24, v24
    v_exp_f32 v25, v25
    v_exp_f32 v26, v26
    v_exp_f32 v27, v27
    v_cvt_pk_bf16_f32 v52, v24, v25
    v_cvt_pk_bf16_f32 v53, v26, v27
    v_mfma_f32_32x32x16_bf16 v[80:95], v[132:135], v[60:63], v[80:95]
    v_exp_f32 v28, v28
    v_exp_f32 v29, v29
    v_exp_f32 v30, v30
    v_exp_f32 v31, v31
    v_cvt_pk_bf16_f32 v54, v28, v29
    v_cvt_pk_bf16_f32 v55, v30, v31
    s_waitcnt lgkmcnt(0)
    v_mfma_f32_32x32x16_bf16 v[16:31], v[112:115], v[96:99], 0
    ds_read_b128 v[124:127], v6 offset:29568
    v_exp_f32 v32, v32
    v_exp_f32 v33, v33
    v_exp_f32 v34, v34
    v_exp_f32 v35, v35
    v_cvt_pk_bf16_f32 v56, v32, v33
    v_cvt_pk_bf16_f32 v57, v34, v35
    v_mfma_f32_32x32x16_bf16 v[64:79], v[120:123], v[48:51], v[64:79]
    ds_read_b128 v[132:135], v6 offset:30272
    v_exp_f32 v36, v36
    v_exp_f32 v37, v37
    v_exp_f32 v38, v38
    v_exp_f32 v39, v39
    v_cvt_pk_bf16_f32 v58, v36, v37
    v_cvt_pk_bf16_f32 v59, v38, v39
    v_mfma_f32_32x32x8_bf16 v[16:31], v[118:119], v[104:105], v[16:31]
    ds_read_b128 v[108:111], v4 offset:32256
    v_exp_f32 v40, v40
    v_exp_f32 v41, v41
    v_exp_f32 v42, v42
    v_exp_f32 v43, v43
    v_cvt_pk_bf16_f32 v60, v40, v41
    v_cvt_pk_bf16_f32 v61, v42, v43
    v_mfma_f32_32x32x16_bf16 v[64:79], v[128:131], v[52:55], v[64:79]
    ds_read_b64 v[116:117], v5 offset:32256
    v_exp_f32 v44, v44
    v_exp_f32 v45, v45
    v_exp_f32 v46, v46
    v_exp_f32 v47, v47
    v_cvt_pk_bf16_f32 v62, v44, v45
    v_cvt_pk_bf16_f32 v63, v46, v47
    v_mfma_f32_32x32x16_bf16 v[32:47], v[112:115], v[100:103], 0
    v_exp_f32 v16, v16
    v_exp_f32 v17, v17
    v_exp_f32 v18, v18
    v_exp_f32 v19, v19
    v_cvt_pk_bf16_f32 v48, v16, v17
    v_cvt_pk_bf16_f32 v49, v18, v19
    v_mfma_f32_32x32x16_bf16 v[80:95], v[120:123], v[56:59], v[80:95]
    v_exp_f32 v20, v20
    v_exp_f32 v21, v21
    v_exp_f32 v22, v22
    v_exp_f32 v23, v23
    v_cvt_pk_bf16_f32 v50, v20, v21
    v_cvt_pk_bf16_f32 v51, v22, v23
    v_mfma_f32_32x32x8_bf16 v[32:47], v[118:119], v[106:107], v[32:47]
    v_exp_f32 v24, v24
    v_exp_f32 v25, v25
    v_exp_f32 v26, v26
    v_exp_f32 v27, v27
    v_cvt_pk_bf16_f32 v52, v24, v25
    v_cvt_pk_bf16_f32 v53, v26, v27
    v_mfma_f32_32x32x16_bf16 v[80:95], v[128:131], v[60:63], v[80:95]
    v_exp_f32 v28, v28
    v_exp_f32 v29, v29
    v_exp_f32 v30, v30
    v_exp_f32 v31, v31
    v_cvt_pk_bf16_f32 v54, v28, v29
    v_cvt_pk_bf16_f32 v55, v30, v31
    s_waitcnt lgkmcnt(0)
    v_mfma_f32_32x32x16_bf16 v[16:31], v[108:111], v[96:99], 0
    ds_read_b128 v[120:123], v6 offset:32256
    v_exp_f32 v32, v32
    v_exp_f32 v33, v33
    v_exp_f32 v34, v34
    v_exp_f32 v35, v35
    v_cvt_pk_bf16_f32 v56, v32, v33
    v_cvt_pk_bf16_f32 v57, v34, v35
    v_mfma_f32_32x32x16_bf16 v[64:79], v[124:127], v[48:51], v[64:79]
    ds_read_b128 v[128:131], v6 offset:32960
    v_exp_f32 v36, v36
    v_exp_f32 v37, v37
    v_exp_f32 v38, v38
    v_exp_f32 v39, v39
    v_cvt_pk_bf16_f32 v58, v36, v37
    v_cvt_pk_bf16_f32 v59, v38, v39
    v_mfma_f32_32x32x8_bf16 v[16:31], v[116:117], v[104:105], v[16:31]
    ds_read_b128 v[112:115], v4 offset:34944
    v_exp_f32 v40, v40
    v_exp_f32 v41, v41
    v_exp_f32 v42, v42
    v_exp_f32 v43, v43
    v_cvt_pk_bf16_f32 v60, v40, v41
    v_cvt_pk_bf16_f32 v61, v42, v43
    v_mfma_f32_32x32x16_bf16 v[64:79], v[132:135], v[52:55], v[64:79]
    ds_read_b64 v[118:119], v5 offset:34944
    v_exp_f32 v44, v44
    v_exp_f32 v45, v45
    v_exp_f32 v46, v46
    v_exp_f32 v47, v47
    v_cvt_pk_bf16_f32 v62, v44, v45
    v_cvt_pk_bf16_f32 v63, v46, v47
    v_mfma_f32_32x32x16_bf16 v[32:47], v[108:111], v[100:103], 0
    v_exp_f32 v16, v16
    v_exp_f32 v17, v17
    v_exp_f32 v18, v18
    v_exp_f32 v19, v19
    v_cvt_pk_bf16_f32 v48, v16, v17
    v_cvt_pk_bf16_f32 v49, v18, v19
    v_mfma_f32_32x32x16_bf16 v[80:95], v[124:127], v[56:59], v[80:95]
    v_exp_f32 v20, v20
    v_exp_f32 v21, v21
    v_exp_f32 v22, v22
    v_exp_f32 v23, v23
    v_cvt_pk_bf16_f32 v50, v20, v21
    v_cvt_pk_bf16_f32 v51, v22, v23
    v_mfma_f32_32x32x8_bf16 v[32:47], v[116:117], v[106:107], v[32:47]
    v_exp_f32 v24, v24
    v_exp_f32 v25, v25
    v_exp_f32 v26, v26
    v_exp_f32 v27, v27
    v_cvt_pk_bf16_f32 v52, v24, v25
    v_cvt_pk_bf16_f32 v53, v26, v27
    v_mfma_f32_32x32x16_bf16 v[80:95], v[132:135], v[60:63], v[80:95]
    v_exp_f32 v28, v28
    v_exp_f32 v29, v29
    v_exp_f32 v30, v30
    v_exp_f32 v31, v31
    v_cvt_pk_bf16_f32 v54, v28, v29
    v_cvt_pk_bf16_f32 v55, v30, v31
    s_waitcnt lgkmcnt(0)
    v_mfma_f32_32x32x16_bf16 v[16:31], v[112:115], v[96:99], 0
    ds_read_b128 v[124:127], v6 offset:34944
    v_exp_f32 v32, v32
    v_exp_f32 v33, v33
    v_exp_f32 v34, v34
    v_exp_f32 v35, v35
    v_cvt_pk_bf16_f32 v56, v32, v33
    v_cvt_pk_bf16_f32 v57, v34, v35
    v_mfma_f32_32x32x16_bf16 v[64:79], v[120:123], v[48:51], v[64:79]
    ds_read_b128 v[132:135], v6 offset:35648
    v_exp_f32 v36, v36
    v_exp_f32 v37, v37
    v_exp_f32 v38, v38
    v_exp_f32 v39, v39
    v_cvt_pk_bf16_f32 v58, v36, v37
    v_cvt_pk_bf16_f32 v59, v38, v39
    v_mfma_f32_32x32x8_bf16 v[16:31], v[118:119], v[104:105], v[16:31]
    ds_read_b128 v[108:111], v4 offset:37632
    v_exp_f32 v40, v40
    v_exp_f32 v41, v41
    v_exp_f32 v42, v42
    v_exp_f32 v43, v43
    v_cvt_pk_bf16_f32 v60, v40, v41
    v_cvt_pk_bf16_f32 v61, v42, v43
    v_mfma_f32_32x32x16_bf16 v[64:79], v[128:131], v[52:55], v[64:79]
    ds_read_b64 v[116:117], v5 offset:37632
    v_exp_f32 v44, v44
    v_exp_f32 v45, v45
    v_exp_f32 v46, v46
    v_exp_f32 v47, v47
    v_cvt_pk_bf16_f32 v62, v44, v45
    v_cvt_pk_bf16_f32 v63, v46, v47
    v_mfma_f32_32x32x16_bf16 v[32:47], v[112:115], v[100:103], 0
    v_exp_f32 v16, v16
    v_exp_f32 v17, v17
    v_exp_f32 v18, v18
    v_exp_f32 v19, v19
    v_cvt_pk_bf16_f32 v48, v16, v17
    v_cvt_pk_bf16_f32 v49, v18, v19
    v_mfma_f32_32x32x16_bf16 v[80:95], v[120:123], v[56:59], v[80:95]
    v_exp_f32 v20, v20
    v_exp_f32 v21, v21
    v_exp_f32 v22, v22
    v_exp_f32 v23, v23
    v_cvt_pk_bf16_f32 v50, v20, v21
    v_cvt_pk_bf16_f32 v51, v22, v23
    v_mfma_f32_32x32x8_bf16 v[32:47], v[118:119], v[106:107], v[32:47]
    v_exp_f32 v24, v24
    v_exp_f32 v25, v25
    v_exp_f32 v26, v26
    v_exp_f32 v27, v27
    v_cvt_pk_bf16_f32 v52, v24, v25
    v_cvt_pk_bf16_f32 v53, v26, v27
    v_mfma_f32_32x32x16_bf16 v[80:95], v[128:131], v[60:63], v[80:95]
    v_exp_f32 v28, v28
    v_exp_f32 v29, v29
    v_exp_f32 v30, v30
    v_exp_f32 v31, v31
    v_cvt_pk_bf16_f32 v54, v28, v29
    v_cvt_pk_bf16_f32 v55, v30, v31
    s_waitcnt lgkmcnt(0)
    v_mfma_f32_32x32x16_bf16 v[16:31], v[108:111], v[96:99], 0
    ds_read_b128 v[120:123], v6 offset:37632
    v_exp_f32 v32, v32
    v_exp_f32 v33, v33
    v_exp_f32 v34, v34
    v_exp_f32 v35, v35
    v_cvt_pk_bf16_f32 v56, v32, v33
    v_cvt_pk_bf16_f32 v57, v34, v35
    v_mfma_f32_32x32x16_bf16 v[64:79], v[124:127], v[48:51], v[64:79]
    ds_read_b128 v[128:131], v6 offset:38336
    v_exp_f32 v36, v36
    v_exp_f32 v37, v37
    v_exp_f32 v38, v38
    v_exp_f32 v39, v39
    v_cvt_pk_bf16_f32 v58, v36, v37
    v_cvt_pk_bf16_f32 v59, v38, v39
    v_mfma_f32_32x32x8_bf16 v[16:31], v[116:117], v[104:105], v[16:31]
    ds_read_b128 v[112:115], v4 offset:40320
    v_exp_f32 v40, v40
    v_exp_f32 v41, v41
    v_exp_f32 v42, v42
    v_exp_f32 v43, v43
    v_cvt_pk_bf16_f32 v60, v40, v41
    v_cvt_pk_bf16_f32 v61, v42, v43
    v_mfma_f32_32x32x16_bf16 v[64:79], v[132:135], v[52:55], v[64:79]
    ds_read_b64 v[118:119], v5 offset:40320
    v_exp_f32 v44, v44
    v_exp_f32 v45, v45
    v_exp_f32 v46, v46
    v_exp_f32 v47, v47
    v_cvt_pk_bf16_f32 v62, v44, v45
    v_cvt_pk_bf16_f32 v63, v46, v47
    v_mfma_f32_32x32x16_bf16 v[32:47], v[108:111], v[100:103], 0
    v_exp_f32 v16, v16
    v_exp_f32 v17, v17
    v_exp_f32 v18, v18
    v_exp_f32 v19, v19
    v_cvt_pk_bf16_f32 v48, v16, v17
    v_cvt_pk_bf16_f32 v49, v18, v19
    v_mfma_f32_32x32x16_bf16 v[80:95], v[124:127], v[56:59], v[80:95]
    v_exp_f32 v20, v20
    v_exp_f32 v21, v21
    v_exp_f32 v22, v22
    v_exp_f32 v23, v23
    v_cvt_pk_bf16_f32 v50, v20, v21
    v_cvt_pk_bf16_f32 v51, v22, v23
    v_mfma_f32_32x32x8_bf16 v[32:47], v[116:117], v[106:107], v[32:47]
    v_exp_f32 v24, v24
    v_exp_f32 v25, v25
    v_exp_f32 v26, v26
    v_exp_f32 v27, v27
    v_cvt_pk_bf16_f32 v52, v24, v25
    v_cvt_pk_bf16_f32 v53, v26, v27
    v_mfma_f32_32x32x16_bf16 v[80:95], v[132:135], v[60:63], v[80:95]
    v_exp_f32 v28, v28
    v_exp_f32 v29, v29
    v_exp_f32 v30, v30
    v_exp_f32 v31, v31
    v_cvt_pk_bf16_f32 v54, v28, v29
    v_cvt_pk_bf16_f32 v55, v30, v31
    s_waitcnt lgkmcnt(0)
    v_mfma_f32_32x32x16_bf16 v[16:31], v[112:115], v[96:99], 0
    ds_read_b128 v[124:127], v6 offset:40320
    v_exp_f32 v32, v32
    v_exp_f32 v33, v33
    v_exp_f32 v34, v34
    v_exp_f32 v35, v35
    v_cvt_pk_bf16_f32 v56, v32, v33
    v_cvt_pk_bf16_f32 v57, v34, v35
    v_mfma_f32_32x32x16_bf16 v[64:79], v[120:123], v[48:51], v[64:79]
    ds_read_b128 v[132:135], v6 offset:41024
    v_exp_f32 v36, v36
    v_exp_f32 v37, v37
    v_exp_f32 v38, v38
    v_exp_f32 v39, v39
    v_cvt_pk_bf16_f32 v58, v36, v37
    v_cvt_pk_bf16_f32 v59, v38, v39
    v_mfma_f32_32x32x8_bf16 v[16:31], v[118:119], v[104:105], v[16:31]
    ds_read_b128 v[108:111], v4 offset:43008
    v_exp_f32 v40, v40
    v_exp_f32 v41, v41
    v_exp_f32 v42, v42
    v_exp_f32 v43, v43
    v_cvt_pk_bf16_f32 v60, v40, v41
    v_cvt_pk_bf16_f32 v61, v42, v43
    v_mfma_f32_32x32x16_bf16 v[64:79], v[128:131], v[52:55], v[64:79]
    ds_read_b64 v[116:117], v5 offset:43008
    v_exp_f32 v44, v44
    v_exp_f32 v45, v45
    v_exp_f32 v46, v46
    v_exp_f32 v47, v47
    v_cvt_pk_bf16_f32 v62, v44, v45
    v_cvt_pk_bf16_f32 v63, v46, v47
    v_mfma_f32_32x32x16_bf16 v[32:47], v[112:115], v[100:103], 0
    v_exp_f32 v16, v16
    v_exp_f32 v17, v17
    v_exp_f32 v18, v18
    v_exp_f32 v19, v19
    v_cvt_pk_bf16_f32 v48, v16, v17
    v_cvt_pk_bf16_f32 v49, v18, v19
    v_mfma_f32_32x32x16_bf16 v[80:95], v[120:123], v[56:59], v[80:95]
    s_cmp_eq_u32 s38, 2
    s_cselect_b32 s37, 4294881280, s52
    v_exp_f32 v20, v20
    v_exp_f32 v21, v21
    v_exp_f32 v22, v22
    v_exp_f32 v23, v23
    v_cvt_pk_bf16_f32 v50, v20, v21
    v_cvt_pk_bf16_f32 v51, v22, v23
    v_mfma_f32_32x32x8_bf16 v[32:47], v[118:119], v[106:107], v[32:47]
    s_add_u32 s38, s38, 1
    s_cmp_lt_u32 s38, 4
    v_exp_f32 v24, v24
    v_exp_f32 v25, v25
    v_exp_f32 v26, v26
    v_exp_f32 v27, v27
    v_cvt_pk_bf16_f32 v52, v24, v25
    v_cvt_pk_bf16_f32 v53, v26, v27
    v_mfma_f32_32x32x16_bf16 v[80:95], v[128:131], v[60:63], v[80:95]
    v_exp_f32 v28, v28
    v_exp_f32 v29, v29
    v_exp_f32 v30, v30
    v_exp_f32 v31, v31
    v_cvt_pk_bf16_f32 v54, v28, v29
    v_cvt_pk_bf16_f32 v55, v30, v31
    s_waitcnt lgkmcnt(0)
    v_mfma_f32_32x32x16_bf16 v[16:31], v[108:111], v[96:99], 0
    ds_read_b128 v[120:123], v6 offset:43008
    v_exp_f32 v32, v32
    v_exp_f32 v33, v33
    v_exp_f32 v34, v34
    v_exp_f32 v35, v35
    v_cvt_pk_bf16_f32 v56, v32, v33
    v_cvt_pk_bf16_f32 v57, v34, v35
    v_mfma_f32_32x32x16_bf16 v[64:79], v[124:127], v[48:51], v[64:79]
    ds_read_b128 v[128:131], v6 offset:43712
    v_exp_f32 v36, v36
    v_exp_f32 v37, v37
    v_exp_f32 v38, v38
    v_exp_f32 v39, v39
    v_cvt_pk_bf16_f32 v58, v36, v37
    v_cvt_pk_bf16_f32 v59, v38, v39
    v_mfma_f32_32x32x8_bf16 v[16:31], v[116:117], v[104:105], v[16:31]
    ds_read_b128 v[112:115], v4 offset:45696
    v_exp_f32 v40, v40
    v_exp_f32 v41, v41
    v_exp_f32 v42, v42
    v_exp_f32 v43, v43
    v_cvt_pk_bf16_f32 v60, v40, v41
    v_cvt_pk_bf16_f32 v61, v42, v43
    v_mfma_f32_32x32x16_bf16 v[64:79], v[132:135], v[52:55], v[64:79]
    ds_read_b64 v[118:119], v5 offset:45696
    v_add_u32 v4, s37, v4
    v_add_u32 v5, s37, v5
    v_add_u32 v6, s37, v6
    v_exp_f32 v44, v44
    v_exp_f32 v45, v45
    v_exp_f32 v46, v46
    v_exp_f32 v47, v47
    v_cvt_pk_bf16_f32 v62, v44, v45
    v_cvt_pk_bf16_f32 v63, v46, v47
    s_cbranch_scc1 Lat_loop
    s_nop 1
    v_mfma_f32_32x32x16_bf16 v[80:95], v[124:127], v[56:59], v[80:95]
    v_mfma_f32_32x32x16_bf16 v[80:95], v[132:135], v[60:63], v[80:95]
    s_waitcnt lgkmcnt(0)
    s_nop 1
    v_mul_f32 v14, 0, v64
    v_fmac_f32 v14, 0, v65
    v_fmac_f32 v14, 0, v66
    v_fmac_f32 v14, 0, v67
    v_fmac_f32 v14, 0, v68
    v_fmac_f32 v14, 0, v69
    v_fmac_f32 v14, 0, v70
    v_fmac_f32 v14, 0, v71
    v_fmac_f32 v14, 0, v72
    v_fmac_f32 v14, 0, v73
    v_fmac_f32 v14, 0, v74
    v_fmac_f32 v14, 0, v75
    s_nop 1
    v_fmac_f32 v14, 0, v80
    v_fmac_f32 v14, 0, v81
    v_fmac_f32 v14, 0, v82
    v_fmac_f32 v14, 0, v83
    v_fmac_f32 v14, 0, v84
    v_fmac_f32 v14, 0, v85
    v_fmac_f32 v14, 0, v86
    v_fmac_f32 v14, 0, v87
    v_fmac_f32 v14, 0, v88
    v_fmac_f32 v14, 0, v89
    v_fmac_f32 v14, 0, v90
    v_fmac_f32 v14, 0, v91
    v_max_f32 v13, v72, v88
    v_cmp_neq_f32 vcc, 0, v14
    v_cmp_nge_f32 s[46:47], s45, v13
    s_andn2_b64 s[46:47], s[46:47], s[50:51]
    s_or_b64 vcc, vcc, s[46:47]
    s_cbranch_vccnz Lat_slow
Lat_store:
    v_mov_b32 v12, v72
    v_mov_b32 v13, v72
    s_nop 1
    v_permlane32_swap_b32 v12, v13
    v_rcp_f32 v14, v13
    s_nop 0
    v_pk_mul_f32 v[64:65], v[64:65], v[14:15] op_sel_hi:[1,0]
    v_pk_mul_f32 v[66:67], v[66:67], v[14:15] op_sel_hi:[1,0]
    v_pk_mul_f32 v[68:69], v[68:69], v[14:15] op_sel_hi:[1,0]
    v_pk_mul_f32 v[70:71], v[70:71], v[14:15] op_sel_hi:[1,0]
    v_pk_mul_f32 v[72:73], v[72:73], v[14:15] op_sel_hi:[1,0]
    v_pk_mul_f32 v[74:75], v[74:75], v[14:15] op_sel_hi:[1,0]
    v_cvt_pk_bf16_f32 v64, v64, v65
    v_cvt_pk_bf16_f32 v65, v66, v67
    v_cvt_pk_bf16_f32 v66, v68, v69
    v_cvt_pk_bf16_f32 v67, v70, v71
    v_cvt_pk_bf16_f32 v68, v72, v73
    v_cvt_pk_bf16_f32 v69, v74, v75
    buffer_store_dwordx4 v[64:67], v138, s[12:15], s43 offen sc1
    s_mov_b64 exec, s[50:51]
    buffer_store_dwordx2 v[68:69], v139, s[12:15], s43 offen sc1
    s_mov_b64 exec, -1
    v_mov_b32 v12, v88
    v_mov_b32 v13, v88
    s_nop 1
    v_permlane32_swap_b32 v12, v13
    v_rcp_f32 v14, v13
    s_nop 0
    v_pk_mul_f32 v[80:81], v[80:81], v[14:15] op_sel_hi:[1,0]
    v_pk_mul_f32 v[82:83], v[82:83], v[14:15] op_sel_hi:[1,0]
    v_pk_mul_f32 v[84:85], v[84:85], v[14:15] op_sel_hi:[1,0]
    v_pk_mul_f32 v[86:87], v[86:87], v[14:15] op_sel_hi:[1,0]
    v_pk_mul_f32 v[88:89], v[88:89], v[14:15] op_sel_hi:[1,0]
    v_pk_mul_f32 v[90:91], v[90:91], v[14:15] op_sel_hi:[1,0]
    v_cvt_pk_bf16_f32 v80, v80, v81
    v_cvt_pk_bf16_f32 v81, v82, v83
    v_cvt_pk_bf16_f32 v82, v84, v85
    v_cvt_pk_bf16_f32 v83, v86, v87
    v_cvt_pk_bf16_f32 v84, v88, v89
    v_cvt_pk_bf16_f32 v85, v90, v91
    buffer_store_dwordx4 v[80:83], v138, s[12:15], s44 offen sc1
    s_mov_b64 exec, s[50:51]
    buffer_store_dwordx2 v[84:85], v139, s[12:15], s44 offen sc1
    s_mov_b64 exec, -1
    s_lshl_b32 s55, s18, 2
    s_add_u32 s55, s55, s16
    s_add_u32 s55, s55, 32
    s_and_b32 s17, s30, 3
    s_lshl_b32 s17, s17, 3
    s_and_b32 s32, s31, 7
    s_add_u32 s17, s17, s32
    s_lshr_b32 s18, s30, 2
    s_lshl_b32 s18, s18, 2
    s_lshr_b32 s33, s31, 3
    s_add_u32 s18, s18, s33
    s_and_b32 s19, s30, 1
    s_lshl_b32 s19, s19, 3
    s_add_u32 s19, s19, s32
    s_lshr_b32 s20, s30, 1
    s_lshl_b32 s20, s20, 2
    s_add_u32 s20, s20, s33
    s_lshr_b32 s21, s17, 1
    s_add_u32 s28, s19, 16
    s_add_u32 s29, s21, 16
    s_add_u32 s56, s17, 32
    v_add_u32 v7, 4096, v3
    s_mul_i32 s51, s16, 20480
    s_add_u32 s32, s16, 1
    s_and_b32 s52, s32, 3
    s_add_u32 s32, s16, 2
    s_and_b32 s53, s32, 3
    s_add_u32 s32, s16, 3
    s_and_b32 s54, s32, 3
    v_add_u32 v29, s51, v3
    s_mul_i32 s32, s52, 20480
    v_add_u32 v4, s32, v3
    s_mul_i32 s32, s53, 20480
    v_add_u32 v5, s32, v3
    s_mul_i32 s32, s54, 20480
    v_add_u32 v6, s32, v3
    s_mul_i32 s34, s18, 20
    s_add_u32 s34, s34, s16
    s_add_u32 s34, s34, 16
    s_mul_i32 s34, s34, 5120
    s_add_u32 s34, s34, 28835840
    s_mul_i32 s35, s17, 81920
    s_lshl_b32 s32, s16, 10
    s_add_u32 s35, s35, s32
    s_add_u32 s35, s35, 8650752
    s_mul_i32 s39, s18, 160
    v_lshrrev_b32 v10, 4, v2
    v_and_b32 v11, 15, v2
    v_lshrrev_b32 v12, 1, v10
    v_lshlrev_b32 v14, 8, v12
    v_lshl_add_u32 v14, v11, 4, v14
    v_and_b32 v12, 1, v10
    v_lshl_add_u32 v13, v12, 9, v14
    v_lshl_add_u32 v14, v12, 3, v14
    v_mul_u32_u24 v15, 160, v11
    v_lshl_add_u32 v15, v10, 3, v15
    s_mul_i32 s43, s16, 2560
    s_add_u32 s43, s43, 0
    v_add_u32 v15, s43, v15
    s_lshl_b32 s40, s17, 2
    s_add_u32 s40, s40, s16
    s_mul_i32 s40, s40, 20480
    s_mul_i32 s32, s18, 2560
    s_add_u32 s40, s40, s32
    s_add_u32 s40, s40, 11534336
    s_lshl_b32 s41, s17, 2
    s_add_u32 s41, s41, s16
    s_mul_i32 s41, s41, 20480
    s_add_u32 s41, s41, s39
    s_mov_b32 s33, 6554
    s_mul_i32 s32, s52, 15360
    s_add_u32 s32, s32, 0
    v_add_u32 v8, s32, v3
    s_mul_i32 s32, s53, 15360
    s_add_u32 s32, s32, 0
    v_add_u32 v30, s32, v3
    s_mul_i32 s32, s54, 15360
    s_add_u32 s32, s32, 0
    v_add_u32 v31, s32, v3
    s_mul_i32 s32, s16, 15360
    s_add_u32 s32, s32, 0
    v_add_u32 v9, s32, v3
    s_mul_i32 s32, s16, 20480
    s_add_u32 s32, s32, 54272
    v_add_u32 v1, s32, v3
    v_add_u32 v10, 0, v2
    v_mul_u32_u24 v11, s33, v10
    v_lshrrev_b32 v11, 16, v11
    v_mad_i32_i24 v10, v11, -10, v10
    v_mul_u32_u24 v11, 1280, v11
    v_lshl_add_u32 v26, v10, 4, v11
    v_add_u32 v10, 64, v2
    v_mul_u32_u24 v11, s33, v10
    v_lshrrev_b32 v11, 16, v11
    v_mad_i32_i24 v10, v11, -10, v10
    v_mul_u32_u24 v11, 1280, v11
    v_lshl_add_u32 v27, v10, 4, v11
    v_add_u32 v10, 128, v2
    v_mul_u32_u24 v11, s33, v10
    v_lshrrev_b32 v11, 16, v11
    v_mad_i32_i24 v10, v11, -10, v10
    v_mul_u32_u24 v11, 1280, v11
    v_lshl_add_u32 v28, v10, 4, v11
    s_waitcnt vmcnt(0)
    s_lshl_b32 s32, s55, 8
    s_add_u32 s32, s32, 15073280
    v_mov_b32 v10, 0
    v_mov_b32 v11, 1
    s_mov_b64 exec, 1
    buffer_atomic_add v11, v10, s[12:15], s32 offen sc1
    s_mov_b64 exec, -1
    s_cmp_lg_u32 s16, 1
    s_cbranch_scc1 Ltl_a1
    s_lshl_b32 s32, s56, 8
    s_add_u32 s32, s32, 15073280
    s_mov_b32 s57, 2097152
    v_mov_b32 v10, 0
Ltl_pz:
    buffer_load_dword v11, v10, s[12:15], s32 offen sc1
    s_sub_u32 s57, s57, 1
    s_cbranch_scc1 Ltl_pzd
    s_waitcnt vmcnt(0)
    v_readfirstlane_b32 s49, v11
    s_cmp_ge_u32 s49, 32
    s_cbranch_scc1 Ltl_pzd
    s_sleep 1
    s_branch Ltl_pz
Ltl_pzd:
    s_waitcnt vmcnt(0)
Ltl_a1:
    s_barrier
    s_mul_i32 s35, s17, 81920
    s_add_u32 s35, s35, 8650752
    v_add_u32 v1, 54272, v3
    v_add_u32 v4, 105472, v3
    buffer_load_dwordx4 v[32:35], v29, s[12:15], s35 offen offset:0 sc1
    buffer_load_dwordx4 v[36:39], v29, s[12:15], s35 offen offset:1024 sc1
    buffer_load_dwordx4 v[40:43], v29, s[12:15], s35 offen offset:2048 sc1
    buffer_load_dwordx4 v[44:47], v29, s[12:15], s35 offen offset:3072 sc1
    s_add_u32 s35, s35, 4096
    buffer_load_dwordx4 v[48:51], v29, s[12:15], s35 offen offset:0 sc1
    buffer_load_dwordx4 v[52:55], v29, s[12:15], s35 offen offset:1024 sc1
    buffer_load_dwordx4 v[56:59], v29, s[12:15], s35 offen offset:2048 sc1
    buffer_load_dwordx4 v[60:63], v29, s[12:15], s35 offen offset:3072 sc1
    s_add_u32 s35, s35, 4096
    buffer_load_dwordx4 v[64:67], v29, s[12:15], s35 offen offset:0 sc1
    buffer_load_dwordx4 v[68:71], v29, s[12:15], s35 offen offset:1024 sc1
    buffer_load_dwordx4 v[72:75], v29, s[12:15], s35 offen offset:2048 sc1
    buffer_load_dwordx4 v[76:79], v29, s[12:15], s35 offen offset:3072 sc1
    s_add_u32 s35, s35, 4096
    buffer_load_dwordx4 v[80:83], v29, s[12:15], s35 offen offset:0 sc1
    buffer_load_dwordx4 v[84:87], v29, s[12:15], s35 offen offset:1024 sc1
    buffer_load_dwordx4 v[88:91], v29, s[12:15], s35 offen offset:2048 sc1
    buffer_load_dwordx4 v[92:95], v29, s[12:15], s35 offen offset:3072 sc1
    s_add_u32 s35, s35, 4096
    buffer_load_dwordx4 v[96:99], v29, s[12:15], s35 offen offset:0 sc1
    buffer_load_dwordx4 v[100:103], v29, s[12:15], s35 offen offset:1024 sc1
    buffer_load_dwordx4 v[104:107], v29, s[12:15], s35 offen offset:2048 sc1
    buffer_load_dwordx4 v[108:111], v29, s[12:15], s35 offen offset:3072 sc1
    s_add_u32 s35, s35, 4096
    s_mov_b32 m0, s43
    s_nop 0
    buffer_load_dwordx4 v26, s[4:7], s41 offen lds
    s_add_u32 m0, s43, 1024
    s_nop 0
    buffer_load_dwordx4 v27, s[4:7], s41 offen lds
    s_add_u32 m0, s43, 2048
    s_mov_b64 exec, 0xffffffff
    buffer_load_dwordx4 v28, s[4:7], s41 offen lds
    s_mov_b64 exec, -1
    ds_read_b128 v[112:115], v1 offset:0
    ds_read_b128 v[116:119], v1 offset:1024
    ds_read_b128 v[120:123], v1 offset:2048
    ds_read_b128 v[124:127], v1 offset:3072
    ds_read_b128 v[128:131], v1 offset:4096
    ds_read_b128 v[132:135], v1 offset:5120
    ds_read_b128 v[136:139], v1 offset:6144
    ds_read_b128 v[140:143], v1 offset:7168
    ds_read_b128 v[144:147], v1 offset:8192
    ds_read_b128 v[148:151], v1 offset:9216
    s_waitcnt vmcnt(22) lgkmcnt(5)
    v_mfma_f32_16x16x32_bf16 v[176:179], v[112:115], v[32:35], 0
    ds_read_b128 v[152:155], v1 offset:10240
    v_mfma_f32_16x16x32_bf16 v[180:183], v[116:119], v[32:35], 0
    ds_read_b128 v[156:159], v1 offset:11264
    v_mfma_f32_16x16x32_bf16 v[184:187], v[120:123], v[32:35], 0
    ds_read_b128 v[160:163], v1 offset:12288
    v_mfma_f32_16x16x32_bf16 v[188:191], v[124:127], v[32:35], 0
    ds_read_b128 v[164:167], v1 offset:13312
    v_mfma_f32_16x16x32_bf16 v[192:195], v[128:131], v[32:35], 0
    ds_read_b128 v[168:171], v1 offset:14336
    s_waitcnt vmcnt(21) lgkmcnt(5)
    v_mfma_f32_16x16x32_bf16 v[176:179], v[132:135], v[36:39], v[176:179]
    ds_read_b128 v[112:115], v1 offset:15360
    v_mfma_f32_16x16x32_bf16 v[180:183], v[136:139], v[36:39], v[180:183]
    ds_read_b128 v[116:119], v1 offset:16384
    v_mfma_f32_16x16x32_bf16 v[184:187], v[140:143], v[36:39], v[184:187]
    ds_read_b128 v[120:123], v1 offset:17408
    v_mfma_f32_16x16x32_bf16 v[188:191], v[144:147], v[36:39], v[188:191]
    ds_read_b128 v[124:127], v1 offset:18432
    v_mfma_f32_16x16x32_bf16 v[192:195], v[148:151], v[36:39], v[192:195]
    ds_read_b128 v[128:131], v1 offset:19456
    s_waitcnt vmcnt(20) lgkmcnt(5)
    v_mfma_f32_16x16x32_bf16 v[176:179], v[152:155], v[40:43], v[176:179]
    ds_read_b128 v[132:135], v1 offset:20480
    v_mfma_f32_16x16x32_bf16 v[180:183], v[156:159], v[40:43], v[180:183]
    ds_read_b128 v[136:139], v1 offset:21504
    v_mfma_f32_16x16x32_bf16 v[184:187], v[160:163], v[40:43], v[184:187]
    ds_read_b128 v[140:143], v1 offset:22528
    v_mfma_f32_16x16x32_bf16 v[188:191], v[164:167], v[40:43], v[188:191]
    ds_read_b128 v[144:147], v1 offset:23552
    v_mfma_f32_16x16x32_bf16 v[192:195], v[168:171], v[40:43], v[192:195]
    ds_read_b128 v[148:151], v1 offset:24576
    s_waitcnt vmcnt(19) lgkmcnt(5)
    v_mfma_f32_16x16x32_bf16 v[176:179], v[112:115], v[44:47], v[176:179]
    ds_read_b128 v[152:155], v1 offset:25600
    v_mfma_f32_16x16x32_bf16 v[180:183], v[116:119], v[44:47], v[180:183]
    ds_read_b128 v[156:159], v1 offset:26624
    v_mfma_f32_16x16x32_bf16 v[184:187], v[120:123], v[44:47], v[184:187]
    ds_read_b128 v[160:163], v1 offset:27648
    v_mfma_f32_16x16x32_bf16 v[188:191], v[124:127], v[44:47], v[188:191]
    ds_read_b128 v[164:167], v1 offset:28672
    v_mfma_f32_16x16x32_bf16 v[192:195], v[128:131], v[44:47], v[192:195]
    ds_read_b128 v[168:171], v1 offset:29696
    s_waitcnt vmcnt(18) lgkmcnt(5)
    v_mfma_f32_16x16x32_bf16 v[176:179], v[132:135], v[48:51], v[176:179]
    ds_read_b128 v[112:115], v1 offset:30720
    v_mfma_f32_16x16x32_bf16 v[180:183], v[136:139], v[48:51], v[180:183]
    ds_read_b128 v[116:119], v1 offset:31744
    v_mfma_f32_16x16x32_bf16 v[184:187], v[140:143], v[48:51], v[184:187]
    ds_read_b128 v[120:123], v1 offset:32768
    v_mfma_f32_16x16x32_bf16 v[188:191], v[144:147], v[48:51], v[188:191]
    ds_read_b128 v[124:127], v1 offset:33792
    v_mfma_f32_16x16x32_bf16 v[192:195], v[148:151], v[48:51], v[192:195]
    ds_read_b128 v[128:131], v1 offset:34816
    s_waitcnt vmcnt(17) lgkmcnt(5)
    v_mfma_f32_16x16x32_bf16 v[176:179], v[152:155], v[52:55], v[176:179]
    ds_read_b128 v[132:135], v1 offset:35840
    v_mfma_f32_16x16x32_bf16 v[180:183], v[156:159], v[52:55], v[180:183]
    ds_read_b128 v[136:139], v1 offset:36864
    v_mfma_f32_16x16x32_bf16 v[184:187], v[160:163], v[52:55], v[184:187]
    ds_read_b128 v[140:143], v1 offset:37888
    v_mfma_f32_16x16x32_bf16 v[188:191], v[164:167], v[52:55], v[188:191]
    ds_read_b128 v[144:147], v1 offset:38912
    v_mfma_f32_16x16x32_bf16 v[192:195], v[168:171], v[52:55], v[192:195]
    ds_read_b128 v[148:151], v1 offset:39936
    s_waitcnt vmcnt(16) lgkmcnt(5)
    v_mfma_f32_16x16x32_bf16 v[176:179], v[112:115], v[56:59], v[176:179]
    ds_read_b128 v[152:155], v1 offset:40960
    v_mfma_f32_16x16x32_bf16 v[180:183], v[116:119], v[56:59], v[180:183]
    ds_read_b128 v[156:159], v1 offset:41984
    v_mfma_f32_16x16x32_bf16 v[184:187], v[120:123], v[56:59], v[184:187]
    ds_read_b128 v[160:163], v1 offset:43008
    v_mfma_f32_16x16x32_bf16 v[188:191], v[124:127], v[56:59], v[188:191]
    ds_read_b128 v[164:167], v1 offset:44032
    v_mfma_f32_16x16x32_bf16 v[192:195], v[128:131], v[56:59], v[192:195]
    ds_read_b128 v[168:171], v1 offset:45056
    s_waitcnt vmcnt(15) lgkmcnt(5)
    v_mfma_f32_16x16x32_bf16 v[176:179], v[132:135], v[60:63], v[176:179]
    ds_read_b128 v[112:115], v1 offset:46080
    v_mfma_f32_16x16x32_bf16 v[180:183], v[136:139], v[60:63], v[180:183]
    ds_read_b128 v[116:119], v1 offset:47104
    v_mfma_f32_16x16x32_bf16 v[184:187], v[140:143], v[60:63], v[184:187]
    ds_read_b128 v[120:123], v1 offset:48128
    v_mfma_f32_16x16x32_bf16 v[188:191], v[144:147], v[60:63], v[188:191]
    ds_read_b128 v[124:127], v1 offset:49152
    v_mfma_f32_16x16x32_bf16 v[192:195], v[148:151], v[60:63], v[192:195]
    ds_read_b128 v[128:131], v1 offset:50176
    s_waitcnt vmcnt(14) lgkmcnt(5)
    v_mfma_f32_16x16x32_bf16 v[176:179], v[152:155], v[64:67], v[176:179]
    ds_read_b128 v[132:135], v4 offset:0
    v_mfma_f32_16x16x32_bf16 v[180:183], v[156:159], v[64:67], v[180:183]
    ds_read_b128 v[136:139], v4 offset:1024
    v_mfma_f32_16x16x32_bf16 v[184:187], v[160:163], v[64:67], v[184:187]
    ds_read_b128 v[140:143], v4 offset:2048
    v_mfma_f32_16x16x32_bf16 v[188:191], v[164:167], v[64:67], v[188:191]
    ds_read_b128 v[144:147], v4 offset:3072
    v_mfma_f32_16x16x32_bf16 v[192:195], v[168:171], v[64:67], v[192:195]
    ds_read_b128 v[148:151], v4 offset:4096
    s_waitcnt vmcnt(13) lgkmcnt(5)
    v_mfma_f32_16x16x32_bf16 v[176:179], v[112:115], v[68:71], v[176:179]
    ds_read_b128 v[152:155], v4 offset:5120
    v_mfma_f32_16x16x32_bf16 v[180:183], v[116:119], v[68:71], v[180:183]
    ds_read_b128 v[156:159], v4 offset:6144
    v_mfma_f32_16x16x32_bf16 v[184:187], v[120:123], v[68:71], v[184:187]
    ds_read_b128 v[160:163], v4 offset:7168
    v_mfma_f32_16x16x32_bf16 v[188:191], v[124:127], v[68:71], v[188:191]
    ds_read_b128 v[164:167], v4 offset:8192
    v_mfma_f32_16x16x32_bf16 v[192:195], v[128:131], v[68:71], v[192:195]
    ds_read_b128 v[168:171], v4 offset:9216
    s_waitcnt vmcnt(12) lgkmcnt(5)
    v_mfma_f32_16x16x32_bf16 v[176:179], v[132:135], v[72:75], v[176:179]
    ds_read_b128 v[112:115], v4 offset:10240
    v_mfma_f32_16x16x32_bf16 v[180:183], v[136:139], v[72:75], v[180:183]
    ds_read_b128 v[116:119], v4 offset:11264
    v_mfma_f32_16x16x32_bf16 v[184:187], v[140:143], v[72:75], v[184:187]
    ds_read_b128 v[120:123], v4 offset:12288
    v_mfma_f32_16x16x32_bf16 v[188:191], v[144:147], v[72:75], v[188:191]
    ds_read_b128 v[124:127], v4 offset:13312
    v_mfma_f32_16x16x32_bf16 v[192:195], v[148:151], v[72:75], v[192:195]
    ds_read_b128 v[128:131], v4 offset:14336
    s_waitcnt vmcnt(11) lgkmcnt(5)
    v_mfma_f32_16x16x32_bf16 v[176:179], v[152:155], v[76:79], v[176:179]
    ds_read_b128 v[132:135], v4 offset:15360
    v_mfma_f32_16x16x32_bf16 v[180:183], v[156:159], v[76:79], v[180:183]
    ds_read_b128 v[136:139], v4 offset:16384
    v_mfma_f32_16x16x32_bf16 v[184:187], v[160:163], v[76:79], v[184:187]
    ds_read_b128 v[140:143], v4 offset:17408
    v_mfma_f32_16x16x32_bf16 v[188:191], v[164:167], v[76:79], v[188:191]
    ds_read_b128 v[144:147], v4 offset:18432
    v_mfma_f32_16x16x32_bf16 v[192:195], v[168:171], v[76:79], v[192:195]
    ds_read_b128 v[148:151], v4 offset:19456
    s_waitcnt vmcnt(10) lgkmcnt(5)
    v_mfma_f32_16x16x32_bf16 v[176:179], v[112:115], v[80:83], v[176:179]
    ds_read_b128 v[152:155], v4 offset:20480
    v_mfma_f32_16x16x32_bf16 v[180:183], v[116:119], v[80:83], v[180:183]
    ds_read_b128 v[156:159], v4 offset:21504
    v_mfma_f32_16x16x32_bf16 v[184:187], v[120:123], v[80:83], v[184:187]
    ds_read_b128 v[160:163], v4 offset:22528
    v_mfma_f32_16x16x32_bf16 v[188:191], v[124:127], v[80:83], v[188:191]
    ds_read_b128 v[164:167], v4 offset:23552
    v_mfma_f32_16x16x32_bf16 v[192:195], v[128:131], v[80:83], v[192:195]
    ds_read_b128 v[168:171], v4 offset:24576
    s_waitcnt vmcnt(9) lgkmcnt(5)
    v_mfma_f32_16x16x32_bf16 v[176:179], v[132:135], v[84:87], v[176:179]
    ds_read_b128 v[112:115], v4 offset:25600
    v_mfma_f32_16x16x32_bf16 v[180:183], v[136:139], v[84:87], v[180:183]
    ds_read_b128 v[116:119], v4 offset:26624
    v_mfma_f32_16x16x32_bf16 v[184:187], v[140:143], v[84:87], v[184:187]
    ds_read_b128 v[120:123], v4 offset:27648
    v_mfma_f32_16x16x32_bf16 v[188:191], v[144:147], v[84:87], v[188:191]
    ds_read_b128 v[124:127], v4 offset:28672
    v_mfma_f32_16x16x32_bf16 v[192:195], v[148:151], v[84:87], v[192:195]
    ds_read_b128 v[128:131], v4 offset:29696
    s_waitcnt vmcnt(8) lgkmcnt(5)
    v_mfma_f32_16x16x32_bf16 v[176:179], v[152:155], v[88:91], v[176:179]
    ds_read_b128 v[132:135], v4 offset:30720
    v_mfma_f32_16x16x32_bf16 v[180:183], v[156:159], v[88:91], v[180:183]
    ds_read_b128 v[136:139], v4 offset:31744
    v_mfma_f32_16x16x32_bf16 v[184:187], v[160:163], v[88:91], v[184:187]
    ds_read_b128 v[140:143], v4 offset:32768
    v_mfma_f32_16x16x32_bf16 v[188:191], v[164:167], v[88:91], v[188:191]
    ds_read_b128 v[144:147], v4 offset:33792
    v_mfma_f32_16x16x32_bf16 v[192:195], v[168:171], v[88:91], v[192:195]
    ds_read_b128 v[148:151], v4 offset:34816
    s_waitcnt vmcnt(7) lgkmcnt(5)
    v_mfma_f32_16x16x32_bf16 v[176:179], v[112:115], v[92:95], v[176:179]
    ds_read_b128 v[152:155], v4 offset:35840
    v_mfma_f32_16x16x32_bf16 v[180:183], v[116:119], v[92:95], v[180:183]
    ds_read_b128 v[156:159], v4 offset:36864
    v_mfma_f32_16x16x32_bf16 v[184:187], v[120:123], v[92:95], v[184:187]
    ds_read_b128 v[160:163], v4 offset:37888
    v_mfma_f32_16x16x32_bf16 v[188:191], v[124:127], v[92:95], v[188:191]
    ds_read_b128 v[164:167], v4 offset:38912
    v_mfma_f32_16x16x32_bf16 v[192:195], v[128:131], v[92:95], v[192:195]
    ds_read_b128 v[168:171], v4 offset:39936
    s_waitcnt vmcnt(6) lgkmcnt(5)
    v_mfma_f32_16x16x32_bf16 v[176:179], v[132:135], v[96:99], v[176:179]
    ds_read_b128 v[112:115], v4 offset:40960
    v_mfma_f32_16x16x32_bf16 v[180:183], v[136:139], v[96:99], v[180:183]
    ds_read_b128 v[116:119], v4 offset:41984
    v_mfma_f32_16x16x32_bf16 v[184:187], v[140:143], v[96:99], v[184:187]
    ds_read_b128 v[120:123], v4 offset:43008
    v_mfma_f32_16x16x32_bf16 v[188:191], v[144:147], v[96:99], v[188:191]
    ds_read_b128 v[124:127], v4 offset:44032
    v_mfma_f32_16x16x32_bf16 v[192:195], v[148:151], v[96:99], v[192:195]
    ds_read_b128 v[128:131], v4 offset:45056
    s_waitcnt vmcnt(5) lgkmcnt(5)
    v_mfma_f32_16x16x32_bf16 v[176:179], v[152:155], v[100:103], v[176:179]
    ds_read_b128 v[132:135], v4 offset:46080
    v_mfma_f32_16x16x32_bf16 v[180:183], v[156:159], v[100:103], v[180:183]
    ds_read_b128 v[136:139], v4 offset:47104
    v_mfma_f32_16x16x32_bf16 v[184:187], v[160:163], v[100:103], v[184:187]
    ds_read_b128 v[140:143], v4 offset:48128
    v_mfma_f32_16x16x32_bf16 v[188:191], v[164:167], v[100:103], v[188:191]
    ds_read_b128 v[144:147], v4 offset:49152
    v_mfma_f32_16x16x32_bf16 v[192:195], v[168:171], v[100:103], v[192:195]
    ds_read_b128 v[148:151], v4 offset:50176
    s_waitcnt vmcnt(4) lgkmcnt(5)
    v_mfma_f32_16x16x32_bf16 v[176:179], v[112:115], v[104:107], v[176:179]
    v_mfma_f32_16x16x32_bf16 v[180:183], v[116:119], v[104:107], v[180:183]
    v_mfma_f32_16x16x32_bf16 v[184:187], v[120:123], v[104:107], v[184:187]
    v_mfma_f32_16x16x32_bf16 v[188:191], v[124:127], v[104:107], v[188:191]
    v_mfma_f32_16x16x32_bf16 v[192:195], v[128:131], v[104:107], v[192:195]
    s_waitcnt vmcnt(3) lgkmcnt(0)
    v_mfma_f32_16x16x32_bf16 v[176:179], v[132:135], v[108:111], v[176:179]
    v_mfma_f32_16x16x32_bf16 v[180:183], v[136:139], v[108:111], v[180:183]
    v_mfma_f32_16x16x32_bf16 v[184:187], v[140:143], v[108:111], v[184:187]
    v_mfma_f32_16x16x32_bf16 v[188:191], v[144:147], v[108:111], v[188:191]
    v_mfma_f32_16x16x32_bf16 v[192:195], v[148:151], v[108:111], v[192:195]
    s_waitcnt vmcnt(0)
    ds_read_b64 v[16:17], v15 offset:0
    ds_read_b64 v[18:19], v15 offset:32
    ds_read_b64 v[20:21], v15 offset:64
    ds_read_b64 v[22:23], v15 offset:96
    ds_read_b64 v[24:25], v15 offset:128
    s_mov_b32 s33, 0xffff0000
    s_waitcnt lgkmcnt(0)
    v_lshlrev_b32 v196, 16, v16
    v_and_b32 v197, s33, v16
    v_lshlrev_b32 v198, 16, v17
    v_and_b32 v199, s33, v17
    v_lshlrev_b32 v200, 16, v18
    v_and_b32 v201, s33, v18
    v_lshlrev_b32 v202, 16, v19
    v_and_b32 v203, s33, v19
    v_lshlrev_b32 v204, 16, v20
    v_and_b32 v205, s33, v20
    v_lshlrev_b32 v206, 16, v21
    v_and_b32 v207, s33, v21
    v_lshlrev_b32 v208, 16, v22
    v_and_b32 v209, s33, v22
    v_lshlrev_b32 v210, 16, v23
    v_and_b32 v211, s33, v23
    v_lshlrev_b32 v212, 16, v24
    v_and_b32 v213, s33, v24
    v_lshlrev_b32 v214, 16, v25
    v_and_b32 v215, s33, v25
    v_pk_add_f32 v[176:177], v[176:177], v[196:197]
    v_pk_add_f32 v[178:179], v[178:179], v[198:199]
    v_pk_add_f32 v[180:181], v[180:181], v[200:201]
    v_pk_add_f32 v[182:183], v[182:183], v[202:203]
    v_pk_add_f32 v[184:185], v[184:185], v[204:205]
    v_pk_add_f32 v[186:187], v[186:187], v[206:207]
    v_pk_add_f32 v[188:189], v[188:189], v[208:209]
    v_pk_add_f32 v[190:191], v[190:191], v[210:211]
    v_pk_add_f32 v[192:193], v[192:193], v[212:213]
    v_pk_add_f32 v[194:195], v[194:195], v[214:215]
    v_cvt_pk_bf16_f32 v196, v176, v177
    v_cvt_pk_bf16_f32 v197, v178, v179
    v_cvt_pk_bf16_f32 v198, v180, v181
    v_cvt_pk_bf16_f32 v199, v182, v183
    v_cvt_pk_bf16_f32 v200, v184, v185
    v_cvt_pk_bf16_f32 v201, v186, v187
    v_cvt_pk_bf16_f32 v202, v188, v189
    v_cvt_pk_bf16_f32 v203, v190, v191
    v_cvt_pk_bf16_f32 v204, v192, v193
    v_cvt_pk_bf16_f32 v205, v194, v195
    buffer_store_dwordx2 v[204:205], v14, s[12:15], s40 offen offset:2048 sc1
    v_mov_b32 v16, 0
    v_mov_b32 v17, 0
    v_mov_b32 v18, 0x3f803f80
    v_dot2c_f32_bf16 v16, v196, v18
    v_dot2c_f32_bf16 v17, v196, v196
    v_dot2c_f32_bf16 v16, v197, v18
    v_dot2c_f32_bf16 v17, v197, v197
    v_dot2c_f32_bf16 v16, v198, v18
    v_dot2c_f32_bf16 v17, v198, v198
    v_dot2c_f32_bf16 v16, v199, v18
    v_dot2c_f32_bf16 v17, v199, v199
    v_dot2c_f32_bf16 v16, v200, v18
    v_dot2c_f32_bf16 v17, v200, v200
    v_dot2c_f32_bf16 v16, v201, v18
    v_dot2c_f32_bf16 v17, v201, v201
    v_dot2c_f32_bf16 v16, v202, v18
    v_dot2c_f32_bf16 v17, v202, v202
    v_dot2c_f32_bf16 v16, v203, v18
    v_dot2c_f32_bf16 v17, v203, v203
    v_dot2c_f32_bf16 v16, v204, v18
    v_dot2c_f32_bf16 v17, v204, v204
    v_dot2c_f32_bf16 v16, v205, v18
    v_dot2c_f32_bf16 v17, v205, v205
    v_permlane16_swap_b32 v196, v198
    v_permlane16_swap_b32 v197, v199
    buffer_store_dwordx4 v[196:199], v13, s[12:15], s40 offen offset:0 sc1
    v_permlane16_swap_b32 v200, v202
    v_permlane16_swap_b32 v201, v203
    buffer_store_dwordx4 v[200:203], v13, s[12:15], s40 offen offset:1024 sc1
    v_mov_b32 v18, v16
    v_mov_b32 v19, v17
    s_nop 1
    v_permlane32_swap_b32 v16, v18
    v_permlane32_swap_b32 v17, v19
    v_add_f32 v16, v16, v18
    v_add_f32 v17, v17, v19
    v_mov_b32 v18, v16
    v_mov_b32 v19, v17
    s_nop 1
    v_permlane16_swap_b32 v16, v18
    v_permlane16_swap_b32 v17, v19
    v_add_f32 v16, v16, v18
    v_add_f32 v17, v17, v19
    s_lshl_b32 s32, s17, 1
    s_lshr_b32 s33, s16, 1
    s_add_u32 s32, s32, s33
    s_lshl_b32 s32, s32, 11
    s_lshr_b32 s33, s18, 1
    s_lshl_b32 s33, s33, 9
    s_add_u32 s32, s32, s33
    s_and_b32 s33, s16, 1
    s_lshl_b32 s33, s33, 8
    s_add_u32 s32, s32, s33
    s_and_b32 s33, s18, 1
    s_lshl_b32 s33, s33, 3
    s_add_u32 s32, s32, s33
    s_add_u32 s32, s32, 14680064
    s_mov_b64 exec, 0xffff
    buffer_store_dwordx2 v[16:17], v3, s[12:15], s32 offen sc1
    s_mov_b64 exec, -1
    s_lshl_b32 s35, s19, 2
    s_add_u32 s35, s35, s16
    s_lshl_b32 s42, s35, 11
    s_add_u32 s42, s42, 14680064
    s_mul_i32 s43, s35, 110592
    s_mul_i32 s35, s35, 40960
    s_add_u32 s35, s35, 11534336
    v_lshrrev_b32 v15, 4, v2
    v_and_b32 v11, 15, v2
    v_lshlrev_b32 v12, 4, v11
    v_lshl_add_u32 v13, v15, 9, v12
    v_mov_b32 v14, v3
    v_add_u32 v1, 20480, v3
    s_mov_b32 s33, 0xffff0000
    s_mov_b32 s37, 0
    s_mov_b32 s38, 28672
    v_lshrrev_b32 v248, 1, v15
    v_lshl_add_u32 v248, v248, 8, v12
    v_and_b32 v15, 1, v15
    v_lshl_add_u32 v249, v15, 3, v248
    v_lshl_add_u32 v248, v15, 9, v248
    s_mul_i32 s32, s20, 3584
    s_add_u32 s43, s43, s32
    s_add_u32 s43, s43, 16777216
    s_add_u32 s50, s43, 55296
    v_mov_b32 v24, 0
    v_mov_b32 v25, 0
    v_mov_b32 v26, 0
    v_mov_b32 v27, 0
    v_mov_b32 v28, 0
    v_mov_b32 v29, 0
    v_mov_b32 v30, 0
    v_mov_b32 v31, 0
    v_mov_b32 v32, 0
    v_mov_b32 v33, 0
    v_mov_b32 v34, 0
    v_mov_b32 v35, 0
    v_mov_b32 v36, 0
    v_mov_b32 v37, 0
    v_mov_b32 v38, 0
    v_mov_b32 v39, 0
    v_mov_b32 v40, 0
    v_mov_b32 v41, 0
    v_mov_b32 v42, 0
    v_mov_b32 v43, 0
    v_mov_b32 v44, 0
    v_mov_b32 v45, 0
    v_mov_b32 v46, 0
    v_mov_b32 v47, 0
    v_mov_b32 v48, 0
    v_mov_b32 v49, 0
    v_mov_b32 v50, 0
    v_mov_b32 v51, 0
    v_mov_b32 v52, 0
    v_mov_b32 v53, 0
    v_mov_b32 v54, 0
    v_mov_b32 v55, 0
    v_mov_b32 v56, 0
    v_mov_b32 v57, 0
    v_mov_b32 v58, 0
    v_mov_b32 v59, 0
    v_mov_b32 v60, 0
    v_mov_b32 v61, 0
    v_mov_b32 v62, 0
    v_mov_b32 v63, 0
    v_mov_b32 v64, 0
    v_mov_b32 v65, 0
    v_mov_b32 v66, 0
    v_mov_b32 v67, 0
    v_mov_b32 v68, 0
    v_mov_b32 v69, 0
    v_mov_b32 v70, 0
    v_mov_b32 v71, 0
    v_mov_b32 v72, 0
    v_mov_b32 v73, 0
    v_mov_b32 v74, 0
    v_mov_b32 v75, 0
    v_mov_b32 v76, 0
    v_mov_b32 v77, 0
    v_mov_b32 v78, 0
    v_mov_b32 v79, 0
    v_mov_b32 v80, 0
    v_mov_b32 v81, 0
    v_mov_b32 v82, 0
    v_mov_b32 v83, 0
    v_mov_b32 v84, 0
    v_mov_b32 v85, 0
    v_mov_b32 v86, 0
    v_mov_b32 v87, 0
    v_mov_b32 v88, 0
    v_mov_b32 v89, 0
    v_mov_b32 v90, 0
    v_mov_b32 v91, 0
    v_mov_b32 v92, 0
    v_mov_b32 v93, 0
    v_mov_b32 v94, 0
    v_mov_b32 v95, 0
    v_mov_b32 v96, 0
    v_mov_b32 v97, 0
    v_mov_b32 v98, 0
    v_mov_b32 v99, 0
    v_mov_b32 v100, 0
    v_mov_b32 v101, 0
    v_mov_b32 v102, 0
    v_mov_b32 v103, 0
    v_mov_b32 v104, 0
    v_mov_b32 v105, 0
    v_mov_b32 v106, 0
    v_mov_b32 v107, 0
    v_mov_b32 v108, 0
    v_mov_b32 v109, 0
    v_mov_b32 v110, 0
    v_mov_b32 v111, 0
    v_mov_b32 v112, 0
    v_mov_b32 v113, 0
    v_mov_b32 v114, 0
    v_mov_b32 v115, 0
    v_mov_b32 v116, 0
    v_mov_b32 v117, 0
    v_mov_b32 v118, 0
    v_mov_b32 v119, 0
    v_mov_b32 v120, 0
    v_mov_b32 v121, 0
    v_mov_b32 v122, 0
    v_mov_b32 v123, 0
    v_mov_b32 v124, 0
    v_mov_b32 v125, 0
    v_mov_b32 v126, 0
    v_mov_b32 v127, 0
    s_waitcnt vmcnt(0)
    s_barrier
    s_cmp_lg_u32 s16, 0
    s_cbranch_scc1 Ltl_c1
    s_lshl_b32 s32, s21, 8
    s_add_u32 s32, s32, 15073280
    v_mov_b32 v10, 0
    v_mov_b32 v11, 1
    s_mov_b64 exec, 1
    buffer_atomic_add v11, v10, s[12:15], s32 offen sc1
    s_mov_b64 exec, -1
Ltl_c1:
    s_cmp_lg_u32 s16, 1
    s_cbranch_scc1 Ltl_c0
    s_lshl_b32 s32, s19, 8
    s_add_u32 s32, s32, 15073280
    s_mov_b32 s57, 2097152
    v_mov_b32 v10, 0
Ltl_pa:
    buffer_load_dword v11, v10, s[12:15], s32 offen sc1
    s_sub_u32 s57, s57, 1
    s_cbranch_scc1 Ltl_pad
    s_waitcnt vmcnt(0)
    v_readfirstlane_b32 s49, v11
    s_cmp_ge_u32 s49, 16
    s_cbranch_scc1 Ltl_pad
    s_sleep 1
    s_branch Ltl_pa
Ltl_pad:
    s_waitcnt vmcnt(0)
Ltl_c0:
    s_barrier
    buffer_load_dwordx4 v[16:19], v13, s[12:15], s42 offen offset:0 sc1
    buffer_load_dwordx4 v[20:23], v13, s[12:15], s42 offen offset:256 sc1
    buffer_load_dwordx4 v[184:187], v3, s[12:15], s35 offen sc1
    buffer_load_dwordx4 v[188:191], v1, s[12:15], s35 offen sc1
    s_add_u32 s35, s35, 1024
    buffer_load_dwordx4 v[192:195], v3, s[12:15], s35 offen sc1
    buffer_load_dwordx4 v[196:199], v1, s[12:15], s35 offen sc1
    s_add_u32 s35, s35, 1024
    buffer_load_dwordx4 v[200:203], v3, s[12:15], s35 offen sc1
    buffer_load_dwordx4 v[204:207], v1, s[12:15], s35 offen sc1
    s_add_u32 s35, s35, 1024
    ds_read_b128 v[128:131], v14 offset:0
    ds_read_b128 v[156:159], v14 offset:7168
    ds_read_b128 v[132:135], v14 offset:1024
    ds_read_b128 v[160:163], v14 offset:8192
    ds_read_b128 v[136:139], v14 offset:2048
    ds_read_b128 v[164:167], v14 offset:9216
    ds_read_b128 v[140:143], v14 offset:3072
    ds_read_b128 v[168:171], v14 offset:10240
    ds_read_b128 v[144:147], v14 offset:4096
    ds_read_b128 v[172:175], v14 offset:11264
    ds_read_b128 v[148:151], v14 offset:5120
    ds_read_b128 v[176:179], v14 offset:12288
    ds_read_b128 v[152:155], v14 offset:6144
    ds_read_b128 v[180:183], v14 offset:13312
    s_waitcnt vmcnt(6)
    v_add_f32 v16, v16, v18
    v_add_f32 v17, v17, v19
    v_add_f32 v20, v20, v22
    v_add_f32 v21, v21, v23
    v_mov_b32 v18, v16
    v_mov_b32 v19, v17
    v_mov_b32 v22, v20
    v_mov_b32 v23, v21
    s_nop 0
    v_permlane32_swap_b32 v16, v18
    v_permlane32_swap_b32 v17, v19
    v_permlane32_swap_b32 v20, v22
    v_permlane32_swap_b32 v21, v23
    v_add_f32 v16, v16, v18
    v_add_f32 v17, v17, v19
    v_add_f32 v20, v20, v22
    v_add_f32 v21, v21, v23
    v_mov_b32 v18, v16
    v_mov_b32 v19, v17
    v_mov_b32 v22, v20
    v_mov_b32 v23, v21
    s_nop 0
    v_permlane16_swap_b32 v16, v18
    v_permlane16_swap_b32 v17, v19
    v_permlane16_swap_b32 v20, v22
    v_permlane16_swap_b32 v21, v23
    v_add_f32 v16, v16, v18
    v_add_f32 v17, v17, v19
    v_add_f32 v20, v20, v22
    v_add_f32 v21, v21, v23
    v_mul_f32 v232, 0x3acccccd, v16
    v_mul_f32 v17, 0x3acccccd, v17
    v_fma_f32 v17, -v232, v232, v17
    v_max_f32 v17, 0, v17
    v_add_f32 v238, 0x3727c5ac, v17
    v_rsq_f32 v16, v238
    s_nop 0
    v_mul_f32 v234, 0xc0135761, v16
    v_mul_f32 v17, v16, v16
    v_mul_f32 v17, v17, v16
    v_mul_f32 v236, 0xbdd2d3e8, v17
    v_mul_f32 v240, 0x3acccccd, v20
    v_mul_f32 v21, 0x3acccccd, v21
    v_fma_f32 v21, -v240, v240, v21
    v_max_f32 v21, 0, v21
    v_add_f32 v246, 0x3727c5ac, v21
    v_rsq_f32 v20, v246
    s_nop 0
    v_mul_f32 v242, 0xc0135761, v20
    v_mul_f32 v21, v20, v20
    v_mul_f32 v21, v21, v20
    v_mul_f32 v244, 0xbdd2d3e8, v21
    v_mov_b32 v16, 0
    v_mov_b32 v17, 0
    v_mov_b32 v18, 0
    v_mov_b32 v19, 0
    v_mov_b32 v20, 0
    v_mov_b32 v21, 0
    v_mov_b32 v22, 0
    v_mov_b32 v23, 0
    s_waitcnt vmcnt(4)
.p2align 6
Ltl_loop:
    s_waitcnt lgkmcnt(12)
    v_mfma_f32_16x16x32_bf16 v[16:19], v[128:131], v[184:187], v[16:19]
    v_mfma_f32_16x16x32_bf16 v[20:23], v[128:131], v[188:191], v[20:23]
    ds_read_b128 v[128:131], v14 offset:14336
    v_mfma_f32_16x16x32_bf16 v[24:27], v[156:159], v[184:187], v[24:27]
    buffer_load_dwordx4 v[208:211], v3, s[12:15], s35 offen sc1
    v_mfma_f32_16x16x32_bf16 v[28:31], v[156:159], v[188:191], v[28:31]
    ds_read_b128 v[156:159], v14 offset:21504
    s_waitcnt lgkmcnt(12)
    v_mfma_f32_16x16x32_bf16 v[32:35], v[132:135], v[184:187], v[32:35]
    buffer_load_dwordx4 v[212:215], v1, s[12:15], s35 offen sc1
    v_mfma_f32_16x16x32_bf16 v[36:39], v[132:135], v[188:191], v[36:39]
    ds_read_b128 v[132:135], v14 offset:15360
    v_mfma_f32_16x16x32_bf16 v[40:43], v[160:163], v[184:187], v[40:43]
    s_add_u32 s35, s35, 1024
    v_mfma_f32_16x16x32_bf16 v[44:47], v[160:163], v[188:191], v[44:47]
    ds_read_b128 v[160:163], v14 offset:22528
    s_waitcnt lgkmcnt(12)
    v_mfma_f32_16x16x32_bf16 v[48:51], v[136:139], v[184:187], v[48:51]
    s_cmp_eq_u32 s37, 4
    v_mfma_f32_16x16x32_bf16 v[52:55], v[136:139], v[188:191], v[52:55]
    ds_read_b128 v[136:139], v14 offset:16384
    v_mfma_f32_16x16x32_bf16 v[56:59], v[164:167], v[184:187], v[56:59]
    s_cselect_b32 s35, 33554432, s35
    v_mfma_f32_16x16x32_bf16 v[60:63], v[164:167], v[188:191], v[60:63]
    ds_read_b128 v[164:167], v14 offset:23552
    s_waitcnt lgkmcnt(12)
    v_mfma_f32_16x16x32_bf16 v[64:67], v[140:143], v[184:187], v[64:67]
    v_mfma_f32_16x16x32_bf16 v[68:71], v[140:143], v[188:191], v[68:71]
    ds_read_b128 v[140:143], v14 offset:17408
    v_mfma_f32_16x16x32_bf16 v[72:75], v[168:171], v[184:187], v[72:75]
    v_mfma_f32_16x16x32_bf16 v[76:79], v[168:171], v[188:191], v[76:79]
    ds_read_b128 v[168:171], v14 offset:24576
    s_waitcnt lgkmcnt(12)
    v_mfma_f32_16x16x32_bf16 v[80:83], v[144:147], v[184:187], v[80:83]
    v_mfma_f32_16x16x32_bf16 v[84:87], v[144:147], v[188:191], v[84:87]
    ds_read_b128 v[144:147], v14 offset:18432
    v_mfma_f32_16x16x32_bf16 v[88:91], v[172:175], v[184:187], v[88:91]
    v_mfma_f32_16x16x32_bf16 v[92:95], v[172:175], v[188:191], v[92:95]
    ds_read_b128 v[172:175], v14 offset:25600
    s_waitcnt lgkmcnt(12)
    v_mfma_f32_16x16x32_bf16 v[96:99], v[148:151], v[184:187], v[96:99]
    v_mfma_f32_16x16x32_bf16 v[100:103], v[148:151], v[188:191], v[100:103]
    ds_read_b128 v[148:151], v14 offset:19456
    v_mfma_f32_16x16x32_bf16 v[104:107], v[176:179], v[184:187], v[104:107]
    v_mfma_f32_16x16x32_bf16 v[108:111], v[176:179], v[188:191], v[108:111]
    ds_read_b128 v[176:179], v14 offset:26624
    s_waitcnt lgkmcnt(12)
    v_mfma_f32_16x16x32_bf16 v[112:115], v[152:155], v[184:187], v[112:115]
    v_mfma_f32_16x16x32_bf16 v[116:119], v[152:155], v[188:191], v[116:119]
    ds_read_b128 v[152:155], v14 offset:20480
    v_mfma_f32_16x16x32_bf16 v[120:123], v[180:183], v[184:187], v[120:123]
    s_waitcnt vmcnt(4)
    v_mfma_f32_16x16x32_bf16 v[124:127], v[180:183], v[188:191], v[124:127]
    ds_read_b128 v[180:183], v14 offset:27648
    s_waitcnt lgkmcnt(12)
    v_mfma_f32_16x16x32_bf16 v[16:19], v[128:131], v[192:195], v[16:19]
    v_mfma_f32_16x16x32_bf16 v[20:23], v[128:131], v[196:199], v[20:23]
    v_mfma_f32_16x16x32_bf16 v[24:27], v[156:159], v[192:195], v[24:27]
    buffer_load_dwordx4 v[184:187], v3, s[12:15], s35 offen sc1
    v_mfma_f32_16x16x32_bf16 v[28:31], v[156:159], v[196:199], v[28:31]
    s_waitcnt lgkmcnt(0)
    s_barrier
    v_add_u32 v14, s38, v3
    ds_read_b128 v[128:131], v14 offset:0
    ds_read_b128 v[156:159], v14 offset:7168
    v_mfma_f32_16x16x32_bf16 v[32:35], v[132:135], v[192:195], v[32:35]
    buffer_load_dwordx4 v[188:191], v1, s[12:15], s35 offen sc1
    v_mfma_f32_16x16x32_bf16 v[36:39], v[132:135], v[196:199], v[36:39]
    ds_read_b128 v[132:135], v14 offset:1024
    v_mfma_f32_16x16x32_bf16 v[40:43], v[160:163], v[192:195], v[40:43]
    s_add_u32 s35, s35, 1024
    v_mfma_f32_16x16x32_bf16 v[44:47], v[160:163], v[196:199], v[44:47]
    ds_read_b128 v[160:163], v14 offset:8192
    v_mfma_f32_16x16x32_bf16 v[48:51], v[136:139], v[192:195], v[48:51]
    v_mfma_f32_16x16x32_bf16 v[52:55], v[136:139], v[196:199], v[52:55]
    ds_read_b128 v[136:139], v14 offset:2048
    v_mfma_f32_16x16x32_bf16 v[56:59], v[164:167], v[192:195], v[56:59]
    v_mfma_f32_16x16x32_bf16 v[60:63], v[164:167], v[196:199], v[60:63]
    ds_read_b128 v[164:167], v14 offset:9216
    v_mfma_f32_16x16x32_bf16 v[64:67], v[140:143], v[192:195], v[64:67]
    v_mfma_f32_16x16x32_bf16 v[68:71], v[140:143], v[196:199], v[68:71]
    ds_read_b128 v[140:143], v14 offset:3072
    v_mfma_f32_16x16x32_bf16 v[72:75], v[168:171], v[192:195], v[72:75]
    v_mfma_f32_16x16x32_bf16 v[76:79], v[168:171], v[196:199], v[76:79]
    ds_read_b128 v[168:171], v14 offset:10240
    v_mfma_f32_16x16x32_bf16 v[80:83], v[144:147], v[192:195], v[80:83]
    v_mfma_f32_16x16x32_bf16 v[84:87], v[144:147], v[196:199], v[84:87]
    ds_read_b128 v[144:147], v14 offset:4096
    v_mfma_f32_16x16x32_bf16 v[88:91], v[172:175], v[192:195], v[88:91]
    v_mfma_f32_16x16x32_bf16 v[92:95], v[172:175], v[196:199], v[92:95]
    ds_read_b128 v[172:175], v14 offset:11264
    v_mfma_f32_16x16x32_bf16 v[96:99], v[148:151], v[192:195], v[96:99]
    s_add_u32 s38, s38, 28672
    v_mfma_f32_16x16x32_bf16 v[100:103], v[148:151], v[196:199], v[100:103]
    ds_read_b128 v[148:151], v14 offset:5120
    v_mfma_f32_16x16x32_bf16 v[104:107], v[176:179], v[192:195], v[104:107]
    s_cmp_eq_u32 s38, 114688
    v_mfma_f32_16x16x32_bf16 v[108:111], v[176:179], v[196:199], v[108:111]
    ds_read_b128 v[176:179], v14 offset:12288
    v_mfma_f32_16x16x32_bf16 v[112:115], v[152:155], v[192:195], v[112:115]
    s_cselect_b32 s38, 0, s38
    v_mfma_f32_16x16x32_bf16 v[116:119], v[152:155], v[196:199], v[116:119]
    ds_read_b128 v[152:155], v14 offset:6144
    v_mfma_f32_16x16x32_bf16 v[120:123], v[180:183], v[192:195], v[120:123]
    s_waitcnt vmcnt(4)
    v_mfma_f32_16x16x32_bf16 v[124:127], v[180:183], v[196:199], v[124:127]
    ds_read_b128 v[180:183], v14 offset:13312
    s_waitcnt lgkmcnt(12)
    v_mfma_f32_16x16x32_bf16 v[16:19], v[128:131], v[200:203], v[16:19]
    v_mfma_f32_16x16x32_bf16 v[20:23], v[128:131], v[204:207], v[20:23]
    ds_read_b128 v[128:131], v14 offset:14336
    v_mfma_f32_16x16x32_bf16 v[24:27], v[156:159], v[200:203], v[24:27]
    buffer_load_dwordx4 v[192:195], v3, s[12:15], s35 offen sc1
    v_mfma_f32_16x16x32_bf16 v[28:31], v[156:159], v[204:207], v[28:31]
    ds_read_b128 v[156:159], v14 offset:21504
    s_waitcnt lgkmcnt(12)
    v_mfma_f32_16x16x32_bf16 v[32:35], v[132:135], v[200:203], v[32:35]
    buffer_load_dwordx4 v[196:199], v1, s[12:15], s35 offen sc1
    v_mfma_f32_16x16x32_bf16 v[36:39], v[132:135], v[204:207], v[36:39]
    ds_read_b128 v[132:135], v14 offset:15360
    v_mfma_f32_16x16x32_bf16 v[40:43], v[160:163], v[200:203], v[40:43]
    s_add_u32 s35, s35, 1024
    v_mfma_f32_16x16x32_bf16 v[44:47], v[160:163], v[204:207], v[44:47]
    ds_read_b128 v[160:163], v14 offset:22528
    s_waitcnt lgkmcnt(12)
    v_mfma_f32_16x16x32_bf16 v[48:51], v[136:139], v[200:203], v[48:51]
    v_mfma_f32_16x16x32_bf16 v[52:55], v[136:139], v[204:207], v[52:55]
    ds_read_b128 v[136:139], v14 offset:16384
    v_mfma_f32_16x16x32_bf16 v[56:59], v[164:167], v[200:203], v[56:59]
    v_mfma_f32_16x16x32_bf16 v[60:63], v[164:167], v[204:207], v[60:63]
    ds_read_b128 v[164:167], v14 offset:23552
    s_waitcnt lgkmcnt(12)
    v_mfma_f32_16x16x32_bf16 v[64:67], v[140:143], v[200:203], v[64:67]
    v_mfma_f32_16x16x32_bf16 v[68:71], v[140:143], v[204:207], v[68:71]
    ds_read_b128 v[140:143], v14 offset:17408
    v_mfma_f32_16x16x32_bf16 v[72:75], v[168:171], v[200:203], v[72:75]
    v_mfma_f32_16x16x32_bf16 v[76:79], v[168:171], v[204:207], v[76:79]
    ds_read_b128 v[168:171], v14 offset:24576
    s_waitcnt lgkmcnt(12)
    v_mfma_f32_16x16x32_bf16 v[80:83], v[144:147], v[200:203], v[80:83]
    v_mfma_f32_16x16x32_bf16 v[84:87], v[144:147], v[204:207], v[84:87]
    ds_read_b128 v[144:147], v14 offset:18432
    v_mfma_f32_16x16x32_bf16 v[88:91], v[172:175], v[200:203], v[88:91]
    v_mfma_f32_16x16x32_bf16 v[92:95], v[172:175], v[204:207], v[92:95]
    ds_read_b128 v[172:175], v14 offset:25600
    s_waitcnt lgkmcnt(12)
    v_mfma_f32_16x16x32_bf16 v[96:99], v[148:151], v[200:203], v[96:99]
    v_mfma_f32_16x16x32_bf16 v[100:103], v[148:151], v[204:207], v[100:103]
    ds_read_b128 v[148:151], v14 offset:19456
    v_mfma_f32_16x16x32_bf16 v[104:107], v[176:179], v[200:203], v[104:107]
    v_mfma_f32_16x16x32_bf16 v[108:111], v[176:179], v[204:207], v[108:111]
    ds_read_b128 v[176:179], v14 offset:26624
    s_waitcnt lgkmcnt(12)
    v_mfma_f32_16x16x32_bf16 v[112:115], v[152:155], v[200:203], v[112:115]
    v_mfma_f32_16x16x32_bf16 v[116:119], v[152:155], v[204:207], v[116:119]
    ds_read_b128 v[152:155], v14 offset:20480
    v_mfma_f32_16x16x32_bf16 v[120:123], v[180:183], v[200:203], v[120:123]
    s_waitcnt vmcnt(4)
    v_mfma_f32_16x16x32_bf16 v[124:127], v[180:183], v[204:207], v[124:127]
    ds_read_b128 v[180:183], v14 offset:27648
    s_waitcnt lgkmcnt(12)
    v_mfma_f32_16x16x32_bf16 v[16:19], v[128:131], v[208:211], v[16:19]
    v_mfma_f32_16x16x32_bf16 v[20:23], v[128:131], v[212:215], v[20:23]
    v_mfma_f32_16x16x32_bf16 v[24:27], v[156:159], v[208:211], v[24:27]
    buffer_load_dwordx4 v[200:203], v3, s[12:15], s35 offen sc1
    v_mfma_f32_16x16x32_bf16 v[28:31], v[156:159], v[212:215], v[28:31]
    s_waitcnt lgkmcnt(0)
    s_barrier
    v_add_u32 v14, s38, v3
    ds_read_b128 v[128:131], v14 offset:0
    ds_read_b128 v[156:159], v14 offset:7168
    v_mfma_f32_16x16x32_bf16 v[32:35], v[132:135], v[208:211], v[32:35]
    buffer_load_dwordx4 v[204:207], v1, s[12:15], s35 offen sc1
    v_mfma_f32_16x16x32_bf16 v[36:39], v[132:135], v[212:215], v[36:39]
    ds_read_b128 v[132:135], v14 offset:1024
    v_mfma_f32_16x16x32_bf16 v[40:43], v[160:163], v[208:211], v[40:43]
    s_add_u32 s35, s35, 1024
    v_mfma_f32_16x16x32_bf16 v[44:47], v[160:163], v[212:215], v[44:47]
    ds_read_b128 v[160:163], v14 offset:8192
    v_mfma_f32_16x16x32_bf16 v[48:51], v[136:139], v[208:211], v[48:51]
    v_mfma_f32_16x16x32_bf16 v[52:55], v[136:139], v[212:215], v[52:55]
    ds_read_b128 v[136:139], v14 offset:2048
    v_mfma_f32_16x16x32_bf16 v[56:59], v[164:167], v[208:211], v[56:59]
    v_mfma_f32_16x16x32_bf16 v[60:63], v[164:167], v[212:215], v[60:63]
    ds_read_b128 v[164:167], v14 offset:9216
    v_mfma_f32_16x16x32_bf16 v[64:67], v[140:143], v[208:211], v[64:67]
    v_mfma_f32_16x16x32_bf16 v[68:71], v[140:143], v[212:215], v[68:71]
    ds_read_b128 v[140:143], v14 offset:3072
    v_mfma_f32_16x16x32_bf16 v[72:75], v[168:171], v[208:211], v[72:75]
    v_mfma_f32_16x16x32_bf16 v[76:79], v[168:171], v[212:215], v[76:79]
    ds_read_b128 v[168:171], v14 offset:10240
    v_mfma_f32_16x16x32_bf16 v[80:83], v[144:147], v[208:211], v[80:83]
    s_add_u32 s38, s38, 28672
    v_mfma_f32_16x16x32_bf16 v[84:87], v[144:147], v[212:215], v[84:87]
    ds_read_b128 v[144:147], v14 offset:4096
    v_mfma_f32_16x16x32_bf16 v[88:91], v[172:175], v[208:211], v[88:91]
    s_cmp_eq_u32 s38, 114688
    v_mfma_f32_16x16x32_bf16 v[92:95], v[172:175], v[212:215], v[92:95]
    ds_read_b128 v[172:175], v14 offset:11264
    v_mfma_f32_16x16x32_bf16 v[96:99], v[148:151], v[208:211], v[96:99]
    s_cselect_b32 s38, 0, s38
    v_mfma_f32_16x16x32_bf16 v[100:103], v[148:151], v[212:215], v[100:103]
    ds_read_b128 v[148:151], v14 offset:5120
    v_mfma_f32_16x16x32_bf16 v[104:107], v[176:179], v[208:211], v[104:107]
    s_add_u32 s37, s37, 1
    v_mfma_f32_16x16x32_bf16 v[108:111], v[176:179], v[212:215], v[108:111]
    ds_read_b128 v[176:179], v14 offset:12288
    v_mfma_f32_16x16x32_bf16 v[112:115], v[152:155], v[208:211], v[112:115]
    s_cmp_lt_u32 s37, 5
    v_mfma_f32_16x16x32_bf16 v[116:119], v[152:155], v[212:215], v[116:119]
    ds_read_b128 v[152:155], v14 offset:6144
    v_mfma_f32_16x16x32_bf16 v[120:123], v[180:183], v[208:211], v[120:123]
    s_waitcnt vmcnt(4)
    v_mfma_f32_16x16x32_bf16 v[124:127], v[180:183], v[212:215], v[124:127]
    ds_read_b128 v[180:183], v14 offset:13312
    s_cbranch_scc1 Ltl_loop
    v_lshrrev_b32 v14, 4, v2
    v_lshlrev_b32 v14, 4, v14
    v_add_u32 v14, 156736, v14
    s_mul_i32 s48, s20, 7
    s_waitcnt lgkmcnt(0)
    ds_read_b128 v[152:155], v14 offset:0
    ds_read_b128 v[156:159], v14 offset:448
    ds_read_b128 v[160:163], v14 offset:64
    ds_read_b128 v[164:167], v14 offset:512
    ds_read_b128 v[168:171], v14 offset:128
    ds_read_b128 v[172:175], v14 offset:576
    ds_read_b128 v[176:179], v14 offset:192
    ds_read_b128 v[180:183], v14 offset:640
    s_waitcnt lgkmcnt(6)
    v_pk_fma_f32 v[16:17], v[152:153], v[232:233], v[16:17] op_sel_hi:[1,0,1] neg_lo:[0,1,0] neg_hi:[0,1,0]
    v_pk_fma_f32 v[18:19], v[154:155], v[232:233], v[18:19] op_sel_hi:[1,0,1] neg_lo:[0,1,0] neg_hi:[0,1,0]
    v_pk_fma_f32 v[20:21], v[152:153], v[240:241], v[20:21] op_sel_hi:[1,0,1] neg_lo:[0,1,0] neg_hi:[0,1,0]
    v_pk_fma_f32 v[22:23], v[154:155], v[240:241], v[22:23] op_sel_hi:[1,0,1] neg_lo:[0,1,0] neg_hi:[0,1,0]
    v_pk_mul_f32 v[128:129], v[16:17], v[16:17]
    v_pk_mul_f32 v[130:131], v[18:19], v[18:19]
    v_pk_mul_f32 v[132:133], v[20:21], v[20:21]
    v_pk_mul_f32 v[134:135], v[22:23], v[22:23]
    v_pk_fma_f32 v[128:129], v[128:129], v[236:237], v[234:235] op_sel_hi:[1,0,0]
    v_pk_fma_f32 v[130:131], v[130:131], v[236:237], v[234:235] op_sel_hi:[1,0,0]
    v_pk_fma_f32 v[132:133], v[132:133], v[244:245], v[242:243] op_sel_hi:[1,0,0]
    v_pk_fma_f32 v[134:135], v[134:135], v[244:245], v[242:243] op_sel_hi:[1,0,0]
    v_pk_mul_f32 v[128:129], v[128:129], v[16:17]
    v_pk_mul_f32 v[130:131], v[130:131], v[18:19]
    v_pk_mul_f32 v[132:133], v[132:133], v[20:21]
    v_pk_mul_f32 v[134:135], v[134:135], v[22:23]
    v_exp_f32 v128, v128
    v_exp_f32 v129, v129
    v_exp_f32 v130, v130
    v_exp_f32 v131, v131
    v_exp_f32 v132, v132
    v_exp_f32 v133, v133
    v_exp_f32 v134, v134
    v_exp_f32 v135, v135
    v_pk_fma_f32 v[24:25], v[156:157], v[232:233], v[24:25] op_sel_hi:[1,0,1] neg_lo:[0,1,0] neg_hi:[0,1,0]
    v_pk_fma_f32 v[26:27], v[158:159], v[232:233], v[26:27] op_sel_hi:[1,0,1] neg_lo:[0,1,0] neg_hi:[0,1,0]
    v_pk_fma_f32 v[28:29], v[156:157], v[240:241], v[28:29] op_sel_hi:[1,0,1] neg_lo:[0,1,0] neg_hi:[0,1,0]
    v_pk_fma_f32 v[30:31], v[158:159], v[240:241], v[30:31] op_sel_hi:[1,0,1] neg_lo:[0,1,0] neg_hi:[0,1,0]
    ds_read_b128 v[152:155], v14 offset:256
    ds_read_b128 v[156:159], v14 offset:704
    v_pk_fma_f32 v[128:129], v[128:129], v[238:239], v[238:239] op_sel_hi:[1,0,0]
    v_pk_fma_f32 v[130:131], v[130:131], v[238:239], v[238:239] op_sel_hi:[1,0,0]
    v_pk_fma_f32 v[132:133], v[132:133], v[246:247], v[246:247] op_sel_hi:[1,0,0]
    v_pk_fma_f32 v[134:135], v[134:135], v[246:247], v[246:247] op_sel_hi:[1,0,0]
    v_rcp_f32 v128, v128
    v_rcp_f32 v129, v129
    v_rcp_f32 v130, v130
    v_rcp_f32 v131, v131
    v_rcp_f32 v132, v132
    v_rcp_f32 v133, v133
    v_rcp_f32 v134, v134
    v_rcp_f32 v135, v135
    v_pk_mul_f32 v[16:17], v[16:17], v[24:25]
    v_pk_mul_f32 v[18:19], v[18:19], v[26:27]
    v_pk_mul_f32 v[20:21], v[20:21], v[28:29]
    v_pk_mul_f32 v[22:23], v[22:23], v[30:31]
    v_pk_mul_f32 v[16:17], v[16:17], v[128:129]
    v_pk_mul_f32 v[18:19], v[18:19], v[130:131]
    v_pk_mul_f32 v[20:21], v[20:21], v[132:133]
    v_pk_mul_f32 v[22:23], v[22:23], v[134:135]
    v_cvt_pk_bf16_f32 v136, v16, v17
    v_cvt_pk_bf16_f32 v137, v18, v19
    v_cvt_pk_bf16_f32 v140, v20, v21
    v_cvt_pk_bf16_f32 v141, v22, v23
    s_waitcnt lgkmcnt(4)
    v_pk_fma_f32 v[32:33], v[160:161], v[232:233], v[32:33] op_sel_hi:[1,0,1] neg_lo:[0,1,0] neg_hi:[0,1,0]
    v_pk_fma_f32 v[34:35], v[162:163], v[232:233], v[34:35] op_sel_hi:[1,0,1] neg_lo:[0,1,0] neg_hi:[0,1,0]
    v_pk_fma_f32 v[36:37], v[160:161], v[240:241], v[36:37] op_sel_hi:[1,0,1] neg_lo:[0,1,0] neg_hi:[0,1,0]
    v_pk_fma_f32 v[38:39], v[162:163], v[240:241], v[38:39] op_sel_hi:[1,0,1] neg_lo:[0,1,0] neg_hi:[0,1,0]
    v_pk_mul_f32 v[128:129], v[32:33], v[32:33]
    v_pk_mul_f32 v[130:131], v[34:35], v[34:35]
    v_pk_mul_f32 v[132:133], v[36:37], v[36:37]
    v_pk_mul_f32 v[134:135], v[38:39], v[38:39]
    v_pk_fma_f32 v[128:129], v[128:129], v[236:237], v[234:235] op_sel_hi:[1,0,0]
    v_pk_fma_f32 v[130:131], v[130:131], v[236:237], v[234:235] op_sel_hi:[1,0,0]
    v_pk_fma_f32 v[132:133], v[132:133], v[244:245], v[242:243] op_sel_hi:[1,0,0]
    v_pk_fma_f32 v[134:135], v[134:135], v[244:245], v[242:243] op_sel_hi:[1,0,0]
    v_pk_mul_f32 v[128:129], v[128:129], v[32:33]
    v_pk_mul_f32 v[130:131], v[130:131], v[34:35]
    v_pk_mul_f32 v[132:133], v[132:133], v[36:37]
    v_pk_mul_f32 v[134:135], v[134:135], v[38:39]
    v_exp_f32 v128, v128
    v_exp_f32 v129, v129
    v_exp_f32 v130, v130
    v_exp_f32 v131, v131
    v_exp_f32 v132, v132
    v_exp_f32 v133, v133
    v_exp_f32 v134, v134
    v_exp_f32 v135, v135
    v_pk_fma_f32 v[40:41], v[164:165], v[232:233], v[40:41] op_sel_hi:[1,0,1] neg_lo:[0,1,0] neg_hi:[0,1,0]
    v_pk_fma_f32 v[42:43], v[166:167], v[232:233], v[42:43] op_sel_hi:[1,0,1] neg_lo:[0,1,0] neg_hi:[0,1,0]
    v_pk_fma_f32 v[44:45], v[164:165], v[240:241], v[44:45] op_sel_hi:[1,0,1] neg_lo:[0,1,0] neg_hi:[0,1,0]
    v_pk_fma_f32 v[46:47], v[166:167], v[240:241], v[46:47] op_sel_hi:[1,0,1] neg_lo:[0,1,0] neg_hi:[0,1,0]
    ds_read_b128 v[160:163], v14 offset:320
    ds_read_b128 v[164:167], v14 offset:768
    v_pk_fma_f32 v[128:129], v[128:129], v[238:239], v[238:239] op_sel_hi:[1,0,0]
    v_pk_fma_f32 v[130:131], v[130:131], v[238:239], v[238:239] op_sel_hi:[1,0,0]
    v_pk_fma_f32 v[132:133], v[132:133], v[246:247], v[246:247] op_sel_hi:[1,0,0]
    v_pk_fma_f32 v[134:135], v[134:135], v[246:247], v[246:247] op_sel_hi:[1,0,0]
    v_rcp_f32 v128, v128
    v_rcp_f32 v129, v129
    v_rcp_f32 v130, v130
    v_rcp_f32 v131, v131
    v_rcp_f32 v132, v132
    v_rcp_f32 v133, v133
    v_rcp_f32 v134, v134
    v_rcp_f32 v135, v135
    v_pk_mul_f32 v[32:33], v[32:33], v[40:41]
    v_pk_mul_f32 v[34:35], v[34:35], v[42:43]
    v_pk_mul_f32 v[36:37], v[36:37], v[44:45]
    v_pk_mul_f32 v[38:39], v[38:39], v[46:47]
    v_pk_mul_f32 v[32:33], v[32:33], v[128:129]
    v_pk_mul_f32 v[34:35], v[34:35], v[130:131]
    v_pk_mul_f32 v[36:37], v[36:37], v[132:133]
    v_pk_mul_f32 v[38:39], v[38:39], v[134:135]
    v_cvt_pk_bf16_f32 v138, v32, v33
    v_cvt_pk_bf16_f32 v139, v34, v35
    v_cvt_pk_bf16_f32 v142, v36, v37
    v_cvt_pk_bf16_f32 v143, v38, v39
    s_nop 1
    v_permlane16_swap_b32 v136, v138
    v_permlane16_swap_b32 v137, v139
    buffer_store_dwordx4 v[136:139], v248, s[12:15], s43 offen offset:0 sc1
    v_permlane16_swap_b32 v140, v142
    v_permlane16_swap_b32 v141, v143
    buffer_store_dwordx4 v[140:143], v248, s[12:15], s50 offen offset:0 sc1
    s_waitcnt lgkmcnt(4)
    v_pk_fma_f32 v[48:49], v[168:169], v[232:233], v[48:49] op_sel_hi:[1,0,1] neg_lo:[0,1,0] neg_hi:[0,1,0]
    v_pk_fma_f32 v[50:51], v[170:171], v[232:233], v[50:51] op_sel_hi:[1,0,1] neg_lo:[0,1,0] neg_hi:[0,1,0]
    v_pk_fma_f32 v[52:53], v[168:169], v[240:241], v[52:53] op_sel_hi:[1,0,1] neg_lo:[0,1,0] neg_hi:[0,1,0]
    v_pk_fma_f32 v[54:55], v[170:171], v[240:241], v[54:55] op_sel_hi:[1,0,1] neg_lo:[0,1,0] neg_hi:[0,1,0]
    v_pk_mul_f32 v[128:129], v[48:49], v[48:49]
    v_pk_mul_f32 v[130:131], v[50:51], v[50:51]
    v_pk_mul_f32 v[132:133], v[52:53], v[52:53]
    v_pk_mul_f32 v[134:135], v[54:55], v[54:55]
    v_pk_fma_f32 v[128:129], v[128:129], v[236:237], v[234:235] op_sel_hi:[1,0,0]
    v_pk_fma_f32 v[130:131], v[130:131], v[236:237], v[234:235] op_sel_hi:[1,0,0]
    v_pk_fma_f32 v[132:133], v[132:133], v[244:245], v[242:243] op_sel_hi:[1,0,0]
    v_pk_fma_f32 v[134:135], v[134:135], v[244:245], v[242:243] op_sel_hi:[1,0,0]
    v_pk_mul_f32 v[128:129], v[128:129], v[48:49]
    v_pk_mul_f32 v[130:131], v[130:131], v[50:51]
    v_pk_mul_f32 v[132:133], v[132:133], v[52:53]
    v_pk_mul_f32 v[134:135], v[134:135], v[54:55]
    v_exp_f32 v128, v128
    v_exp_f32 v129, v129
    v_exp_f32 v130, v130
    v_exp_f32 v131, v131
    v_exp_f32 v132, v132
    v_exp_f32 v133, v133
    v_exp_f32 v134, v134
    v_exp_f32 v135, v135
    v_pk_fma_f32 v[56:57], v[172:173], v[232:233], v[56:57] op_sel_hi:[1,0,1] neg_lo:[0,1,0] neg_hi:[0,1,0]
    v_pk_fma_f32 v[58:59], v[174:175], v[232:233], v[58:59] op_sel_hi:[1,0,1] neg_lo:[0,1,0] neg_hi:[0,1,0]
    v_pk_fma_f32 v[60:61], v[172:173], v[240:241], v[60:61] op_sel_hi:[1,0,1] neg_lo:[0,1,0] neg_hi:[0,1,0]
    v_pk_fma_f32 v[62:63], v[174:175], v[240:241], v[62:63] op_sel_hi:[1,0,1] neg_lo:[0,1,0] neg_hi:[0,1,0]
    ds_read_b128 v[168:171], v14 offset:384
    ds_read_b128 v[172:175], v14 offset:832
    v_pk_fma_f32 v[128:129], v[128:129], v[238:239], v[238:239] op_sel_hi:[1,0,0]
    v_pk_fma_f32 v[130:131], v[130:131], v[238:239], v[238:239] op_sel_hi:[1,0,0]
    v_pk_fma_f32 v[132:133], v[132:133], v[246:247], v[246:247] op_sel_hi:[1,0,0]
    v_pk_fma_f32 v[134:135], v[134:135], v[246:247], v[246:247] op_sel_hi:[1,0,0]
    v_rcp_f32 v128, v128
    v_rcp_f32 v129, v129
    v_rcp_f32 v130, v130
    v_rcp_f32 v131, v131
    v_rcp_f32 v132, v132
    v_rcp_f32 v133, v133
    v_rcp_f32 v134, v134
    v_rcp_f32 v135, v135
    v_pk_mul_f32 v[48:49], v[48:49], v[56:57]
    v_pk_mul_f32 v[50:51], v[50:51], v[58:59]
    v_pk_mul_f32 v[52:53], v[52:53], v[60:61]
    v_pk_mul_f32 v[54:55], v[54:55], v[62:63]
    v_pk_mul_f32 v[48:49], v[48:49], v[128:129]
    v_pk_mul_f32 v[50:51], v[50:51], v[130:131]
    v_pk_mul_f32 v[52:53], v[52:53], v[132:133]
    v_pk_mul_f32 v[54:55], v[54:55], v[134:135]
    v_cvt_pk_bf16_f32 v144, v48, v49
    v_cvt_pk_bf16_f32 v145, v50, v51
    v_cvt_pk_bf16_f32 v148, v52, v53
    v_cvt_pk_bf16_f32 v149, v54, v55
    s_cmp_ge_u32 s48, 105
    s_cbranch_scc1 Ltl_flast
    s_waitcnt lgkmcnt(4)
    v_pk_fma_f32 v[64:65], v[176:177], v[232:233], v[64:65] op_sel_hi:[1,0,1] neg_lo:[0,1,0] neg_hi:[0,1,0]
    v_pk_fma_f32 v[66:67], v[178:179], v[232:233], v[66:67] op_sel_hi:[1,0,1] neg_lo:[0,1,0] neg_hi:[0,1,0]
    v_pk_fma_f32 v[68:69], v[176:177], v[240:241], v[68:69] op_sel_hi:[1,0,1] neg_lo:[0,1,0] neg_hi:[0,1,0]
    v_pk_fma_f32 v[70:71], v[178:179], v[240:241], v[70:71] op_sel_hi:[1,0,1] neg_lo:[0,1,0] neg_hi:[0,1,0]
    v_pk_mul_f32 v[128:129], v[64:65], v[64:65]
    v_pk_mul_f32 v[130:131], v[66:67], v[66:67]
    v_pk_mul_f32 v[132:133], v[68:69], v[68:69]
    v_pk_mul_f32 v[134:135], v[70:71], v[70:71]
    v_pk_fma_f32 v[128:129], v[128:129], v[236:237], v[234:235] op_sel_hi:[1,0,0]
    v_pk_fma_f32 v[130:131], v[130:131], v[236:237], v[234:235] op_sel_hi:[1,0,0]
    v_pk_fma_f32 v[132:133], v[132:133], v[244:245], v[242:243] op_sel_hi:[1,0,0]
    v_pk_fma_f32 v[134:135], v[134:135], v[244:245], v[242:243] op_sel_hi:[1,0,0]
    v_pk_mul_f32 v[128:129], v[128:129], v[64:65]
    v_pk_mul_f32 v[130:131], v[130:131], v[66:67]
    v_pk_mul_f32 v[132:133], v[132:133], v[68:69]
    v_pk_mul_f32 v[134:135], v[134:135], v[70:71]
    v_exp_f32 v128, v128
    v_exp_f32 v129, v129
    v_exp_f32 v130, v130
    v_exp_f32 v131, v131
    v_exp_f32 v132, v132
    v_exp_f32 v133, v133
    v_exp_f32 v134, v134
    v_exp_f32 v135, v135
    v_pk_fma_f32 v[72:73], v[180:181], v[232:233], v[72:73] op_sel_hi:[1,0,1] neg_lo:[0,1,0] neg_hi:[0,1,0]
    v_pk_fma_f32 v[74:75], v[182:183], v[232:233], v[74:75] op_sel_hi:[1,0,1] neg_lo:[0,1,0] neg_hi:[0,1,0]
    v_pk_fma_f32 v[76:77], v[180:181], v[240:241], v[76:77] op_sel_hi:[1,0,1] neg_lo:[0,1,0] neg_hi:[0,1,0]
    v_pk_fma_f32 v[78:79], v[182:183], v[240:241], v[78:79] op_sel_hi:[1,0,1] neg_lo:[0,1,0] neg_hi:[0,1,0]
    v_pk_fma_f32 v[128:129], v[128:129], v[238:239], v[238:239] op_sel_hi:[1,0,0]
    v_pk_fma_f32 v[130:131], v[130:131], v[238:239], v[238:239] op_sel_hi:[1,0,0]
    v_pk_fma_f32 v[132:133], v[132:133], v[246:247], v[246:247] op_sel_hi:[1,0,0]
    v_pk_fma_f32 v[134:135], v[134:135], v[246:247], v[246:247] op_sel_hi:[1,0,0]
    v_rcp_f32 v128, v128
    v_rcp_f32 v129, v129
    v_rcp_f32 v130, v130
    v_rcp_f32 v131, v131
    v_rcp_f32 v132, v132
    v_rcp_f32 v133, v133
    v_rcp_f32 v134, v134
    v_rcp_f32 v135, v135
    v_pk_mul_f32 v[64:65], v[64:65], v[72:73]
    v_pk_mul_f32 v[66:67], v[66:67], v[74:75]
    v_pk_mul_f32 v[68:69], v[68:69], v[76:77]
    v_pk_mul_f32 v[70:71], v[70:71], v[78:79]
    v_pk_mul_f32 v[64:65], v[64:65], v[128:129]
    v_pk_mul_f32 v[66:67], v[66:67], v[130:131]
    v_pk_mul_f32 v[68:69], v[68:69], v[132:133]
    v_pk_mul_f32 v[70:71], v[70:71], v[134:135]
    v_cvt_pk_bf16_f32 v146, v64, v65
    v_cvt_pk_bf16_f32 v147, v66, v67
    v_cvt_pk_bf16_f32 v150, v68, v69
    v_cvt_pk_bf16_f32 v151, v70, v71
    s_nop 1
    v_permlane16_swap_b32 v144, v146
    v_permlane16_swap_b32 v145, v147
    buffer_store_dwordx4 v[144:147], v248, s[12:15], s43 offen offset:1024 sc1
    v_permlane16_swap_b32 v148, v150
    v_permlane16_swap_b32 v149, v151
    buffer_store_dwordx4 v[148:151], v248, s[12:15], s50 offen offset:1024 sc1
    s_waitcnt lgkmcnt(4)
    v_pk_fma_f32 v[80:81], v[152:153], v[232:233], v[80:81] op_sel_hi:[1,0,1] neg_lo:[0,1,0] neg_hi:[0,1,0]
    v_pk_fma_f32 v[82:83], v[154:155], v[232:233], v[82:83] op_sel_hi:[1,0,1] neg_lo:[0,1,0] neg_hi:[0,1,0]
    v_pk_fma_f32 v[84:85], v[152:153], v[240:241], v[84:85] op_sel_hi:[1,0,1] neg_lo:[0,1,0] neg_hi:[0,1,0]
    v_pk_fma_f32 v[86:87], v[154:155], v[240:241], v[86:87] op_sel_hi:[1,0,1] neg_lo:[0,1,0] neg_hi:[0,1,0]
    v_pk_mul_f32 v[128:129], v[80:81], v[80:81]
    v_pk_mul_f32 v[130:131], v[82:83], v[82:83]
    v_pk_mul_f32 v[132:133], v[84:85], v[84:85]
    v_pk_mul_f32 v[134:135], v[86:87], v[86:87]
    v_pk_fma_f32 v[128:129], v[128:129], v[236:237], v[234:235] op_sel_hi:[1,0,0]
    v_pk_fma_f32 v[130:131], v[130:131], v[236:237], v[234:235] op_sel_hi:[1,0,0]
    v_pk_fma_f32 v[132:133], v[132:133], v[244:245], v[242:243] op_sel_hi:[1,0,0]
    v_pk_fma_f32 v[134:135], v[134:135], v[244:245], v[242:243] op_sel_hi:[1,0,0]
    v_pk_mul_f32 v[128:129], v[128:129], v[80:81]
    v_pk_mul_f32 v[130:131], v[130:131], v[82:83]
    v_pk_mul_f32 v[132:133], v[132:133], v[84:85]
    v_pk_mul_f32 v[134:135], v[134:135], v[86:87]
    v_exp_f32 v128, v128
    v_exp_f32 v129, v129
    v_exp_f32 v130, v130
    v_exp_f32 v131, v131
    v_exp_f32 v132, v132
    v_exp_f32 v133, v133
    v_exp_f32 v134, v134
    v_exp_f32 v135, v135
    v_pk_fma_f32 v[88:89], v[156:157], v[232:233], v[88:89] op_sel_hi:[1,0,1] neg_lo:[0,1,0] neg_hi:[0,1,0]
    v_pk_fma_f32 v[90:91], v[158:159], v[232:233], v[90:91] op_sel_hi:[1,0,1] neg_lo:[0,1,0] neg_hi:[0,1,0]
    v_pk_fma_f32 v[92:93], v[156:157], v[240:241], v[92:93] op_sel_hi:[1,0,1] neg_lo:[0,1,0] neg_hi:[0,1,0]
    v_pk_fma_f32 v[94:95], v[158:159], v[240:241], v[94:95] op_sel_hi:[1,0,1] neg_lo:[0,1,0] neg_hi:[0,1,0]
    v_pk_fma_f32 v[128:129], v[128:129], v[238:239], v[238:239] op_sel_hi:[1,0,0]
    v_pk_fma_f32 v[130:131], v[130:131], v[238:239], v[238:239] op_sel_hi:[1,0,0]
    v_pk_fma_f32 v[132:133], v[132:133], v[246:247], v[246:247] op_sel_hi:[1,0,0]
    v_pk_fma_f32 v[134:135], v[134:135], v[246:247], v[246:247] op_sel_hi:[1,0,0]
    v_rcp_f32 v128, v128
    v_rcp_f32 v129, v129
    v_rcp_f32 v130, v130
    v_rcp_f32 v131, v131
    v_rcp_f32 v132, v132
    v_rcp_f32 v133, v133
    v_rcp_f32 v134, v134
    v_rcp_f32 v135, v135
    v_pk_mul_f32 v[80:81], v[80:81], v[88:89]
    v_pk_mul_f32 v[82:83], v[82:83], v[90:91]
    v_pk_mul_f32 v[84:85], v[84:85], v[92:93]
    v_pk_mul_f32 v[86:87], v[86:87], v[94:95]
    v_pk_mul_f32 v[80:81], v[80:81], v[128:129]
    v_pk_mul_f32 v[82:83], v[82:83], v[130:131]
    v_pk_mul_f32 v[84:85], v[84:85], v[132:133]
    v_pk_mul_f32 v[86:87], v[86:87], v[134:135]
    v_cvt_pk_bf16_f32 v136, v80, v81
    v_cvt_pk_bf16_f32 v137, v82, v83
    v_cvt_pk_bf16_f32 v140, v84, v85
    v_cvt_pk_bf16_f32 v141, v86, v87
    s_waitcnt lgkmcnt(2)
    v_pk_fma_f32 v[96:97], v[160:161], v[232:233], v[96:97] op_sel_hi:[1,0,1] neg_lo:[0,1,0] neg_hi:[0,1,0]
    v_pk_fma_f32 v[98:99], v[162:163], v[232:233], v[98:99] op_sel_hi:[1,0,1] neg_lo:[0,1,0] neg_hi:[0,1,0]
    v_pk_fma_f32 v[100:101], v[160:161], v[240:241], v[100:101] op_sel_hi:[1,0,1] neg_lo:[0,1,0] neg_hi:[0,1,0]
    v_pk_fma_f32 v[102:103], v[162:163], v[240:241], v[102:103] op_sel_hi:[1,0,1] neg_lo:[0,1,0] neg_hi:[0,1,0]
    v_pk_mul_f32 v[128:129], v[96:97], v[96:97]
    v_pk_mul_f32 v[130:131], v[98:99], v[98:99]
    v_pk_mul_f32 v[132:133], v[100:101], v[100:101]
    v_pk_mul_f32 v[134:135], v[102:103], v[102:103]
    v_pk_fma_f32 v[128:129], v[128:129], v[236:237], v[234:235] op_sel_hi:[1,0,0]
    v_pk_fma_f32 v[130:131], v[130:131], v[236:237], v[234:235] op_sel_hi:[1,0,0]
    v_pk_fma_f32 v[132:133], v[132:133], v[244:245], v[242:243] op_sel_hi:[1,0,0]
    v_pk_fma_f32 v[134:135], v[134:135], v[244:245], v[242:243] op_sel_hi:[1,0,0]
    v_pk_mul_f32 v[128:129], v[128:129], v[96:97]
    v_pk_mul_f32 v[130:131], v[130:131], v[98:99]
    v_pk_mul_f32 v[132:133], v[132:133], v[100:101]
    v_pk_mul_f32 v[134:135], v[134:135], v[102:103]
    v_exp_f32 v128, v128
    v_exp_f32 v129, v129
    v_exp_f32 v130, v130
    v_exp_f32 v131, v131
    v_exp_f32 v132, v132
    v_exp_f32 v133, v133
    v_exp_f32 v134, v134
    v_exp_f32 v135, v135
    v_pk_fma_f32 v[104:105], v[164:165], v[232:233], v[104:105] op_sel_hi:[1,0,1] neg_lo:[0,1,0] neg_hi:[0,1,0]
    v_pk_fma_f32 v[106:107], v[166:167], v[232:233], v[106:107] op_sel_hi:[1,0,1] neg_lo:[0,1,0] neg_hi:[0,1,0]
    v_pk_fma_f32 v[108:109], v[164:165], v[240:241], v[108:109] op_sel_hi:[1,0,1] neg_lo:[0,1,0] neg_hi:[0,1,0]
    v_pk_fma_f32 v[110:111], v[166:167], v[240:241], v[110:111] op_sel_hi:[1,0,1] neg_lo:[0,1,0] neg_hi:[0,1,0]
    v_pk_fma_f32 v[128:129], v[128:129], v[238:239], v[238:239] op_sel_hi:[1,0,0]
    v_pk_fma_f32 v[130:131], v[130:131], v[238:239], v[238:239] op_sel_hi:[1,0,0]
    v_pk_fma_f32 v[132:133], v[132:133], v[246:247], v[246:247] op_sel_hi:[1,0,0]
    v_pk_fma_f32 v[134:135], v[134:135], v[246:247], v[246:247] op_sel_hi:[1,0,0]
    v_rcp_f32 v128, v128
    v_rcp_f32 v129, v129
    v_rcp_f32 v130, v130
    v_rcp_f32 v131, v131
    v_rcp_f32 v132, v132
    v_rcp_f32 v133, v133
    v_rcp_f32 v134, v134
    v_rcp_f32 v135, v135
    v_pk_mul_f32 v[96:97], v[96:97], v[104:105]
    v_pk_mul_f32 v[98:99], v[98:99], v[106:107]
    v_pk_mul_f32 v[100:101], v[100:101], v[108:109]
    v_pk_mul_f32 v[102:103], v[102:103], v[110:111]
    v_pk_mul_f32 v[96:97], v[96:97], v[128:129]
    v_pk_mul_f32 v[98:99], v[98:99], v[130:131]
    v_pk_mul_f32 v[100:101], v[100:101], v[132:133]
    v_pk_mul_f32 v[102:103], v[102:103], v[134:135]
    v_cvt_pk_bf16_f32 v138, v96, v97
    v_cvt_pk_bf16_f32 v139, v98, v99
    v_cvt_pk_bf16_f32 v142, v100, v101
    v_cvt_pk_bf16_f32 v143, v102, v103
    s_nop 1
    v_permlane16_swap_b32 v136, v138
    v_permlane16_swap_b32 v137, v139
    buffer_store_dwordx4 v[136:139], v248, s[12:15], s43 offen offset:2048 sc1
    v_permlane16_swap_b32 v140, v142
    v_permlane16_swap_b32 v141, v143
    buffer_store_dwordx4 v[140:143], v248, s[12:15], s50 offen offset:2048 sc1
    s_waitcnt lgkmcnt(0)
    v_pk_fma_f32 v[112:113], v[168:169], v[232:233], v[112:113] op_sel_hi:[1,0,1] neg_lo:[0,1,0] neg_hi:[0,1,0]
    v_pk_fma_f32 v[114:115], v[170:171], v[232:233], v[114:115] op_sel_hi:[1,0,1] neg_lo:[0,1,0] neg_hi:[0,1,0]
    v_pk_fma_f32 v[116:117], v[168:169], v[240:241], v[116:117] op_sel_hi:[1,0,1] neg_lo:[0,1,0] neg_hi:[0,1,0]
    v_pk_fma_f32 v[118:119], v[170:171], v[240:241], v[118:119] op_sel_hi:[1,0,1] neg_lo:[0,1,0] neg_hi:[0,1,0]
    v_pk_mul_f32 v[128:129], v[112:113], v[112:113]
    v_pk_mul_f32 v[130:131], v[114:115], v[114:115]
    v_pk_mul_f32 v[132:133], v[116:117], v[116:117]
    v_pk_mul_f32 v[134:135], v[118:119], v[118:119]
    v_pk_fma_f32 v[128:129], v[128:129], v[236:237], v[234:235] op_sel_hi:[1,0,0]
    v_pk_fma_f32 v[130:131], v[130:131], v[236:237], v[234:235] op_sel_hi:[1,0,0]
    v_pk_fma_f32 v[132:133], v[132:133], v[244:245], v[242:243] op_sel_hi:[1,0,0]
    v_pk_fma_f32 v[134:135], v[134:135], v[244:245], v[242:243] op_sel_hi:[1,0,0]
    v_pk_mul_f32 v[128:129], v[128:129], v[112:113]
    v_pk_mul_f32 v[130:131], v[130:131], v[114:115]
    v_pk_mul_f32 v[132:133], v[132:133], v[116:117]
    v_pk_mul_f32 v[134:135], v[134:135], v[118:119]
    v_exp_f32 v128, v128
    v_exp_f32 v129, v129
    v_exp_f32 v130, v130
    v_exp_f32 v131, v131
    v_exp_f32 v132, v132
    v_exp_f32 v133, v133
    v_exp_f32 v134, v134
    v_exp_f32 v135, v135
    v_pk_fma_f32 v[120:121], v[172:173], v[232:233], v[120:121] op_sel_hi:[1,0,1] neg_lo:[0,1,0] neg_hi:[0,1,0]
    v_pk_fma_f32 v[122:123], v[174:175], v[232:233], v[122:123] op_sel_hi:[1,0,1] neg_lo:[0,1,0] neg_hi:[0,1,0]
    v_pk_fma_f32 v[124:125], v[172:173], v[240:241], v[124:125] op_sel_hi:[1,0,1] neg_lo:[0,1,0] neg_hi:[0,1,0]
    v_pk_fma_f32 v[126:127], v[174:175], v[240:241], v[126:127] op_sel_hi:[1,0,1] neg_lo:[0,1,0] neg_hi:[0,1,0]
    v_pk_fma_f32 v[128:129], v[128:129], v[238:239], v[238:239] op_sel_hi:[1,0,0]
    v_pk_fma_f32 v[130:131], v[130:131], v[238:239], v[238:239] op_sel_hi:[1,0,0]
    v_pk_fma_f32 v[132:133], v[132:133], v[246:247], v[246:247] op_sel_hi:[1,0,0]
    v_pk_fma_f32 v[134:135], v[134:135], v[246:247], v[246:247] op_sel_hi:[1,0,0]
    v_rcp_f32 v128, v128
    v_rcp_f32 v129, v129
    v_rcp_f32 v130, v130
    v_rcp_f32 v131, v131
    v_rcp_f32 v132, v132
    v_rcp_f32 v133, v133
    v_rcp_f32 v134, v134
    v_rcp_f32 v135, v135
    v_pk_mul_f32 v[112:113], v[112:113], v[120:121]
    v_pk_mul_f32 v[114:115], v[114:115], v[122:123]
    v_pk_mul_f32 v[116:117], v[116:117], v[124:125]
    v_pk_mul_f32 v[118:119], v[118:119], v[126:127]
    v_pk_mul_f32 v[112:113], v[112:113], v[128:129]
    v_pk_mul_f32 v[114:115], v[114:115], v[130:131]
    v_pk_mul_f32 v[116:117], v[116:117], v[132:133]
    v_pk_mul_f32 v[118:119], v[118:119], v[134:135]
    v_cvt_pk_bf16_f32 v144, v112, v113
    v_cvt_pk_bf16_f32 v145, v114, v115
    v_cvt_pk_bf16_f32 v148, v116, v117
    v_cvt_pk_bf16_f32 v149, v118, v119
    buffer_store_dwordx2 v[144:145], v249, s[12:15], s43 offen offset:3072 sc1
    buffer_store_dwordx2 v[148:149], v249, s[12:15], s50 offen offset:3072 sc1
    s_branch Ltl_fdone
Ltl_flast:
    buffer_store_dwordx2 v[144:145], v249, s[12:15], s43 offen offset:1024 sc1
    buffer_store_dwordx2 v[148:149], v249, s[12:15], s50 offen offset:1024 sc1
Ltl_fdone:
    v_add_u32 v7, 4096, v3
    s_mul_i32 s51, s16, 55296
    s_add_u32 s32, s16, 1
    s_and_b32 s52, s32, 3
    s_add_u32 s32, s16, 2
    s_and_b32 s53, s32, 3
    s_add_u32 s32, s16, 3
    s_and_b32 s54, s32, 3
    v_add_u32 v29, s51, v3
    s_mul_i32 s32, s52, 55296
    v_add_u32 v4, s32, v3
    s_mul_i32 s32, s53, 55296
    v_add_u32 v5, s32, v3
    s_mul_i32 s32, s54, 55296
    v_add_u32 v6, s32, v3
    s_mul_i32 s34, s18, 56
    s_add_u32 s34, s34, s16
    s_add_u32 s34, s34, 16
    s_mul_i32 s34, s34, 5120
    s_add_u32 s34, s34, 29884416
    s_mul_i32 s35, s17, 221184
    s_lshl_b32 s32, s16, 10
    s_add_u32 s35, s35, s32
    s_add_u32 s35, s35, 16777216
    s_mul_i32 s39, s18, 160
    v_lshrrev_b32 v10, 4, v2
    v_and_b32 v11, 15, v2
    v_lshrrev_b32 v12, 1, v10
    v_lshlrev_b32 v14, 8, v12
    v_lshl_add_u32 v14, v11, 4, v14
    v_and_b32 v12, 1, v10
    v_lshl_add_u32 v13, v12, 9, v14
    v_lshl_add_u32 v14, v12, 3, v14
    v_mul_u32_u24 v15, 160, v11
    v_lshl_add_u32 v15, v10, 3, v15
    s_mul_i32 s43, s16, 2560
    s_add_u32 s43, s43, 30720
    v_add_u32 v15, s43, v15
    s_lshl_b32 s40, s17, 2
    s_add_u32 s40, s40, s16
    s_mul_i32 s40, s40, 20480
    s_mul_i32 s32, s18, 2560
    s_add_u32 s40, s40, s32
    s_add_u32 s40, s40, 11534336
    s_lshl_b32 s41, s17, 2
    s_add_u32 s41, s41, s16
    s_mul_i32 s41, s41, 20480
    s_add_u32 s41, s41, s39
    s_mov_b32 s33, 6554
    s_mul_i32 s32, s52, 15360
    s_add_u32 s32, s32, 81920
    v_add_u32 v8, s32, v3
    s_mul_i32 s32, s53, 15360
    s_add_u32 s32, s32, 81920
    v_add_u32 v30, s32, v3
    s_mul_i32 s32, s54, 15360
    s_add_u32 s32, s32, 81920
    v_add_u32 v31, s32, v3
    s_mul_i32 s32, s16, 15360
    s_add_u32 s32, s32, 81920
    v_add_u32 v9, s32, v3
    s_mul_i32 s32, s16, 20480
    s_add_u32 s32, s32, 0
    v_add_u32 v1, s32, v3
    v_add_u32 v10, 0, v2
    v_mul_u32_u24 v11, s33, v10
    v_lshrrev_b32 v11, 16, v11
    v_mad_i32_i24 v10, v11, -10, v10
    v_mul_u32_u24 v11, 1280, v11
    v_lshl_add_u32 v26, v10, 4, v11
    v_add_u32 v10, 64, v2
    v_mul_u32_u24 v11, s33, v10
    v_lshrrev_b32 v11, 16, v11
    v_mad_i32_i24 v10, v11, -10, v10
    v_mul_u32_u24 v11, 1280, v11
    v_lshl_add_u32 v27, v10, 4, v11
    v_add_u32 v10, 128, v2
    v_mul_u32_u24 v11, s33, v10
    v_lshrrev_b32 v11, 16, v11
    v_mad_i32_i24 v10, v11, -10, v10
    v_mul_u32_u24 v11, 1280, v11
    v_lshl_add_u32 v28, v10, 4, v11
    s_waitcnt vmcnt(0)
    s_barrier
    s_cmp_lg_u32 s16, 0
    s_cbranch_scc1 Ltl_c2
    s_lshl_b32 s32, s28, 8
    s_add_u32 s32, s32, 15073280
    v_mov_b32 v10, 0
    v_mov_b32 v11, 1
    s_mov_b64 exec, 1
    buffer_atomic_add v11, v10, s[12:15], s32 offen sc1
    s_mov_b64 exec, -1
Ltl_c2:
    s_cmp_lg_u32 s16, 1
    s_cbranch_scc1 Ltl_c3
    s_lshl_b32 s32, s29, 8
    s_add_u32 s32, s32, 15073280
    s_mov_b32 s57, 2097152
    v_mov_b32 v10, 0
Ltl_pb:
    buffer_load_dword v11, v10, s[12:15], s32 offen sc1
    s_sub_u32 s57, s57, 1
    s_cbranch_scc1 Ltl_pbd
    s_waitcnt vmcnt(0)
    v_readfirstlane_b32 s49, v11
    s_cmp_ge_u32 s49, 16
    s_cbranch_scc1 Ltl_pbd
    s_sleep 1
    s_branch Ltl_pb
Ltl_pbd:
    s_waitcnt vmcnt(0)
Ltl_c3:
    s_barrier
    s_mul_i32 s35, s17, 221184
    s_add_u32 s35, s35, 16777216
    v_add_u32 v4, 61440, v3
    v_add_u32 v5, 122880, v3
    buffer_load_dwordx4 v[32:35], v29, s[12:15], s35 offen offset:0 sc1
    buffer_load_dwordx4 v[36:39], v29, s[12:15], s35 offen offset:1024 sc1
    buffer_load_dwordx4 v[40:43], v29, s[12:15], s35 offen offset:2048 sc1
    buffer_load_dwordx4 v[44:47], v29, s[12:15], s35 offen offset:3072 sc1
    s_add_u32 s35, s35, 4096
    buffer_load_dwordx4 v[48:51], v29, s[12:15], s35 offen offset:0 sc1
    buffer_load_dwordx4 v[52:55], v29, s[12:15], s35 offen offset:1024 sc1
    buffer_load_dwordx4 v[56:59], v29, s[12:15], s35 offen offset:2048 sc1
    buffer_load_dwordx4 v[60:63], v29, s[12:15], s35 offen offset:3072 sc1
    s_add_u32 s35, s35, 4096
    buffer_load_dwordx4 v[64:67], v29, s[12:15], s35 offen offset:0 sc1
    buffer_load_dwordx4 v[68:71], v29, s[12:15], s35 offen offset:1024 sc1
    buffer_load_dwordx4 v[72:75], v29, s[12:15], s35 offen offset:2048 sc1
    buffer_load_dwordx4 v[76:79], v29, s[12:15], s35 offen offset:3072 sc1
    s_add_u32 s35, s35, 4096
    buffer_load_dwordx4 v[80:83], v29, s[12:15], s35 offen offset:0 sc1
    buffer_load_dwordx4 v[84:87], v29, s[12:15], s35 offen offset:1024 sc1
    buffer_load_dwordx4 v[88:91], v29, s[12:15], s35 offen offset:2048 sc1
    buffer_load_dwordx4 v[92:95], v29, s[12:15], s35 offen offset:3072 sc1
    s_add_u32 s35, s35, 4096
    buffer_load_dwordx4 v[96:99], v29, s[12:15], s35 offen offset:0 sc1
    buffer_load_dwordx4 v[100:103], v29, s[12:15], s35 offen offset:1024 sc1
    buffer_load_dwordx4 v[104:107], v29, s[12:15], s35 offen offset:2048 sc1
    ds_read_b128 v[112:115], v3 offset:0
    ds_read_b128 v[116:119], v3 offset:1024
    ds_read_b128 v[120:123], v3 offset:2048
    ds_read_b128 v[124:127], v3 offset:3072
    ds_read_b128 v[128:131], v3 offset:4096
    ds_read_b128 v[132:135], v3 offset:5120
    ds_read_b128 v[136:139], v3 offset:6144
    ds_read_b128 v[140:143], v3 offset:7168
    ds_read_b128 v[144:147], v3 offset:8192
    ds_read_b128 v[148:151], v3 offset:9216
    s_waitcnt vmcnt(18) lgkmcnt(5)
    v_mfma_f32_16x16x32_bf16 v[176:179], v[112:115], v[32:35], 0
    ds_read_b128 v[152:155], v3 offset:10240
    buffer_load_dwordx4 v[108:111], v29, s[12:15], s35 offen offset:3072 sc1
    s_add_u32 s35, s35, 4096
    v_mfma_f32_16x16x32_bf16 v[180:183], v[116:119], v[32:35], 0
    ds_read_b128 v[156:159], v3 offset:11264
    v_mfma_f32_16x16x32_bf16 v[184:187], v[120:123], v[32:35], 0
    ds_read_b128 v[160:163], v3 offset:12288
    v_mfma_f32_16x16x32_bf16 v[188:191], v[124:127], v[32:35], 0
    ds_read_b128 v[164:167], v3 offset:13312
    v_mfma_f32_16x16x32_bf16 v[192:195], v[128:131], v[32:35], 0
    ds_read_b128 v[168:171], v3 offset:14336
    s_waitcnt vmcnt(18) lgkmcnt(5)
    v_mfma_f32_16x16x32_bf16 v[176:179], v[132:135], v[36:39], v[176:179]
    ds_read_b128 v[112:115], v3 offset:15360
    buffer_load_dwordx4 v[32:35], v29, s[12:15], s35 offen offset:0 sc1
    v_mfma_f32_16x16x32_bf16 v[180:183], v[136:139], v[36:39], v[180:183]
    ds_read_b128 v[116:119], v3 offset:16384
    v_mfma_f32_16x16x32_bf16 v[184:187], v[140:143], v[36:39], v[184:187]
    ds_read_b128 v[120:123], v3 offset:17408
    v_mfma_f32_16x16x32_bf16 v[188:191], v[144:147], v[36:39], v[188:191]
    ds_read_b128 v[124:127], v3 offset:18432
    v_mfma_f32_16x16x32_bf16 v[192:195], v[148:151], v[36:39], v[192:195]
    ds_read_b128 v[128:131], v3 offset:19456
    s_waitcnt vmcnt(18) lgkmcnt(5)
    v_mfma_f32_16x16x32_bf16 v[176:179], v[152:155], v[40:43], v[176:179]
    ds_read_b128 v[132:135], v3 offset:20480
    buffer_load_dwordx4 v[36:39], v29, s[12:15], s35 offen offset:1024 sc1
    v_mfma_f32_16x16x32_bf16 v[180:183], v[156:159], v[40:43], v[180:183]
    ds_read_b128 v[136:139], v3 offset:21504
    v_mfma_f32_16x16x32_bf16 v[184:187], v[160:163], v[40:43], v[184:187]
    ds_read_b128 v[140:143], v3 offset:22528
    v_mfma_f32_16x16x32_bf16 v[188:191], v[164:167], v[40:43], v[188:191]
    ds_read_b128 v[144:147], v3 offset:23552
    v_mfma_f32_16x16x32_bf16 v[192:195], v[168:171], v[40:43], v[192:195]
    ds_read_b128 v[148:151], v3 offset:24576
    s_waitcnt vmcnt(18) lgkmcnt(5)
    v_mfma_f32_16x16x32_bf16 v[176:179], v[112:115], v[44:47], v[176:179]
    ds_read_b128 v[152:155], v3 offset:25600
    buffer_load_dwordx4 v[40:43], v29, s[12:15], s35 offen offset:2048 sc1
    v_mfma_f32_16x16x32_bf16 v[180:183], v[116:119], v[44:47], v[180:183]
    ds_read_b128 v[156:159], v3 offset:26624
    v_mfma_f32_16x16x32_bf16 v[184:187], v[120:123], v[44:47], v[184:187]
    ds_read_b128 v[160:163], v3 offset:27648
    v_mfma_f32_16x16x32_bf16 v[188:191], v[124:127], v[44:47], v[188:191]
    ds_read_b128 v[164:167], v3 offset:28672
    v_mfma_f32_16x16x32_bf16 v[192:195], v[128:131], v[44:47], v[192:195]
    ds_read_b128 v[168:171], v3 offset:29696
    s_waitcnt vmcnt(18) lgkmcnt(0)
    s_barrier
    v_mfma_f32_16x16x32_bf16 v[176:179], v[132:135], v[48:51], v[176:179]
    ds_read_b128 v[112:115], v3 offset:30720
    buffer_load_dwordx4 v[44:47], v29, s[12:15], s35 offen offset:3072 sc1
    s_add_u32 s35, s35, 4096
    v_mfma_f32_16x16x32_bf16 v[180:183], v[136:139], v[48:51], v[180:183]
    ds_read_b128 v[116:119], v3 offset:31744
    v_mfma_f32_16x16x32_bf16 v[184:187], v[140:143], v[48:51], v[184:187]
    ds_read_b128 v[120:123], v3 offset:32768
    v_mfma_f32_16x16x32_bf16 v[188:191], v[144:147], v[48:51], v[188:191]
    ds_read_b128 v[124:127], v3 offset:33792
    v_mfma_f32_16x16x32_bf16 v[192:195], v[148:151], v[48:51], v[192:195]
    ds_read_b128 v[128:131], v3 offset:34816
    s_waitcnt vmcnt(18) lgkmcnt(5)
    v_mfma_f32_16x16x32_bf16 v[176:179], v[152:155], v[52:55], v[176:179]
    ds_read_b128 v[132:135], v3 offset:35840
    buffer_load_dwordx4 v[48:51], v29, s[12:15], s35 offen offset:0 sc1
    v_mfma_f32_16x16x32_bf16 v[180:183], v[156:159], v[52:55], v[180:183]
    ds_read_b128 v[136:139], v3 offset:36864
    v_mfma_f32_16x16x32_bf16 v[184:187], v[160:163], v[52:55], v[184:187]
    ds_read_b128 v[140:143], v3 offset:37888
    v_mfma_f32_16x16x32_bf16 v[188:191], v[164:167], v[52:55], v[188:191]
    ds_read_b128 v[144:147], v3 offset:38912
    v_mfma_f32_16x16x32_bf16 v[192:195], v[168:171], v[52:55], v[192:195]
    ds_read_b128 v[148:151], v3 offset:39936
    s_waitcnt vmcnt(18) lgkmcnt(5)
    v_mfma_f32_16x16x32_bf16 v[176:179], v[112:115], v[56:59], v[176:179]
    ds_read_b128 v[152:155], v3 offset:40960
    buffer_load_dwordx4 v[52:55], v29, s[12:15], s35 offen offset:1024 sc1
    v_mfma_f32_16x16x32_bf16 v[180:183], v[116:119], v[56:59], v[180:183]
    ds_read_b128 v[156:159], v3 offset:41984
    v_mfma_f32_16x16x32_bf16 v[184:187], v[120:123], v[56:59], v[184:187]
    ds_read_b128 v[160:163], v3 offset:43008
    v_mfma_f32_16x16x32_bf16 v[188:191], v[124:127], v[56:59], v[188:191]
    ds_read_b128 v[164:167], v3 offset:44032
    v_mfma_f32_16x16x32_bf16 v[192:195], v[128:131], v[56:59], v[192:195]
    ds_read_b128 v[168:171], v3 offset:45056
    s_waitcnt vmcnt(18) lgkmcnt(5)
    v_mfma_f32_16x16x32_bf16 v[176:179], v[132:135], v[60:63], v[176:179]
    ds_read_b128 v[112:115], v3 offset:46080
    buffer_load_dwordx4 v[56:59], v29, s[12:15], s35 offen offset:2048 sc1
    v_mfma_f32_16x16x32_bf16 v[180:183], v[136:139], v[60:63], v[180:183]
    ds_read_b128 v[116:119], v3 offset:47104
    v_mfma_f32_16x16x32_bf16 v[184:187], v[140:143], v[60:63], v[184:187]
    ds_read_b128 v[120:123], v3 offset:48128
    v_mfma_f32_16x16x32_bf16 v[188:191], v[144:147], v[60:63], v[188:191]
    ds_read_b128 v[124:127], v3 offset:49152
    v_mfma_f32_16x16x32_bf16 v[192:195], v[148:151], v[60:63], v[192:195]
    ds_read_b128 v[128:131], v3 offset:50176
    s_waitcnt vmcnt(18) lgkmcnt(5)
    v_mfma_f32_16x16x32_bf16 v[176:179], v[152:155], v[64:67], v[176:179]
    ds_read_b128 v[132:135], v3 offset:51200
    buffer_load_dwordx4 v[60:63], v29, s[12:15], s35 offen offset:3072 sc1
    s_add_u32 s35, s35, 4096
    v_mfma_f32_16x16x32_bf16 v[180:183], v[156:159], v[64:67], v[180:183]
    ds_read_b128 v[136:139], v3 offset:52224
    v_mfma_f32_16x16x32_bf16 v[184:187], v[160:163], v[64:67], v[184:187]
    ds_read_b128 v[140:143], v3 offset:53248
    v_mfma_f32_16x16x32_bf16 v[188:191], v[164:167], v[64:67], v[188:191]
    ds_read_b128 v[144:147], v3 offset:54272
    v_mfma_f32_16x16x32_bf16 v[192:195], v[168:171], v[64:67], v[192:195]
    ds_read_b128 v[148:151], v3 offset:55296
    s_waitcnt vmcnt(18) lgkmcnt(5)
    v_mfma_f32_16x16x32_bf16 v[176:179], v[112:115], v[68:71], v[176:179]
    ds_read_b128 v[152:155], v3 offset:56320
    buffer_load_dwordx4 v[64:67], v29, s[12:15], s35 offen offset:0 sc1
    v_mfma_f32_16x16x32_bf16 v[180:183], v[116:119], v[68:71], v[180:183]
    ds_read_b128 v[156:159], v3 offset:57344
    v_mfma_f32_16x16x32_bf16 v[184:187], v[120:123], v[68:71], v[184:187]
    ds_read_b128 v[160:163], v3 offset:58368
    v_mfma_f32_16x16x32_bf16 v[188:191], v[124:127], v[68:71], v[188:191]
    ds_read_b128 v[164:167], v3 offset:59392
    v_mfma_f32_16x16x32_bf16 v[192:195], v[128:131], v[68:71], v[192:195]
    ds_read_b128 v[168:171], v3 offset:60416
    s_waitcnt vmcnt(18) lgkmcnt(0)
    s_barrier
    v_mfma_f32_16x16x32_bf16 v[176:179], v[132:135], v[72:75], v[176:179]
    ds_read_b128 v[112:115], v4 offset:0
    buffer_load_dwordx4 v[68:71], v29, s[12:15], s35 offen offset:1024 sc1
    v_mfma_f32_16x16x32_bf16 v[180:183], v[136:139], v[72:75], v[180:183]
    ds_read_b128 v[116:119], v4 offset:1024
    v_mfma_f32_16x16x32_bf16 v[184:187], v[140:143], v[72:75], v[184:187]
    ds_read_b128 v[120:123], v4 offset:2048
    v_mfma_f32_16x16x32_bf16 v[188:191], v[144:147], v[72:75], v[188:191]
    ds_read_b128 v[124:127], v4 offset:3072
    v_mfma_f32_16x16x32_bf16 v[192:195], v[148:151], v[72:75], v[192:195]
    ds_read_b128 v[128:131], v4 offset:4096
    s_waitcnt vmcnt(18) lgkmcnt(5)
    v_mfma_f32_16x16x32_bf16 v[176:179], v[152:155], v[76:79], v[176:179]
    ds_read_b128 v[132:135], v4 offset:5120
    buffer_load_dwordx4 v[72:75], v29, s[12:15], s35 offen offset:2048 sc1
    v_mfma_f32_16x16x32_bf16 v[180:183], v[156:159], v[76:79], v[180:183]
    ds_read_b128 v[136:139], v4 offset:6144
    v_mfma_f32_16x16x32_bf16 v[184:187], v[160:163], v[76:79], v[184:187]
    ds_read_b128 v[140:143], v4 offset:7168
    v_mfma_f32_16x16x32_bf16 v[188:191], v[164:167], v[76:79], v[188:191]
    ds_read_b128 v[144:147], v4 offset:8192
    v_mfma_f32_16x16x32_bf16 v[192:195], v[168:171], v[76:79], v[192:195]
    ds_read_b128 v[148:151], v4 offset:9216
    s_waitcnt vmcnt(18) lgkmcnt(5)
    v_mfma_f32_16x16x32_bf16 v[176:179], v[112:115], v[80:83], v[176:179]
    ds_read_b128 v[152:155], v4 offset:10240
    buffer_load_dwordx4 v[76:79], v29, s[12:15], s35 offen offset:3072 sc1
    s_add_u32 s35, s35, 4096
    v_mfma_f32_16x16x32_bf16 v[180:183], v[116:119], v[80:83], v[180:183]
    ds_read_b128 v[156:159], v4 offset:11264
    v_mfma_f32_16x16x32_bf16 v[184:187], v[120:123], v[80:83], v[184:187]
    ds_read_b128 v[160:163], v4 offset:12288
    v_mfma_f32_16x16x32_bf16 v[188:191], v[124:127], v[80:83], v[188:191]
    ds_read_b128 v[164:167], v4 offset:13312
    v_mfma_f32_16x16x32_bf16 v[192:195], v[128:131], v[80:83], v[192:195]
    ds_read_b128 v[168:171], v4 offset:14336
    s_waitcnt vmcnt(18) lgkmcnt(5)
    v_mfma_f32_16x16x32_bf16 v[176:179], v[132:135], v[84:87], v[176:179]
    ds_read_b128 v[112:115], v4 offset:15360
    buffer_load_dwordx4 v[80:83], v29, s[12:15], s35 offen offset:0 sc1
    v_mfma_f32_16x16x32_bf16 v[180:183], v[136:139], v[84:87], v[180:183]
    ds_read_b128 v[116:119], v4 offset:16384
    v_mfma_f32_16x16x32_bf16 v[184:187], v[140:143], v[84:87], v[184:187]
    ds_read_b128 v[120:123], v4 offset:17408
    v_mfma_f32_16x16x32_bf16 v[188:191], v[144:147], v[84:87], v[188:191]
    ds_read_b128 v[124:127], v4 offset:18432
    v_mfma_f32_16x16x32_bf16 v[192:195], v[148:151], v[84:87], v[192:195]
    ds_read_b128 v[128:131], v4 offset:19456
    s_waitcnt vmcnt(18) lgkmcnt(5)
    v_mfma_f32_16x16x32_bf16 v[176:179], v[152:155], v[88:91], v[176:179]
    ds_read_b128 v[132:135], v4 offset:20480
    buffer_load_dwordx4 v[84:87], v29, s[12:15], s35 offen offset:1024 sc1
    v_mfma_f32_16x16x32_bf16 v[180:183], v[156:159], v[88:91], v[180:183]
    ds_read_b128 v[136:139], v4 offset:21504
    v_mfma_f32_16x16x32_bf16 v[184:187], v[160:163], v[88:91], v[184:187]
    ds_read_b128 v[140:143], v4 offset:22528
    v_mfma_f32_16x16x32_bf16 v[188:191], v[164:167], v[88:91], v[188:191]
    ds_read_b128 v[144:147], v4 offset:23552
    v_mfma_f32_16x16x32_bf16 v[192:195], v[168:171], v[88:91], v[192:195]
    ds_read_b128 v[148:151], v4 offset:24576
    s_waitcnt vmcnt(18) lgkmcnt(5)
    v_mfma_f32_16x16x32_bf16 v[176:179], v[112:115], v[92:95], v[176:179]
    ds_read_b128 v[152:155], v4 offset:25600
    buffer_load_dwordx4 v[88:91], v29, s[12:15], s35 offen offset:2048 sc1
    v_mfma_f32_16x16x32_bf16 v[180:183], v[116:119], v[92:95], v[180:183]
    ds_read_b128 v[156:159], v4 offset:26624
    v_mfma_f32_16x16x32_bf16 v[184:187], v[120:123], v[92:95], v[184:187]
    ds_read_b128 v[160:163], v4 offset:27648
    v_mfma_f32_16x16x32_bf16 v[188:191], v[124:127], v[92:95], v[188:191]
    ds_read_b128 v[164:167], v4 offset:28672
    v_mfma_f32_16x16x32_bf16 v[192:195], v[128:131], v[92:95], v[192:195]
    ds_read_b128 v[168:171], v4 offset:29696
    s_waitcnt vmcnt(18) lgkmcnt(0)
    s_barrier
    v_mfma_f32_16x16x32_bf16 v[176:179], v[132:135], v[96:99], v[176:179]
    ds_read_b128 v[112:115], v4 offset:30720
    buffer_load_dwordx4 v[92:95], v29, s[12:15], s35 offen offset:3072 sc1
    s_add_u32 s35, s35, 4096
    v_mfma_f32_16x16x32_bf16 v[180:183], v[136:139], v[96:99], v[180:183]
    ds_read_b128 v[116:119], v4 offset:31744
    v_mfma_f32_16x16x32_bf16 v[184:187], v[140:143], v[96:99], v[184:187]
    ds_read_b128 v[120:123], v4 offset:32768
    v_mfma_f32_16x16x32_bf16 v[188:191], v[144:147], v[96:99], v[188:191]
    ds_read_b128 v[124:127], v4 offset:33792
    v_mfma_f32_16x16x32_bf16 v[192:195], v[148:151], v[96:99], v[192:195]
    ds_read_b128 v[128:131], v4 offset:34816
    s_waitcnt vmcnt(18) lgkmcnt(5)
    v_mfma_f32_16x16x32_bf16 v[176:179], v[152:155], v[100:103], v[176:179]
    ds_read_b128 v[132:135], v4 offset:35840
    buffer_load_dwordx4 v[96:99], v29, s[12:15], s35 offen offset:0 sc1
    v_mfma_f32_16x16x32_bf16 v[180:183], v[156:159], v[100:103], v[180:183]
    ds_read_b128 v[136:139], v4 offset:36864
    v_mfma_f32_16x16x32_bf16 v[184:187], v[160:163], v[100:103], v[184:187]
    ds_read_b128 v[140:143], v4 offset:37888
    v_mfma_f32_16x16x32_bf16 v[188:191], v[164:167], v[100:103], v[188:191]
    ds_read_b128 v[144:147], v4 offset:38912
    v_mfma_f32_16x16x32_bf16 v[192:195], v[168:171], v[100:103], v[192:195]
    ds_read_b128 v[148:151], v4 offset:39936
    s_waitcnt vmcnt(18) lgkmcnt(5)
    v_mfma_f32_16x16x32_bf16 v[176:179], v[112:115], v[104:107], v[176:179]
    ds_read_b128 v[152:155], v4 offset:40960
    buffer_load_dwordx4 v[100:103], v29, s[12:15], s35 offen offset:1024 sc1
    v_mfma_f32_16x16x32_bf16 v[180:183], v[116:119], v[104:107], v[180:183]
    ds_read_b128 v[156:159], v4 offset:41984
    v_mfma_f32_16x16x32_bf16 v[184:187], v[120:123], v[104:107], v[184:187]
    ds_read_b128 v[160:163], v4 offset:43008
    v_mfma_f32_16x16x32_bf16 v[188:191], v[124:127], v[104:107], v[188:191]
    ds_read_b128 v[164:167], v4 offset:44032
    v_mfma_f32_16x16x32_bf16 v[192:195], v[128:131], v[104:107], v[192:195]
    ds_read_b128 v[168:171], v4 offset:45056
    s_waitcnt vmcnt(18) lgkmcnt(5)
    v_mfma_f32_16x16x32_bf16 v[176:179], v[132:135], v[108:111], v[176:179]
    ds_read_b128 v[112:115], v4 offset:46080
    buffer_load_dwordx4 v[104:107], v29, s[12:15], s35 offen offset:2048 sc1
    v_mfma_f32_16x16x32_bf16 v[180:183], v[136:139], v[108:111], v[180:183]
    ds_read_b128 v[116:119], v4 offset:47104
    v_mfma_f32_16x16x32_bf16 v[184:187], v[140:143], v[108:111], v[184:187]
    ds_read_b128 v[120:123], v4 offset:48128
    v_mfma_f32_16x16x32_bf16 v[188:191], v[144:147], v[108:111], v[188:191]
    ds_read_b128 v[124:127], v4 offset:49152
    v_mfma_f32_16x16x32_bf16 v[192:195], v[148:151], v[108:111], v[192:195]
    ds_read_b128 v[128:131], v4 offset:50176
    s_waitcnt vmcnt(18) lgkmcnt(5)
    v_mfma_f32_16x16x32_bf16 v[176:179], v[152:155], v[32:35], v[176:179]
    ds_read_b128 v[132:135], v4 offset:51200
    buffer_load_dwordx4 v[108:111], v29, s[12:15], s35 offen offset:3072 sc1
    s_add_u32 s35, s35, 4096
    v_mfma_f32_16x16x32_bf16 v[180:183], v[156:159], v[32:35], v[180:183]
    ds_read_b128 v[136:139], v4 offset:52224
    v_mfma_f32_16x16x32_bf16 v[184:187], v[160:163], v[32:35], v[184:187]
    ds_read_b128 v[140:143], v4 offset:53248
    v_mfma_f32_16x16x32_bf16 v[188:191], v[164:167], v[32:35], v[188:191]
    ds_read_b128 v[144:147], v4 offset:54272
    v_mfma_f32_16x16x32_bf16 v[192:195], v[168:171], v[32:35], v[192:195]
    ds_read_b128 v[148:151], v4 offset:55296
    s_waitcnt vmcnt(18) lgkmcnt(5)
    v_mfma_f32_16x16x32_bf16 v[176:179], v[112:115], v[36:39], v[176:179]
    ds_read_b128 v[152:155], v4 offset:56320
    buffer_load_dwordx4 v[32:35], v29, s[12:15], s35 offen offset:0 sc1
    v_mfma_f32_16x16x32_bf16 v[180:183], v[116:119], v[36:39], v[180:183]
    ds_read_b128 v[156:159], v4 offset:57344
    v_mfma_f32_16x16x32_bf16 v[184:187], v[120:123], v[36:39], v[184:187]
    ds_read_b128 v[160:163], v4 offset:58368
    v_mfma_f32_16x16x32_bf16 v[188:191], v[124:127], v[36:39], v[188:191]
    ds_read_b128 v[164:167], v4 offset:59392
    v_mfma_f32_16x16x32_bf16 v[192:195], v[128:131], v[36:39], v[192:195]
    ds_read_b128 v[168:171], v4 offset:60416
    s_waitcnt vmcnt(18) lgkmcnt(0)
    s_barrier
    v_mfma_f32_16x16x32_bf16 v[176:179], v[132:135], v[40:43], v[176:179]
    ds_read_b128 v[112:115], v5 offset:0
    buffer_load_dwordx4 v[36:39], v29, s[12:15], s35 offen offset:1024 sc1
    v_mfma_f32_16x16x32_bf16 v[180:183], v[136:139], v[40:43], v[180:183]
    ds_read_b128 v[116:119], v5 offset:1024
    v_mfma_f32_16x16x32_bf16 v[184:187], v[140:143], v[40:43], v[184:187]
    ds_read_b128 v[120:123], v5 offset:2048
    v_mfma_f32_16x16x32_bf16 v[188:191], v[144:147], v[40:43], v[188:191]
    ds_read_b128 v[124:127], v5 offset:3072
    v_mfma_f32_16x16x32_bf16 v[192:195], v[148:151], v[40:43], v[192:195]
    ds_read_b128 v[128:131], v5 offset:4096
    s_waitcnt vmcnt(18) lgkmcnt(5)
    v_mfma_f32_16x16x32_bf16 v[176:179], v[152:155], v[44:47], v[176:179]
    ds_read_b128 v[132:135], v5 offset:5120
    buffer_load_dwordx4 v[40:43], v29, s[12:15], s35 offen offset:2048 sc1
    v_mfma_f32_16x16x32_bf16 v[180:183], v[156:159], v[44:47], v[180:183]
    ds_read_b128 v[136:139], v5 offset:6144
    v_mfma_f32_16x16x32_bf16 v[184:187], v[160:163], v[44:47], v[184:187]
    ds_read_b128 v[140:143], v5 offset:7168
    v_mfma_f32_16x16x32_bf16 v[188:191], v[164:167], v[44:47], v[188:191]
    ds_read_b128 v[144:147], v5 offset:8192
    v_mfma_f32_16x16x32_bf16 v[192:195], v[168:171], v[44:47], v[192:195]
    ds_read_b128 v[148:151], v5 offset:9216
    s_waitcnt vmcnt(18) lgkmcnt(5)
    v_mfma_f32_16x16x32_bf16 v[176:179], v[112:115], v[48:51], v[176:179]
    ds_read_b128 v[152:155], v5 offset:10240
    buffer_load_dwordx4 v[44:47], v29, s[12:15], s35 offen offset:3072 sc1
    s_add_u32 s35, s35, 4096
    v_mfma_f32_16x16x32_bf16 v[180:183], v[116:119], v[48:51], v[180:183]
    ds_read_b128 v[156:159], v5 offset:11264
    v_mfma_f32_16x16x32_bf16 v[184:187], v[120:123], v[48:51], v[184:187]
    ds_read_b128 v[160:163], v5 offset:12288
    v_mfma_f32_16x16x32_bf16 v[188:191], v[124:127], v[48:51], v[188:191]
    ds_read_b128 v[164:167], v5 offset:13312
    v_mfma_f32_16x16x32_bf16 v[192:195], v[128:131], v[48:51], v[192:195]
    ds_read_b128 v[168:171], v5 offset:14336
    s_waitcnt vmcnt(18) lgkmcnt(5)
    v_mfma_f32_16x16x32_bf16 v[176:179], v[132:135], v[52:55], v[176:179]
    ds_read_b128 v[112:115], v5 offset:15360
    buffer_load_dwordx4 v[48:51], v29, s[12:15], s35 offen offset:0 sc1
    v_mfma_f32_16x16x32_bf16 v[180:183], v[136:139], v[52:55], v[180:183]
    ds_read_b128 v[116:119], v5 offset:16384
    v_mfma_f32_16x16x32_bf16 v[184:187], v[140:143], v[52:55], v[184:187]
    ds_read_b128 v[120:123], v5 offset:17408
    v_mfma_f32_16x16x32_bf16 v[188:191], v[144:147], v[52:55], v[188:191]
    ds_read_b128 v[124:127], v5 offset:18432
    v_mfma_f32_16x16x32_bf16 v[192:195], v[148:151], v[52:55], v[192:195]
    ds_read_b128 v[128:131], v5 offset:19456
    s_waitcnt vmcnt(18) lgkmcnt(5)
    v_mfma_f32_16x16x32_bf16 v[176:179], v[152:155], v[56:59], v[176:179]
    ds_read_b128 v[132:135], v5 offset:20480
    buffer_load_dwordx4 v[52:55], v29, s[12:15], s35 offen offset:1024 sc1
    v_mfma_f32_16x16x32_bf16 v[180:183], v[156:159], v[56:59], v[180:183]
    ds_read_b128 v[136:139], v5 offset:21504
    v_mfma_f32_16x16x32_bf16 v[184:187], v[160:163], v[56:59], v[184:187]
    ds_read_b128 v[140:143], v5 offset:22528
    v_mfma_f32_16x16x32_bf16 v[188:191], v[164:167], v[56:59], v[188:191]
    ds_read_b128 v[144:147], v5 offset:23552
    v_mfma_f32_16x16x32_bf16 v[192:195], v[168:171], v[56:59], v[192:195]
    ds_read_b128 v[148:151], v5 offset:24576
    s_waitcnt vmcnt(18) lgkmcnt(5)
    v_mfma_f32_16x16x32_bf16 v[176:179], v[112:115], v[60:63], v[176:179]
    ds_read_b128 v[152:155], v5 offset:25600
    buffer_load_dwordx4 v[56:59], v29, s[12:15], s35 offen offset:2048 sc1
    v_mfma_f32_16x16x32_bf16 v[180:183], v[116:119], v[60:63], v[180:183]
    ds_read_b128 v[156:159], v5 offset:26624
    v_mfma_f32_16x16x32_bf16 v[184:187], v[120:123], v[60:63], v[184:187]
    ds_read_b128 v[160:163], v5 offset:27648
    v_mfma_f32_16x16x32_bf16 v[188:191], v[124:127], v[60:63], v[188:191]
    ds_read_b128 v[164:167], v5 offset:28672
    v_mfma_f32_16x16x32_bf16 v[192:195], v[128:131], v[60:63], v[192:195]
    ds_read_b128 v[168:171], v5 offset:29696
    s_waitcnt vmcnt(18) lgkmcnt(0)
    s_barrier
    v_mfma_f32_16x16x32_bf16 v[176:179], v[132:135], v[64:67], v[176:179]
    ds_read_b128 v[112:115], v3 offset:0
    buffer_load_dwordx4 v[60:63], v29, s[12:15], s35 offen offset:3072 sc1
    s_add_u32 s35, s35, 4096
    v_mfma_f32_16x16x32_bf16 v[180:183], v[136:139], v[64:67], v[180:183]
    ds_read_b128 v[116:119], v3 offset:1024
    v_mfma_f32_16x16x32_bf16 v[184:187], v[140:143], v[64:67], v[184:187]
    ds_read_b128 v[120:123], v3 offset:2048
    v_mfma_f32_16x16x32_bf16 v[188:191], v[144:147], v[64:67], v[188:191]
    ds_read_b128 v[124:127], v3 offset:3072
    v_mfma_f32_16x16x32_bf16 v[192:195], v[148:151], v[64:67], v[192:195]
    ds_read_b128 v[128:131], v3 offset:4096
    s_waitcnt vmcnt(18) lgkmcnt(5)
    v_mfma_f32_16x16x32_bf16 v[176:179], v[152:155], v[68:71], v[176:179]
    ds_read_b128 v[132:135], v3 offset:5120
    buffer_load_dwordx4 v[64:67], v29, s[12:15], s35 offen offset:0 sc1
    v_mfma_f32_16x16x32_bf16 v[180:183], v[156:159], v[68:71], v[180:183]
    ds_read_b128 v[136:139], v3 offset:6144
    v_mfma_f32_16x16x32_bf16 v[184:187], v[160:163], v[68:71], v[184:187]
    ds_read_b128 v[140:143], v3 offset:7168
    v_mfma_f32_16x16x32_bf16 v[188:191], v[164:167], v[68:71], v[188:191]
    ds_read_b128 v[144:147], v3 offset:8192
    v_mfma_f32_16x16x32_bf16 v[192:195], v[168:171], v[68:71], v[192:195]
    ds_read_b128 v[148:151], v3 offset:9216
    s_waitcnt vmcnt(18) lgkmcnt(5)
    v_mfma_f32_16x16x32_bf16 v[176:179], v[112:115], v[72:75], v[176:179]
    ds_read_b128 v[152:155], v3 offset:10240
    buffer_load_dwordx4 v[68:71], v29, s[12:15], s35 offen offset:1024 sc1
    v_mfma_f32_16x16x32_bf16 v[180:183], v[116:119], v[72:75], v[180:183]
    ds_read_b128 v[156:159], v3 offset:11264
    v_mfma_f32_16x16x32_bf16 v[184:187], v[120:123], v[72:75], v[184:187]
    ds_read_b128 v[160:163], v3 offset:12288
    v_mfma_f32_16x16x32_bf16 v[188:191], v[124:127], v[72:75], v[188:191]
    ds_read_b128 v[164:167], v3 offset:13312
    v_mfma_f32_16x16x32_bf16 v[192:195], v[128:131], v[72:75], v[192:195]
    ds_read_b128 v[168:171], v3 offset:14336
    s_waitcnt vmcnt(18) lgkmcnt(5)
    v_mfma_f32_16x16x32_bf16 v[176:179], v[132:135], v[76:79], v[176:179]
    ds_read_b128 v[112:115], v3 offset:15360
    buffer_load_dwordx4 v[72:75], v29, s[12:15], s35 offen offset:2048 sc1
    v_mfma_f32_16x16x32_bf16 v[180:183], v[136:139], v[76:79], v[180:183]
    ds_read_b128 v[116:119], v3 offset:16384
    v_mfma_f32_16x16x32_bf16 v[184:187], v[140:143], v[76:79], v[184:187]
    ds_read_b128 v[120:123], v3 offset:17408
    v_mfma_f32_16x16x32_bf16 v[188:191], v[144:147], v[76:79], v[188:191]
    ds_read_b128 v[124:127], v3 offset:18432
    v_mfma_f32_16x16x32_bf16 v[192:195], v[148:151], v[76:79], v[192:195]
    ds_read_b128 v[128:131], v3 offset:19456
    s_waitcnt vmcnt(18) lgkmcnt(5)
    v_mfma_f32_16x16x32_bf16 v[176:179], v[152:155], v[80:83], v[176:179]
    ds_read_b128 v[132:135], v3 offset:20480
    buffer_load_dwordx4 v[76:79], v29, s[12:15], s35 offen offset:3072 sc1
    s_add_u32 s35, s35, 4096
    v_mfma_f32_16x16x32_bf16 v[180:183], v[156:159], v[80:83], v[180:183]
    ds_read_b128 v[136:139], v3 offset:21504
    v_mfma_f32_16x16x32_bf16 v[184:187], v[160:163], v[80:83], v[184:187]
    ds_read_b128 v[140:143], v3 offset:22528
    v_mfma_f32_16x16x32_bf16 v[188:191], v[164:167], v[80:83], v[188:191]
    ds_read_b128 v[144:147], v3 offset:23552
    v_mfma_f32_16x16x32_bf16 v[192:195], v[168:171], v[80:83], v[192:195]
    ds_read_b128 v[148:151], v3 offset:24576
    s_waitcnt vmcnt(18) lgkmcnt(5)
    v_mfma_f32_16x16x32_bf16 v[176:179], v[112:115], v[84:87], v[176:179]
    ds_read_b128 v[152:155], v3 offset:25600
    buffer_load_dwordx4 v[80:83], v29, s[12:15], s35 offen offset:0 sc1
    v_mfma_f32_16x16x32_bf16 v[180:183], v[116:119], v[84:87], v[180:183]
    ds_read_b128 v[156:159], v3 offset:26624
    v_mfma_f32_16x16x32_bf16 v[184:187], v[120:123], v[84:87], v[184:187]
    ds_read_b128 v[160:163], v3 offset:27648
    v_mfma_f32_16x16x32_bf16 v[188:191], v[124:127], v[84:87], v[188:191]
    ds_read_b128 v[164:167], v3 offset:28672
    v_mfma_f32_16x16x32_bf16 v[192:195], v[128:131], v[84:87], v[192:195]
    ds_read_b128 v[168:171], v3 offset:29696
    s_waitcnt vmcnt(18) lgkmcnt(0)
    s_barrier
    v_mfma_f32_16x16x32_bf16 v[176:179], v[132:135], v[88:91], v[176:179]
    ds_read_b128 v[112:115], v3 offset:30720
    buffer_load_dwordx4 v[84:87], v29, s[12:15], s35 offen offset:1024 sc1
    v_mfma_f32_16x16x32_bf16 v[180:183], v[136:139], v[88:91], v[180:183]
    ds_read_b128 v[116:119], v3 offset:31744
    v_mfma_f32_16x16x32_bf16 v[184:187], v[140:143], v[88:91], v[184:187]
    ds_read_b128 v[120:123], v3 offset:32768
    v_mfma_f32_16x16x32_bf16 v[188:191], v[144:147], v[88:91], v[188:191]
    ds_read_b128 v[124:127], v3 offset:33792
    v_mfma_f32_16x16x32_bf16 v[192:195], v[148:151], v[88:91], v[192:195]
    ds_read_b128 v[128:131], v3 offset:34816
    s_waitcnt vmcnt(18) lgkmcnt(5)
    v_mfma_f32_16x16x32_bf16 v[176:179], v[152:155], v[92:95], v[176:179]
    ds_read_b128 v[132:135], v3 offset:35840
    buffer_load_dwordx2 v[16:17], v14, s[12:15], s40 offen offset:0 sc1
    buffer_load_dwordx2 v[18:19], v14, s[12:15], s40 offen offset:512 sc1
    buffer_load_dwordx2 v[20:21], v14, s[12:15], s40 offen offset:1024 sc1
    buffer_load_dwordx2 v[22:23], v14, s[12:15], s40 offen offset:1536 sc1
    buffer_load_dwordx2 v[24:25], v14, s[12:15], s40 offen offset:2048 sc1
    v_mfma_f32_16x16x32_bf16 v[180:183], v[156:159], v[92:95], v[180:183]
    ds_read_b128 v[136:139], v3 offset:36864
    v_mfma_f32_16x16x32_bf16 v[184:187], v[160:163], v[92:95], v[184:187]
    ds_read_b128 v[140:143], v3 offset:37888
    v_mfma_f32_16x16x32_bf16 v[188:191], v[164:167], v[92:95], v[188:191]
    ds_read_b128 v[144:147], v3 offset:38912
    v_mfma_f32_16x16x32_bf16 v[192:195], v[168:171], v[92:95], v[192:195]
    ds_read_b128 v[148:151], v3 offset:39936
    s_waitcnt vmcnt(22) lgkmcnt(5)
    v_mfma_f32_16x16x32_bf16 v[176:179], v[112:115], v[96:99], v[176:179]
    ds_read_b128 v[152:155], v3 offset:40960
    v_mfma_f32_16x16x32_bf16 v[180:183], v[116:119], v[96:99], v[180:183]
    ds_read_b128 v[156:159], v3 offset:41984
    v_mfma_f32_16x16x32_bf16 v[184:187], v[120:123], v[96:99], v[184:187]
    ds_read_b128 v[160:163], v3 offset:43008
    v_mfma_f32_16x16x32_bf16 v[188:191], v[124:127], v[96:99], v[188:191]
    ds_read_b128 v[164:167], v3 offset:44032
    v_mfma_f32_16x16x32_bf16 v[192:195], v[128:131], v[96:99], v[192:195]
    ds_read_b128 v[168:171], v3 offset:45056
    s_waitcnt vmcnt(21) lgkmcnt(5)
    v_mfma_f32_16x16x32_bf16 v[176:179], v[132:135], v[100:103], v[176:179]
    ds_read_b128 v[112:115], v3 offset:46080
    v_mfma_f32_16x16x32_bf16 v[180:183], v[136:139], v[100:103], v[180:183]
    ds_read_b128 v[116:119], v3 offset:47104
    v_mfma_f32_16x16x32_bf16 v[184:187], v[140:143], v[100:103], v[184:187]
    ds_read_b128 v[120:123], v3 offset:48128
    v_mfma_f32_16x16x32_bf16 v[188:191], v[144:147], v[100:103], v[188:191]
    ds_read_b128 v[124:127], v3 offset:49152
    v_mfma_f32_16x16x32_bf16 v[192:195], v[148:151], v[100:103], v[192:195]
    ds_read_b128 v[128:131], v3 offset:50176
    s_waitcnt vmcnt(20) lgkmcnt(5)
    v_mfma_f32_16x16x32_bf16 v[176:179], v[152:155], v[104:107], v[176:179]
    ds_read_b128 v[132:135], v3 offset:51200
    v_mfma_f32_16x16x32_bf16 v[180:183], v[156:159], v[104:107], v[180:183]
    ds_read_b128 v[136:139], v3 offset:52224
    v_mfma_f32_16x16x32_bf16 v[184:187], v[160:163], v[104:107], v[184:187]
    ds_read_b128 v[140:143], v3 offset:53248
    v_mfma_f32_16x16x32_bf16 v[188:191], v[164:167], v[104:107], v[188:191]
    ds_read_b128 v[144:147], v3 offset:54272
    v_mfma_f32_16x16x32_bf16 v[192:195], v[168:171], v[104:107], v[192:195]
    ds_read_b128 v[148:151], v3 offset:55296
    s_waitcnt vmcnt(19) lgkmcnt(5)
    v_mfma_f32_16x16x32_bf16 v[176:179], v[112:115], v[108:111], v[176:179]
    ds_read_b128 v[152:155], v3 offset:56320
    v_mfma_f32_16x16x32_bf16 v[180:183], v[116:119], v[108:111], v[180:183]
    ds_read_b128 v[156:159], v3 offset:57344
    v_mfma_f32_16x16x32_bf16 v[184:187], v[120:123], v[108:111], v[184:187]
    ds_read_b128 v[160:163], v3 offset:58368
    v_mfma_f32_16x16x32_bf16 v[188:191], v[124:127], v[108:111], v[188:191]
    ds_read_b128 v[164:167], v3 offset:59392
    v_mfma_f32_16x16x32_bf16 v[192:195], v[128:131], v[108:111], v[192:195]
    ds_read_b128 v[168:171], v3 offset:60416
    s_waitcnt vmcnt(18) lgkmcnt(0)
    s_barrier
    v_mfma_f32_16x16x32_bf16 v[176:179], v[132:135], v[32:35], v[176:179]
    ds_read_b128 v[112:115], v4 offset:0
    v_mfma_f32_16x16x32_bf16 v[180:183], v[136:139], v[32:35], v[180:183]
    ds_read_b128 v[116:119], v4 offset:1024
    v_mfma_f32_16x16x32_bf16 v[184:187], v[140:143], v[32:35], v[184:187]
    ds_read_b128 v[120:123], v4 offset:2048
    v_mfma_f32_16x16x32_bf16 v[188:191], v[144:147], v[32:35], v[188:191]
    ds_read_b128 v[124:127], v4 offset:3072
    v_mfma_f32_16x16x32_bf16 v[192:195], v[148:151], v[32:35], v[192:195]
    ds_read_b128 v[128:131], v4 offset:4096
    s_waitcnt vmcnt(17) lgkmcnt(5)
    v_mfma_f32_16x16x32_bf16 v[176:179], v[152:155], v[36:39], v[176:179]
    ds_read_b128 v[132:135], v4 offset:5120
    v_mfma_f32_16x16x32_bf16 v[180:183], v[156:159], v[36:39], v[180:183]
    ds_read_b128 v[136:139], v4 offset:6144
    v_mfma_f32_16x16x32_bf16 v[184:187], v[160:163], v[36:39], v[184:187]
    ds_read_b128 v[140:143], v4 offset:7168
    v_mfma_f32_16x16x32_bf16 v[188:191], v[164:167], v[36:39], v[188:191]
    ds_read_b128 v[144:147], v4 offset:8192
    v_mfma_f32_16x16x32_bf16 v[192:195], v[168:171], v[36:39], v[192:195]
    ds_read_b128 v[148:151], v4 offset:9216
    s_waitcnt vmcnt(16) lgkmcnt(5)
    v_mfma_f32_16x16x32_bf16 v[176:179], v[112:115], v[40:43], v[176:179]
    ds_read_b128 v[152:155], v4 offset:10240
    v_mfma_f32_16x16x32_bf16 v[180:183], v[116:119], v[40:43], v[180:183]
    ds_read_b128 v[156:159], v4 offset:11264
    v_mfma_f32_16x16x32_bf16 v[184:187], v[120:123], v[40:43], v[184:187]
    ds_read_b128 v[160:163], v4 offset:12288
    v_mfma_f32_16x16x32_bf16 v[188:191], v[124:127], v[40:43], v[188:191]
    ds_read_b128 v[164:167], v4 offset:13312
    v_mfma_f32_16x16x32_bf16 v[192:195], v[128:131], v[40:43], v[192:195]
    ds_read_b128 v[168:171], v4 offset:14336
    s_waitcnt vmcnt(15) lgkmcnt(5)
    v_mfma_f32_16x16x32_bf16 v[176:179], v[132:135], v[44:47], v[176:179]
    ds_read_b128 v[112:115], v4 offset:15360
    v_mfma_f32_16x16x32_bf16 v[180:183], v[136:139], v[44:47], v[180:183]
    ds_read_b128 v[116:119], v4 offset:16384
    v_mfma_f32_16x16x32_bf16 v[184:187], v[140:143], v[44:47], v[184:187]
    ds_read_b128 v[120:123], v4 offset:17408
    v_mfma_f32_16x16x32_bf16 v[188:191], v[144:147], v[44:47], v[188:191]
    ds_read_b128 v[124:127], v4 offset:18432
    v_mfma_f32_16x16x32_bf16 v[192:195], v[148:151], v[44:47], v[192:195]
    ds_read_b128 v[128:131], v4 offset:19456
    s_waitcnt vmcnt(14) lgkmcnt(5)
    v_mfma_f32_16x16x32_bf16 v[176:179], v[152:155], v[48:51], v[176:179]
    ds_read_b128 v[132:135], v4 offset:20480
    v_mfma_f32_16x16x32_bf16 v[180:183], v[156:159], v[48:51], v[180:183]
    ds_read_b128 v[136:139], v4 offset:21504
    v_mfma_f32_16x16x32_bf16 v[184:187], v[160:163], v[48:51], v[184:187]
    ds_read_b128 v[140:143], v4 offset:22528
    v_mfma_f32_16x16x32_bf16 v[188:191], v[164:167], v[48:51], v[188:191]
    ds_read_b128 v[144:147], v4 offset:23552
    v_mfma_f32_16x16x32_bf16 v[192:195], v[168:171], v[48:51], v[192:195]
    ds_read_b128 v[148:151], v4 offset:24576
    s_waitcnt vmcnt(13) lgkmcnt(5)
    v_mfma_f32_16x16x32_bf16 v[176:179], v[112:115], v[52:55], v[176:179]
    ds_read_b128 v[152:155], v4 offset:25600
    v_mfma_f32_16x16x32_bf16 v[180:183], v[116:119], v[52:55], v[180:183]
    ds_read_b128 v[156:159], v4 offset:26624
    v_mfma_f32_16x16x32_bf16 v[184:187], v[120:123], v[52:55], v[184:187]
    ds_read_b128 v[160:163], v4 offset:27648
    v_mfma_f32_16x16x32_bf16 v[188:191], v[124:127], v[52:55], v[188:191]
    ds_read_b128 v[164:167], v4 offset:28672
    v_mfma_f32_16x16x32_bf16 v[192:195], v[128:131], v[52:55], v[192:195]
    ds_read_b128 v[168:171], v4 offset:29696
    s_waitcnt vmcnt(12) lgkmcnt(0)
    s_barrier
    v_mfma_f32_16x16x32_bf16 v[176:179], v[132:135], v[56:59], v[176:179]
    ds_read_b128 v[112:115], v4 offset:30720
    v_mfma_f32_16x16x32_bf16 v[180:183], v[136:139], v[56:59], v[180:183]
    ds_read_b128 v[116:119], v4 offset:31744
    v_mfma_f32_16x16x32_bf16 v[184:187], v[140:143], v[56:59], v[184:187]
    ds_read_b128 v[120:123], v4 offset:32768
    v_mfma_f32_16x16x32_bf16 v[188:191], v[144:147], v[56:59], v[188:191]
    ds_read_b128 v[124:127], v4 offset:33792
    v_mfma_f32_16x16x32_bf16 v[192:195], v[148:151], v[56:59], v[192:195]
    ds_read_b128 v[128:131], v4 offset:34816
    s_waitcnt vmcnt(11) lgkmcnt(5)
    v_mfma_f32_16x16x32_bf16 v[176:179], v[152:155], v[60:63], v[176:179]
    ds_read_b128 v[132:135], v4 offset:35840
    v_mfma_f32_16x16x32_bf16 v[180:183], v[156:159], v[60:63], v[180:183]
    ds_read_b128 v[136:139], v4 offset:36864
    v_mfma_f32_16x16x32_bf16 v[184:187], v[160:163], v[60:63], v[184:187]
    ds_read_b128 v[140:143], v4 offset:37888
    v_mfma_f32_16x16x32_bf16 v[188:191], v[164:167], v[60:63], v[188:191]
    ds_read_b128 v[144:147], v4 offset:38912
    v_mfma_f32_16x16x32_bf16 v[192:195], v[168:171], v[60:63], v[192:195]
    ds_read_b128 v[148:151], v4 offset:39936
    s_waitcnt vmcnt(10) lgkmcnt(5)
    v_mfma_f32_16x16x32_bf16 v[176:179], v[112:115], v[64:67], v[176:179]
    ds_read_b128 v[152:155], v4 offset:40960
    v_mfma_f32_16x16x32_bf16 v[180:183], v[116:119], v[64:67], v[180:183]
    ds_read_b128 v[156:159], v4 offset:41984
    v_mfma_f32_16x16x32_bf16 v[184:187], v[120:123], v[64:67], v[184:187]
    ds_read_b128 v[160:163], v4 offset:43008
    v_mfma_f32_16x16x32_bf16 v[188:191], v[124:127], v[64:67], v[188:191]
    ds_read_b128 v[164:167], v4 offset:44032
    v_mfma_f32_16x16x32_bf16 v[192:195], v[128:131], v[64:67], v[192:195]
    ds_read_b128 v[168:171], v4 offset:45056
    s_waitcnt vmcnt(9) lgkmcnt(5)
    v_mfma_f32_16x16x32_bf16 v[176:179], v[132:135], v[68:71], v[176:179]
    ds_read_b128 v[112:115], v4 offset:46080
    v_mfma_f32_16x16x32_bf16 v[180:183], v[136:139], v[68:71], v[180:183]
    ds_read_b128 v[116:119], v4 offset:47104
    v_mfma_f32_16x16x32_bf16 v[184:187], v[140:143], v[68:71], v[184:187]
    ds_read_b128 v[120:123], v4 offset:48128
    v_mfma_f32_16x16x32_bf16 v[188:191], v[144:147], v[68:71], v[188:191]
    ds_read_b128 v[124:127], v4 offset:49152
    v_mfma_f32_16x16x32_bf16 v[192:195], v[148:151], v[68:71], v[192:195]
    ds_read_b128 v[128:131], v4 offset:50176
    s_waitcnt vmcnt(8) lgkmcnt(5)
    v_mfma_f32_16x16x32_bf16 v[176:179], v[152:155], v[72:75], v[176:179]
    ds_read_b128 v[132:135], v4 offset:51200
    v_mfma_f32_16x16x32_bf16 v[180:183], v[156:159], v[72:75], v[180:183]
    ds_read_b128 v[136:139], v4 offset:52224
    v_mfma_f32_16x16x32_bf16 v[184:187], v[160:163], v[72:75], v[184:187]
    ds_read_b128 v[140:143], v4 offset:53248
    v_mfma_f32_16x16x32_bf16 v[188:191], v[164:167], v[72:75], v[188:191]
    ds_read_b128 v[144:147], v4 offset:54272
    v_mfma_f32_16x16x32_bf16 v[192:195], v[168:171], v[72:75], v[192:195]
    ds_read_b128 v[148:151], v4 offset:55296
    s_waitcnt vmcnt(7) lgkmcnt(5)
    v_mfma_f32_16x16x32_bf16 v[176:179], v[112:115], v[76:79], v[176:179]
    ds_read_b128 v[152:155], v4 offset:56320
    v_mfma_f32_16x16x32_bf16 v[180:183], v[116:119], v[76:79], v[180:183]
    ds_read_b128 v[156:159], v4 offset:57344
    v_mfma_f32_16x16x32_bf16 v[184:187], v[120:123], v[76:79], v[184:187]
    ds_read_b128 v[160:163], v4 offset:58368
    v_mfma_f32_16x16x32_bf16 v[188:191], v[124:127], v[76:79], v[188:191]
    ds_read_b128 v[164:167], v4 offset:59392
    v_mfma_f32_16x16x32_bf16 v[192:195], v[128:131], v[76:79], v[192:195]
    ds_read_b128 v[168:171], v4 offset:60416
    s_waitcnt vmcnt(6) lgkmcnt(5)
    v_mfma_f32_16x16x32_bf16 v[176:179], v[132:135], v[80:83], v[176:179]
    v_mfma_f32_16x16x32_bf16 v[180:183], v[136:139], v[80:83], v[180:183]
    v_mfma_f32_16x16x32_bf16 v[184:187], v[140:143], v[80:83], v[184:187]
    v_mfma_f32_16x16x32_bf16 v[188:191], v[144:147], v[80:83], v[188:191]
    v_mfma_f32_16x16x32_bf16 v[192:195], v[148:151], v[80:83], v[192:195]
    s_waitcnt vmcnt(5) lgkmcnt(0)
    v_mfma_f32_16x16x32_bf16 v[176:179], v[152:155], v[84:87], v[176:179]
    v_mfma_f32_16x16x32_bf16 v[180:183], v[156:159], v[84:87], v[180:183]
    v_mfma_f32_16x16x32_bf16 v[184:187], v[160:163], v[84:87], v[184:187]
    v_mfma_f32_16x16x32_bf16 v[188:191], v[164:167], v[84:87], v[188:191]
    v_mfma_f32_16x16x32_bf16 v[192:195], v[168:171], v[84:87], v[192:195]
    s_mov_b32 s33, 0xffff0000
    s_waitcnt vmcnt(0)
    v_lshlrev_b32 v196, 16, v16
    v_and_b32 v197, s33, v16
    v_lshlrev_b32 v198, 16, v17
    v_and_b32 v199, s33, v17
    v_lshlrev_b32 v200, 16, v18
    v_and_b32 v201, s33, v18
    v_lshlrev_b32 v202, 16, v19
    v_and_b32 v203, s33, v19
    v_lshlrev_b32 v204, 16, v20
    v_and_b32 v205, s33, v20
    v_lshlrev_b32 v206, 16, v21
    v_and_b32 v207, s33, v21
    v_lshlrev_b32 v208, 16, v22
    v_and_b32 v209, s33, v22
    v_lshlrev_b32 v210, 16, v23
    v_and_b32 v211, s33, v23
    v_lshlrev_b32 v212, 16, v24
    v_and_b32 v213, s33, v24
    v_lshlrev_b32 v214, 16, v25
    v_and_b32 v215, s33, v25
    v_pk_add_f32 v[176:177], v[176:177], v[196:197]
    v_pk_add_f32 v[178:179], v[178:179], v[198:199]
    v_pk_add_f32 v[180:181], v[180:181], v[200:201]
    v_pk_add_f32 v[182:183], v[182:183], v[202:203]
    v_pk_add_f32 v[184:185], v[184:185], v[204:205]
    v_pk_add_f32 v[186:187], v[186:187], v[206:207]
    v_pk_add_f32 v[188:189], v[188:189], v[208:209]
    v_pk_add_f32 v[190:191], v[190:191], v[210:211]
    v_pk_add_f32 v[192:193], v[192:193], v[212:213]
    v_pk_add_f32 v[194:195], v[194:195], v[214:215]
    v_cvt_pk_bf16_f32 v196, v176, v177
    v_cvt_pk_bf16_f32 v197, v178, v179
    ds_write_b64 v15, v[196:197] offset:0
    v_cvt_pk_bf16_f32 v198, v180, v181
    v_cvt_pk_bf16_f32 v199, v182, v183
    ds_write_b64 v15, v[198:199] offset:32
    v_cvt_pk_bf16_f32 v200, v184, v185
    v_cvt_pk_bf16_f32 v201, v186, v187
    ds_write_b64 v15, v[200:201] offset:64
    v_cvt_pk_bf16_f32 v202, v188, v189
    v_cvt_pk_bf16_f32 v203, v190, v191
    ds_write_b64 v15, v[202:203] offset:96
    v_cvt_pk_bf16_f32 v204, v192, v193
    v_cvt_pk_bf16_f32 v205, v194, v195
    ds_write_b64 v15, v[204:205] offset:128
    v_add_u32 v9, s43, v3
    s_waitcnt lgkmcnt(0)
    ds_read_b128 v[32:35], v9 offset:0
    ds_read_b128 v[36:39], v9 offset:1024
    ds_read_b128 v[40:43], v9 offset:2048
    s_waitcnt lgkmcnt(2)
    buffer_store_dwordx4 v[32:35], v26, s[8:11], s41 offen nt
    s_waitcnt lgkmcnt(1)
    buffer_store_dwordx4 v[36:39], v27, s[8:11], s41 offen nt
    s_waitcnt lgkmcnt(0)
    s_mov_b64 exec, 0xffffffff
    buffer_store_dwordx4 v[40:43], v28, s[8:11], s41 offen nt
Ltl_end:
    s_endpgm
Lat_xb:
Lat_yb:
    ds_read_b32 v10, v15 offset:0
    s_waitcnt lgkmcnt(0)
    v_readfirstlane_b32 s42, v10
    s_cmp_ge_u32 s42, 4
    s_cbranch_scc1 Lat_rb
    s_branch Lat_yb
Lat_xc:
    v_mov_b32 v10, 1
    s_waitcnt lgkmcnt(0)
    s_mov_b64 exec, 1
    ds_add_u32 v15, v10 offset:16
    s_mov_b64 exec, -1
Lat_yc:
    ds_read_b32 v10, v15 offset:4
    s_waitcnt lgkmcnt(0)
    v_readfirstlane_b32 s42, v10
    s_cmp_ge_u32 s42, 4
    s_cbranch_scc1 Lat_rc
    s_branch Lat_yc
Lat_xd:
    v_mov_b32 v10, 1
    s_waitcnt lgkmcnt(0)
    s_mov_b64 exec, 1
    ds_add_u32 v15, v10 offset:20
    s_mov_b64 exec, -1
Lat_yd:
    ds_read_b32 v10, v15 offset:12
    s_waitcnt lgkmcnt(0)
    v_readfirstlane_b32 s42, v10
    s_cmp_ge_u32 s42, 4
    s_cbranch_scc1 Lat_rd
    s_branch Lat_yd
Lat_slow:
    s_not_b64 exec, s[50:51]
    v_mov_b32 v104, 0
    v_mov_b32 v105, 0
    v_mov_b32 v106, 0
    v_mov_b32 v107, 0
    s_mov_b64 exec, -1
    s_mov_b32 s37, s33
    s_mov_b32 s38, 0
    v_mov_b32 v10, 0xff800000
    v_mov_b32 v11, 0xff800000
Lat_sl:
    buffer_load_dwordx4 v[112:115], v3, s[12:15], s37 offen sc1
    buffer_load_dwordx2 v[118:119], v136, s[12:15], s37 offen sc1
    s_waitcnt vmcnt(0)
    v_mfma_f32_32x32x16_bf16 v[16:31], v[112:115], v[96:99], 0
    v_mfma_f32_32x32x16_bf16 v[32:47], v[112:115], v[100:103], 0
    s_nop 9
    v_mfma_f32_32x32x8_bf16 v[16:31], v[118:119], v[104:105], v[16:31]
    v_mfma_f32_32x32x8_bf16 v[32:47], v[118:119], v[106:107], v[32:47]
    s_add_u32 s37, s37, 2688
    s_add_u32 s38, s38, 1
    s_cmp_lt_u32 s38, 64
    s_nop 9
    v_max3_f32 v10, v10, v16, v17
    v_max3_f32 v10, v10, v18, v19
    v_max3_f32 v10, v10, v20, v21
    v_max3_f32 v10, v10, v22, v23
    v_max3_f32 v10, v10, v24, v25
    v_max3_f32 v10, v10, v26, v27
    v_max3_f32 v10, v10, v28, v29
    v_max3_f32 v10, v10, v30, v31
    v_max3_f32 v11, v11, v32, v33
    v_max3_f32 v11, v11, v34, v35
    v_max3_f32 v11, v11, v36, v37
    v_max3_f32 v11, v11, v38, v39
    v_max3_f32 v11, v11, v40, v41
    v_max3_f32 v11, v11, v42, v43
    v_max3_f32 v11, v11, v44, v45
    v_max3_f32 v11, v11, v46, v47
    s_cbranch_scc1 Lat_sl
    v_mov_b32 v12, v10
    s_nop 1
    v_permlane32_swap_b32 v10, v12
    v_max_f32 v10, v10, v12
    v_and_b32 v12, s41, v10
    v_sub_f32 v10, v10, v12
    v_and_b32 v13, s41, v10
    v_sub_f32 v10, v10, v13
    v_lshrrev_b32 v12, 16, v12
    v_or_b32 v12, v12, v13
    v_lshrrev_b32 v10, 16, v10
    s_not_b64 exec, s[50:51]
    v_xor_b32 v104, 0x80008000, v12
    v_xor_b32 v105, 0x8000, v10
    s_mov_b64 exec, -1
    v_mov_b32 v12, v11
    s_nop 1
    v_permlane32_swap_b32 v11, v12
    v_max_f32 v11, v11, v12
    v_and_b32 v12, s41, v11
    v_sub_f32 v11, v11, v12
    v_and_b32 v13, s41, v11
    v_sub_f32 v11, v11, v13
    v_lshrrev_b32 v12, 16, v12
    v_or_b32 v12, v12, v13
    v_lshrrev_b32 v11, 16, v11
    s_not_b64 exec, s[50:51]
    v_xor_b32 v106, 0x80008000, v12
    v_xor_b32 v107, 0x8000, v11
    s_mov_b64 exec, -1
    v_mov_b32 v64, 0
    v_mov_b32 v65, 0
    v_mov_b32 v66, 0
    v_mov_b32 v67, 0
    v_mov_b32 v68, 0
    v_mov_b32 v69, 0
    v_mov_b32 v70, 0
    v_mov_b32 v71, 0
    v_mov_b32 v72, 0
    v_mov_b32 v73, 0
    v_mov_b32 v74, 0
    v_mov_b32 v75, 0
    v_mov_b32 v76, 0
    v_mov_b32 v77, 0
    v_mov_b32 v78, 0
    v_mov_b32 v79, 0
    v_mov_b32 v80, 0
    v_mov_b32 v81, 0
    v_mov_b32 v82, 0
    v_mov_b32 v83, 0
    v_mov_b32 v84, 0
    v_mov_b32 v85, 0
    v_mov_b32 v86, 0
    v_mov_b32 v87, 0
    v_mov_b32 v88, 0
    v_mov_b32 v89, 0
    v_mov_b32 v90, 0
    v_mov_b32 v91, 0
    v_mov_b32 v92, 0
    v_mov_b32 v93, 0
    v_mov_b32 v94, 0
    v_mov_b32 v95, 0
    s_mov_b32 s37, s33
    s_mov_b32 s38, 0
Lat_s2:
    buffer_load_dwordx4 v[112:115], v3, s[12:15], s37 offen sc1
    buffer_load_dwordx2 v[118:119], v136, s[12:15], s37 offen sc1
    buffer_load_dwordx4 v[124:127], v137, s[12:15], s37 offen sc1
    buffer_load_dwordx4 v[132:135], v137, s[12:15], s37 offen offset:704 sc1
    s_waitcnt vmcnt(0)
    v_mfma_f32_32x32x16_bf16 v[16:31], v[112:115], v[96:99], 0
    v_mfma_f32_32x32x16_bf16 v[32:47], v[112:115], v[100:103], 0
    s_nop 9
    v_mfma_f32_32x32x8_bf16 v[16:31], v[118:119], v[104:105], v[16:31]
    v_mfma_f32_32x32x8_bf16 v[32:47], v[118:119], v[106:107], v[32:47]
    s_add_u32 s37, s37, 2688
    s_add_u32 s38, s38, 1
    s_cmp_lt_u32 s38, 64
    s_nop 9
    v_exp_f32 v16, v16
    v_exp_f32 v17, v17
    v_exp_f32 v18, v18
    v_exp_f32 v19, v19
    v_cvt_pk_bf16_f32 v48, v16, v17
    v_cvt_pk_bf16_f32 v49, v18, v19
    v_exp_f32 v20, v20
    v_exp_f32 v21, v21
    v_exp_f32 v22, v22
    v_exp_f32 v23, v23
    v_cvt_pk_bf16_f32 v50, v20, v21
    v_cvt_pk_bf16_f32 v51, v22, v23
    v_exp_f32 v24, v24
    v_exp_f32 v25, v25
    v_exp_f32 v26, v26
    v_exp_f32 v27, v27
    v_cvt_pk_bf16_f32 v52, v24, v25
    v_cvt_pk_bf16_f32 v53, v26, v27
    v_exp_f32 v28, v28
    v_exp_f32 v29, v29
    v_exp_f32 v30, v30
    v_exp_f32 v31, v31
    v_cvt_pk_bf16_f32 v54, v28, v29
    v_cvt_pk_bf16_f32 v55, v30, v31
    v_exp_f32 v32, v32
    v_exp_f32 v33, v33
    v_exp_f32 v34, v34
    v_exp_f32 v35, v35
    v_cvt_pk_bf16_f32 v56, v32, v33
    v_cvt_pk_bf16_f32 v57, v34, v35
    v_exp_f32 v36, v36
    v_exp_f32 v37, v37
    v_exp_f32 v38, v38
    v_exp_f32 v39, v39
    v_cvt_pk_bf16_f32 v58, v36, v37
    v_cvt_pk_bf16_f32 v59, v38, v39
    v_exp_f32 v40, v40
    v_exp_f32 v41, v41
    v_exp_f32 v42, v42
    v_exp_f32 v43, v43
    v_cvt_pk_bf16_f32 v60, v40, v41
    v_cvt_pk_bf16_f32 v61, v42, v43
    v_exp_f32 v44, v44
    v_exp_f32 v45, v45
    v_exp_f32 v46, v46
    v_exp_f32 v47, v47
    v_cvt_pk_bf16_f32 v62, v44, v45
    v_cvt_pk_bf16_f32 v63, v46, v47
    s_nop 1
    v_mfma_f32_32x32x16_bf16 v[64:79], v[124:127], v[48:51], v[64:79]
    v_mfma_f32_32x32x16_bf16 v[64:79], v[132:135], v[52:55], v[64:79]
    v_mfma_f32_32x32x16_bf16 v[80:95], v[124:127], v[56:59], v[80:95]
    v_mfma_f32_32x32x16_bf16 v[80:95], v[132:135], v[60:63], v[80:95]
    s_cbranch_scc1 Lat_s2
    s_nop 12
    s_branch Lat_store
Ltl_prod:
    s_sub_u32 s16, s16, 4
Lone_help:
    v_lshlrev_b32 v3, 4, v2
    s_lshl_b32 s17, s30, 2
    s_lshr_b32 s32, s31, 3
    s_add_u32 s17, s17, s32
    s_and_b32 s18, s31, 7
    s_mul_i32 s33, s17, 172032
    s_add_u32 s33, s33, 2621440
    s_load_dwordx2 s[54:55], s[0:1], 16
    s_load_dwordx4 s[56:59], s[0:1], 32
    s_load_dwordx2 s[60:61], s[0:1], 48
    v_mov_b32 v15, 156672
    v_mov_b32 v10, 0
    v_mov_b32 v32, 0
    v_mov_b32 v33, 0
    v_mov_b32 v34, 0
    v_mov_b32 v35, 0
    v_add_u32 v11, 156672, v3
    s_mov_b64 exec, 15
    ds_write_b128 v11, v[32:35]
    s_mov_b64 exec, -1
    v_add_u32 v10, 0, v2
    v_mul_u32_u24 v11, 4682, v10
    v_lshrrev_b32 v11, 16, v11
    v_mad_i32_i24 v10, v11, -14, v10
    v_and_b32 v12, 0x13, v11
    v_bfe_u32 v13, v11, 2, 1
    v_lshl_add_u32 v12, v13, 3, v12
    v_bfe_u32 v13, v11, 3, 1
    v_lshl_add_u32 v12, v13, 2, v12
    v_mul_u32_u24 v12, 3456, v12
    v_lshl_add_u32 v16, v10, 4, v12
    v_add_u32 v16, 4096, v16
    v_add_u32 v10, 64, v2
    v_mul_u32_u24 v11, 4682, v10
    v_lshrrev_b32 v11, 16, v11
    v_mad_i32_i24 v10, v11, -14, v10
    v_and_b32 v12, 0x13, v11
    v_bfe_u32 v13, v11, 2, 1
    v_lshl_add_u32 v12, v13, 3, v12
    v_bfe_u32 v13, v11, 3, 1
    v_lshl_add_u32 v12, v13, 2, v12
    v_mul_u32_u24 v12, 3456, v12
    v_lshl_add_u32 v17, v10, 4, v12
    v_add_u32 v17, 3072, v17
    v_add_u32 v10, 128, v2
    v_mul_u32_u24 v11, 4682, v10
    v_lshrrev_b32 v11, 16, v11
    v_mad_i32_i24 v10, v11, -14, v10
    v_and_b32 v12, 0x13, v11
    v_bfe_u32 v13, v11, 2, 1
    v_lshl_add_u32 v12, v13, 3, v12
    v_bfe_u32 v13, v11, 3, 1
    v_lshl_add_u32 v12, v13, 2, v12
    v_mul_u32_u24 v12, 3456, v12
    v_lshl_add_u32 v18, v10, 4, v12
    v_add_u32 v18, 2048, v18
    v_add_u32 v10, 192, v2
    v_mul_u32_u24 v11, 4682, v10
    v_lshrrev_b32 v11, 16, v11
    v_mad_i32_i24 v10, v11, -14, v10
    v_and_b32 v12, 0x13, v11
    v_bfe_u32 v13, v11, 2, 1
    v_lshl_add_u32 v12, v13, 3, v12
    v_bfe_u32 v13, v11, 3, 1
    v_lshl_add_u32 v12, v13, 2, v12
    v_mul_u32_u24 v12, 3456, v12
    v_lshl_add_u32 v19, v10, 4, v12
    v_add_u32 v19, 1024, v19
    v_add_u32 v10, 256, v2
    v_mul_u32_u24 v11, 4682, v10
    v_lshrrev_b32 v11, 16, v11
    v_mad_i32_i24 v10, v11, -14, v10
    v_and_b32 v12, 0x13, v11
    v_bfe_u32 v13, v11, 2, 1
    v_lshl_add_u32 v12, v13, 3, v12
    v_bfe_u32 v13, v11, 3, 1
    v_lshl_add_u32 v12, v13, 2, v12
    v_mul_u32_u24 v12, 3456, v12
    v_lshl_add_u32 v20, v10, 4, v12
    v_add_u32 v20, 4096, v20
    v_add_u32 v10, 320, v2
    v_mul_u32_u24 v11, 4682, v10
    v_lshrrev_b32 v11, 16, v11
    v_mad_i32_i24 v10, v11, -14, v10
    v_and_b32 v12, 0x13, v11
    v_bfe_u32 v13, v11, 2, 1
    v_lshl_add_u32 v12, v13, 3, v12
    v_bfe_u32 v13, v11, 3, 1
    v_lshl_add_u32 v12, v13, 2, v12
    v_mul_u32_u24 v12, 3456, v12
    v_lshl_add_u32 v21, v10, 4, v12
    v_add_u32 v21, 3072, v21
    v_add_u32 v10, 384, v2
    v_mul_u32_u24 v11, 4682, v10
    v_lshrrev_b32 v11, 16, v11
    v_mad_i32_i24 v10, v11, -14, v10
    v_and_b32 v12, 0x13, v11
    v_bfe_u32 v13, v11, 2, 1
    v_lshl_add_u32 v12, v13, 3, v12
    v_bfe_u32 v13, v11, 3, 1
    v_lshl_add_u32 v12, v13, 2, v12
    v_mul_u32_u24 v12, 3456, v12
    v_lshl_add_u32 v22, v10, 4, v12
    v_add_u32 v22, 2048, v22
    s_lshl_b32 s42, s16, 8
    s_add_u32 s42, s42, s2
    s_mul_i32 s43, s42, 3277
    s_lshr_b32 s43, s43, 16
    s_mul_i32 s47, s43, 20
    s_sub_u32 s47, s42, s47
    s_cmp_lt_u32 s47, 16
    s_cselect_b32 s76, 20, 80
    s_cselect_b32 s77, 4, 40
    s_cselect_b32 s78, 8, 20
    s_mul_i32 s48, s47, 40
    s_mul_i32 s49, s47, 160
    s_sub_u32 s49, s49, 2544
    s_cselect_b32 s79, s48, s49
    s_cmp_lt_u32 s47, 16
    s_cselect_b32 s79, s48, s49
    s_cmp_lt_u32 s42, 160
    s_cselect_b32 s76, s76, 16
    s_cselect_b32 s77, s77, 8
    s_cselect_b32 s78, s78, 4
    v_add_u32 v10, 0, v2
    v_mul_u32_u24 v11, 6554, v10
    v_lshrrev_b32 v11, 16, v11
    v_mad_i32_i24 v10, v11, -10, v10
    v_and_b32 v12, 3, v11
    v_bfe_u32 v13, v11, 2, 1
    v_mad_u32_u24 v12, v13, s77, v12
    v_bfe_u32 v13, v11, 3, 1
    v_mad_u32_u24 v12, v13, s78, v12
    v_lshrrev_b32 v13, 4, v11
    v_mad_u32_u24 v12, v13, s76, v12
    v_mul_u32_u24 v12, 1280, v12
    v_lshl_add_u32 v25, v10, 4, v12
    v_add_u32 v25, 4096, v25
    v_add_u32 v10, 64, v2
    v_mul_u32_u24 v11, 6554, v10
    v_lshrrev_b32 v11, 16, v11
    v_mad_i32_i24 v10, v11, -10, v10
    v_and_b32 v12, 3, v11
    v_bfe_u32 v13, v11, 2, 1
    v_mad_u32_u24 v12, v13, s77, v12
    v_bfe_u32 v13, v11, 3, 1
    v_mad_u32_u24 v12, v13, s78, v12
    v_lshrrev_b32 v13, 4, v11
    v_mad_u32_u24 v12, v13, s76, v12
    v_mul_u32_u24 v12, 1280, v12
    v_lshl_add_u32 v26, v10, 4, v12
    v_add_u32 v26, 3072, v26
    v_add_u32 v10, 128, v2
    v_mul_u32_u24 v11, 6554, v10
    v_lshrrev_b32 v11, 16, v11
    v_mad_i32_i24 v10, v11, -10, v10
    v_and_b32 v12, 3, v11
    v_bfe_u32 v13, v11, 2, 1
    v_mad_u32_u24 v12, v13, s77, v12
    v_bfe_u32 v13, v11, 3, 1
    v_mad_u32_u24 v12, v13, s78, v12
    v_lshrrev_b32 v13, 4, v11
    v_mad_u32_u24 v12, v13, s76, v12
    v_mul_u32_u24 v12, 1280, v12
    v_lshl_add_u32 v27, v10, 4, v12
    v_add_u32 v27, 2048, v27
    v_add_u32 v10, 192, v2
    v_mul_u32_u24 v11, 6554, v10
    v_lshrrev_b32 v11, 16, v11
    v_mad_i32_i24 v10, v11, -10, v10
    v_and_b32 v12, 3, v11
    v_bfe_u32 v13, v11, 2, 1
    v_mad_u32_u24 v12, v13, s77, v12
    v_bfe_u32 v13, v11, 3, 1
    v_mad_u32_u24 v12, v13, s78, v12
    v_lshrrev_b32 v13, 4, v11
    v_mad_u32_u24 v12, v13, s76, v12
    v_mul_u32_u24 v12, 1280, v12
    v_lshl_add_u32 v28, v10, 4, v12
    v_add_u32 v28, 1024, v28
    v_add_u32 v10, 256, v2
    v_mul_u32_u24 v11, 6554, v10
    v_lshrrev_b32 v11, 16, v11
    v_mad_i32_i24 v10, v11, -10, v10
    v_and_b32 v12, 3, v11
    v_bfe_u32 v13, v11, 2, 1
    v_mad_u32_u24 v12, v13, s77, v12
    v_bfe_u32 v13, v11, 3, 1
    v_mad_u32_u24 v12, v13, s78, v12
    v_lshrrev_b32 v13, 4, v11
    v_mad_u32_u24 v12, v13, s76, v12
    v_mul_u32_u24 v12, 1280, v12
    v_lshl_add_u32 v29, v10, 4, v12
    v_add_u32 v29, 4096, v29
    s_mov_b32 s62, 224
    s_mov_b32 s63, 160
    s_mul_i32 s39, s16, 7168
    s_add_u32 s39, s39, 135168
    v_lshrrev_b32 v10, 4, v2
    v_lshrrev_b32 v11, 1, v10
    v_lshlrev_b32 v11, 4, v11
    v_and_b32 v12, 1, v10
    v_lshl_add_u32 v11, v12, 2, v11
    v_bfe_u32 v13, v2, 2, 2
    v_add_u32 v11, v11, v13
    v_and_b32 v12, 3, v2
    v_lshlrev_b32 v12, 3, v12
    v_add_u32 v12, s39, v12
    v_mad_u32_u24 v23, v11, s62, v12
    v_mad_u32_u24 v24, v11, s63, v12
    v_mov_b32 v30, 1
    v_and_b32 v11, 15, v2
    v_mov_b32 v12, 0x3f803f80
    v_lshlrev_b32 v33, 6, v11
    v_lshl_add_u32 v33, v10, 4, v33
    v_cmp_eq_u32 vcc, 0, v11
    s_nop 1
    v_cndmask_b32 v64, 0, v12, vcc
    v_mov_b32 v65, v64
    v_mov_b32 v66, v64
    v_mov_b32 v67, v64
    v_cmp_eq_u32 vcc, 1, v11
    s_nop 1
    v_cndmask_b32 v68, 0, v12, vcc
    v_mov_b32 v69, v68
    v_mov_b32 v70, v68
    v_mov_b32 v71, v68
    v_cmp_eq_u32 vcc, 2, v11
    s_nop 1
    v_cndmask_b32 v72, 0, v12, vcc
    v_mov_b32 v73, v72
    v_mov_b32 v74, v72
    v_mov_b32 v75, v72
    v_cmp_eq_u32 vcc, 3, v11
    s_nop 1
    v_cndmask_b32 v76, 0, v12, vcc
    v_mov_b32 v77, v76
    v_mov_b32 v78, v76
    v_mov_b32 v79, v76
    v_cmp_eq_u32 vcc, 4, v11
    s_nop 1
    v_cndmask_b32 v80, 0, v12, vcc
    v_mov_b32 v81, v80
    v_mov_b32 v82, v80
    v_mov_b32 v83, v80
    v_cmp_eq_u32 vcc, 5, v11
    s_nop 1
    v_cndmask_b32 v84, 0, v12, vcc
    v_mov_b32 v85, v84
    v_mov_b32 v86, v84
    v_mov_b32 v87, v84
    v_cmp_eq_u32 vcc, 6, v11
    s_nop 1
    v_cndmask_b32 v88, 0, v12, vcc
    v_mov_b32 v89, v88
    v_mov_b32 v90, v88
    v_mov_b32 v91, v88
    v_cmp_gt_u32 vcc, 7, v11
    s_nop 1
    s_mov_b64 s[72:73], vcc
    s_lshl_b32 s42, s16, 8
    s_add_u32 s42, s42, s2
    s_mul_i32 s43, s42, 1639
    s_lshr_b32 s43, s43, 16
    s_mul_i32 s44, s43, 40
    s_sub_u32 s44, s42, s44
    s_mul_i32 s46, s44, 7168
    s_lshr_b32 s44, s44, 1
    s_mul_i32 s44, s44, 110592
    s_mul_i32 s43, s43, 224
    s_add_u32 s44, s44, s43
    s_lshl_b32 s43, s43, 1
    s_add_u32 s46, s46, s43
    s_add_u32 s46, s46, 15138816
    s_mul_i32 s45, s42, 7168
    s_add_u32 s45, s45, 24117248
    s_cmp_lt_u32 s42, 640
    s_cselect_b32 s44, s44, 33554432
    s_cselect_b32 s45, s45, 33554432
    s_cselect_b32 s46, s46, 33554432
    s_mul_i32 s43, s42, 3277
    s_lshr_b32 s43, s43, 16
    s_mul_i32 s47, s79, 1280
    s_mul_i32 s43, s43, 160
    s_add_u32 s47, s47, s43
    s_mul_i32 s48, s42, 5120
    s_add_u32 s48, s48, 28835840
    s_sub_u32 s49, s42, 160
    s_mul_i32 s43, s49, 1214
    s_lshr_b32 s43, s43, 16
    s_mul_i32 s40, s43, 54
    s_sub_u32 s40, s49, s40
    s_mul_i32 s41, s43, 56
    s_add_u32 s41, s41, s40
    s_mul_i32 s41, s41, 5120
    s_add_u32 s41, s41, 29884416
    s_mul_i32 s40, s40, 40960
    s_mul_i32 s43, s43, 160
    s_add_u32 s40, s40, s43
    s_cmp_lt_u32 s49, 432
    s_cselect_b32 s40, s40, 33554432
    s_cselect_b32 s41, s41, 33554432
    s_cmp_lt_u32 s42, 160
    s_cselect_b32 s47, s47, s40
    s_cselect_b32 s48, s48, s41
    s_mov_b32 s75, 2215936
    s_waitcnt lgkmcnt(0)
    s_cselect_b32 s60, s54, s60
    s_cselect_b32 s61, s55, s61
    s_cselect_b32 s74, 823296, s75
    s_bitcmp1_b32 s2, 0
    s_cselect_b32 s56, s58, s56
    s_cselect_b32 s57, s59, s57
    s_sub_u32 s56, s56, 4096
    s_subb_u32 s57, s57, 0
    s_sub_u32 s60, s60, 4096
    s_subb_u32 s61, s61, 0
    s_mov_b32 s64, s56
    s_and_b32 s65, s57, 0xffff
    s_mov_b32 s66, 2215936
    s_mov_b32 s67, 0x20000
    s_mov_b32 s68, s60
    s_and_b32 s69, s61, 0xffff
    s_mov_b32 s70, 0
    s_mov_b32 s71, 0x20000
    s_mov_b32 s70, s74
    s_waitcnt vmcnt(0)
    s_barrier
    s_barrier
    s_lshl_b32 s36, s16, 12
    s_add_u32 m0, s36, 0
    s_add_u32 s37, s36, s33
    s_add_u32 s37, s37, 0
    s_sub_u32 s38, 7, s16
    s_lshr_b32 s38, s38, 2
Lat_lda:
    buffer_load_dwordx4 v3, s[12:15], s37 offen offset:0 sc1 lds
    buffer_load_dwordx4 v3, s[12:15], s37 offen offset:1024 sc1 lds
    buffer_load_dwordx4 v3, s[12:15], s37 offen offset:2048 sc1 lds
    buffer_load_dwordx4 v3, s[12:15], s37 offen offset:3072 sc1 lds
    s_add_u32 m0, m0, 16384
    s_add_u32 s37, s37, 16384
    s_sub_u32 s38, s38, 1
    s_cmp_lg_u32 s38, 0
    s_cbranch_scc1 Lat_lda
    s_lshl_b32 s36, s16, 12
    s_add_u32 m0, s36, 16384
    s_add_u32 s37, s36, s33
    s_add_u32 s37, s37, 16384
    s_sub_u32 s38, 13, s16
    s_lshr_b32 s38, s38, 2
Lat_ldb:
    buffer_load_dwordx4 v3, s[12:15], s37 offen offset:0 sc1 lds
    buffer_load_dwordx4 v3, s[12:15], s37 offen offset:1024 sc1 lds
    buffer_load_dwordx4 v3, s[12:15], s37 offen offset:2048 sc1 lds
    buffer_load_dwordx4 v3, s[12:15], s37 offen offset:3072 sc1 lds
    s_add_u32 m0, m0, 16384
    s_add_u32 s37, s37, 16384
    s_sub_u32 s38, s38, 1
    s_cmp_lg_u32 s38, 0
    s_cbranch_scc1 Lat_ldb
    s_cmp_lt_u32 s16, 2
    s_cbranch_scc1 Lat_h0
    s_waitcnt vmcnt(8)
Lat_h0:
    s_waitcnt vmcnt(12)
    s_barrier
    s_waitcnt vmcnt(0)
    s_mov_b64 exec, 1
    ds_add_u32 v15, v30
    s_mov_b64 exec, -1
    s_lshl_b32 s36, s16, 12
    s_add_u32 m0, s36, 57344
    s_add_u32 s37, s36, s33
    s_add_u32 s37, s37, 57344
    s_sub_u32 s38, 22, s16
    s_lshr_b32 s38, s38, 2
Lat_ldc:
    buffer_load_dwordx4 v3, s[12:15], s37 offen offset:0 sc1 lds
    buffer_load_dwordx4 v3, s[12:15], s37 offen offset:1024 sc1 lds
    buffer_load_dwordx4 v3, s[12:15], s37 offen offset:2048 sc1 lds
    buffer_load_dwordx4 v3, s[12:15], s37 offen offset:3072 sc1 lds
    s_add_u32 m0, m0, 16384
    s_add_u32 s37, s37, 16384
    s_sub_u32 s38, s38, 1
    s_cmp_lg_u32 s38, 0
    s_cbranch_scc1 Lat_ldc
    s_cmp_eq_u32 s16, 3
    s_cbranch_scc1 Lat_h3
    s_add_u32 m0, s39, 0
    s_nop 0
    buffer_load_dwordx4 v16, s[64:67], s44 offen offset:0 lds
    buffer_load_dwordx4 v17, s[64:67], s44 offen offset:1024 lds
    buffer_load_dwordx4 v18, s[64:67], s44 offen offset:2048 lds
    buffer_load_dwordx4 v19, s[64:67], s44 offen offset:3072 lds
    s_add_u32 m0, s39, 4096
    s_nop 0
    buffer_load_dwordx4 v20, s[64:67], s44 offen offset:0 lds
    buffer_load_dwordx4 v21, s[64:67], s44 offen offset:1024 lds
    buffer_load_dwordx4 v22, s[64:67], s44 offen offset:2048 lds
    s_waitcnt vmcnt(7)
    s_mov_b64 exec, 1
    ds_add_u32 v15, v30 offset:4
    s_mov_b64 exec, -1
    s_waitcnt vmcnt(0)
    ds_read_b64_tr_b16 v[36:37], v23 offset:0
    ds_read_b64_tr_b16 v[38:39], v23 offset:1792
    ds_read_b64_tr_b16 v[40:41], v23 offset:32
    ds_read_b64_tr_b16 v[42:43], v23 offset:1824
    ds_read_b64_tr_b16 v[44:45], v23 offset:64
    ds_read_b64_tr_b16 v[46:47], v23 offset:1856
    ds_read_b64_tr_b16 v[48:49], v23 offset:96
    ds_read_b64_tr_b16 v[50:51], v23 offset:1888
    ds_read_b64_tr_b16 v[52:53], v23 offset:128
    ds_read_b64_tr_b16 v[54:55], v23 offset:1920
    ds_read_b64_tr_b16 v[56:57], v23 offset:160
    ds_read_b64_tr_b16 v[58:59], v23 offset:1952
    ds_read_b64_tr_b16 v[60:61], v23 offset:192
    ds_read_b64_tr_b16 v[62:63], v23 offset:1984
    s_add_u32 s44, s45, 4096
    s_waitcnt lgkmcnt(0)
    s_add_u32 m0, s39, 0
    s_nop 0
    buffer_load_dwordx4 v25, s[68:71], s47 offen offset:0 lds
    buffer_load_dwordx4 v26, s[68:71], s47 offen offset:1024 lds
    buffer_load_dwordx4 v27, s[68:71], s47 offen offset:2048 lds
    buffer_load_dwordx4 v28, s[68:71], s47 offen offset:3072 lds
    s_add_u32 m0, s39, 4096
    s_nop 0
    buffer_load_dwordx4 v29, s[68:71], s47 offen offset:0 lds
    v_mfma_f32_16x16x32_bf16 v[92:95], v[36:39], v[64:67], 0
    buffer_store_dwordx4 v[36:39], v3, s[12:15], s45 offen offset:0 sc1
    v_mfma_f32_16x16x32_bf16 v[92:95], v[40:43], v[68:71], v[92:95]
    buffer_store_dwordx4 v[40:43], v3, s[12:15], s45 offen offset:1024 sc1
    v_mfma_f32_16x16x32_bf16 v[92:95], v[44:47], v[72:75], v[92:95]
    buffer_store_dwordx4 v[44:47], v3, s[12:15], s45 offen offset:2048 sc1
    v_mfma_f32_16x16x32_bf16 v[92:95], v[48:51], v[76:79], v[92:95]
    buffer_store_dwordx4 v[48:51], v3, s[12:15], s45 offen offset:3072 sc1
    v_mfma_f32_16x16x32_bf16 v[92:95], v[52:55], v[80:83], v[92:95]
    buffer_store_dwordx4 v[52:55], v3, s[12:15], s44 offen offset:0 sc1
    v_mfma_f32_16x16x32_bf16 v[92:95], v[56:59], v[84:87], v[92:95]
    buffer_store_dwordx4 v[56:59], v3, s[12:15], s44 offen offset:1024 sc1
    v_mfma_f32_16x16x32_bf16 v[92:95], v[60:63], v[88:91], v[92:95]
    buffer_store_dwordx4 v[60:63], v3, s[12:15], s44 offen offset:2048 sc1
    s_nop 7
    s_mov_b64 exec, s[72:73]
    buffer_store_dwordx4 v[92:95], v33, s[12:15], s46 offen sc1
    s_mov_b64 exec, -1
    s_waitcnt vmcnt(0)
    ds_read_b64_tr_b16 v[36:37], v24 offset:0
    ds_read_b64_tr_b16 v[38:39], v24 offset:1280
    ds_read_b64_tr_b16 v[40:41], v24 offset:32
    ds_read_b64_tr_b16 v[42:43], v24 offset:1312
    ds_read_b64_tr_b16 v[44:45], v24 offset:64
    ds_read_b64_tr_b16 v[46:47], v24 offset:1344
    ds_read_b64_tr_b16 v[48:49], v24 offset:96
    ds_read_b64_tr_b16 v[50:51], v24 offset:1376
    ds_read_b64_tr_b16 v[52:53], v24 offset:128
    ds_read_b64_tr_b16 v[54:55], v24 offset:1408
    s_add_u32 s44, s48, 4096
    s_waitcnt lgkmcnt(0)
    buffer_store_dwordx4 v[36:39], v3, s[12:15], s48 offen offset:0 sc1
    buffer_store_dwordx4 v[40:43], v3, s[12:15], s48 offen offset:1024 sc1
    buffer_store_dwordx4 v[44:47], v3, s[12:15], s48 offen offset:2048 sc1
    buffer_store_dwordx4 v[48:51], v3, s[12:15], s48 offen offset:3072 sc1
    buffer_store_dwordx4 v[52:55], v3, s[12:15], s44 offen offset:0 sc1
    s_branch Lat_lp
Lat_h3:
    s_waitcnt vmcnt(0)
    s_mov_b64 exec, 1
    ds_add_u32 v15, v30 offset:4
    s_mov_b64 exec, -1
Lat_lp:
    ds_read_b32 v10, v15 offset:16
    s_waitcnt lgkmcnt(0)
    v_readfirstlane_b32 s43, v10
    s_cmp_ge_u32 s43, 4
    s_cbranch_scc1 Lat_lq
    s_sleep 4
    s_branch Lat_lp
Lat_lq:
    s_lshl_b32 s36, s16, 12
    s_add_u32 m0, s36, 0
    s_add_u32 s37, s36, s33
    s_add_u32 s37, s37, 129024
    s_sub_u32 s38, 13, s16
    s_lshr_b32 s38, s38, 2
Lat_ldd:
    buffer_load_dwordx4 v3, s[12:15], s37 offen offset:0 sc1 lds
    buffer_load_dwordx4 v3, s[12:15], s37 offen offset:1024 sc1 lds
    buffer_load_dwordx4 v3, s[12:15], s37 offen offset:2048 sc1 lds
    buffer_load_dwordx4 v3, s[12:15], s37 offen offset:3072 sc1 lds
    s_add_u32 m0, m0, 16384
    s_add_u32 s37, s37, 16384
    s_sub_u32 s38, s38, 1
    s_cmp_lg_u32 s38, 0
    s_cbranch_scc1 Lat_ldd
    s_cmp_lg_u32 s16, 2
    s_cbranch_scc1 Lat_h4
    buffer_load_dwordx4 v3, s[12:15], s37 offen sc1 lds
    buffer_load_dwordx4 v3, s[12:15], s37 offen offset:1024 sc1 lds
Lat_h4:
    s_waitcnt vmcnt(0)
    s_mov_b64 exec, 1
    ds_add_u32 v15, v30 offset:12
    s_mov_b64 exec, -1
    s_and_b32 s17, s30, 3
    s_lshl_b32 s17, s17, 3
    s_and_b32 s32, s31, 7
    s_add_u32 s17, s17, s32
    s_lshr_b32 s18, s30, 2
    s_lshl_b32 s18, s18, 2
    s_lshr_b32 s33, s31, 3
    s_add_u32 s18, s18, s33
    s_and_b32 s19, s30, 1
    s_lshl_b32 s19, s19, 3
    s_add_u32 s19, s19, s32
    s_lshr_b32 s20, s30, 1
    s_lshl_b32 s20, s20, 2
    s_add_u32 s20, s20, s33
    s_lshr_b32 s21, s17, 1
    s_add_u32 s28, s19, 16
    s_add_u32 s29, s21, 16
    s_add_u32 s55, s30, 64
    v_mov_b32 v10, 1
    s_mov_b64 exec, 1
    ds_add_rtn_u32 v11, v15, v10 offset:24
    s_waitcnt lgkmcnt(0)
    s_mov_b64 exec, -1
    v_readfirstlane_b32 s43, v11
    s_cmp_lg_u32 s43, 3
    s_cbranch_scc1 Ltl_ry
    s_lshl_b32 s32, s55, 8
    s_add_u32 s32, s32, 15073280
    v_mov_b32 v10, 0
    v_mov_b32 v11, 1
    s_mov_b64 exec, 1
    buffer_atomic_add v11, v10, s[12:15], s32 offen sc1
    s_mov_b64 exec, -1
    v_lshlrev_b32 v10, 8, v2
    s_mov_b32 s32, 15089664
    s_mov_b64 exec, 0xff
    s_mov_b32 s57, 2097152
Ltl_rw:
    s_sleep 24
    buffer_load_dword v11, v10, s[12:15], s32 offen sc1
    s_sub_u32 s57, s57, 1
    s_cbranch_scc1 Ltl_rv
    s_waitcnt vmcnt(0)
    v_cmp_gt_u32 vcc, 32, v11
    s_cbranch_vccnz Ltl_rw
Ltl_rv:
    s_mov_b64 exec, 1
    buffer_inv sc1
    v_mov_b32 v10, 1
    s_waitcnt vmcnt(0)
    ds_write_b32 v15, v10 offset:28
    s_mov_b64 exec, -1
Ltl_ry:
    ds_read_b32 v10, v15 offset:28
    s_waitcnt lgkmcnt(0)
    v_readfirstlane_b32 s43, v10
    s_cmp_lg_u32 s43, 0
    s_cbranch_scc1 Ltl_p2v
    s_sleep 8
    s_branch Ltl_ry
Ltl_p2v:
Ltl_p2w:
    ds_read_b32 v10, v15 offset:20
    s_waitcnt lgkmcnt(0)
    v_readfirstlane_b32 s43, v10
    s_cmp_ge_u32 s43, 4
    s_cbranch_scc1 Ltl_p2x
    s_sleep 8
    s_branch Ltl_p2w
Ltl_p2x:
    s_mul_i32 s34, s18, 20
    s_mul_i32 s36, s16, 5
    s_add_u32 s34, s34, s36
    s_mul_i32 s34, s34, 5120
    s_add_u32 s34, s34, 28835840
    s_mul_i32 s36, s16, 25600
    s_add_u32 m0, s36, 54272
    s_nop 0
    buffer_load_dwordx4 v3, s[12:15], s34 offen offset:0 lds
    buffer_load_dwordx4 v3, s[12:15], s34 offen offset:1024 lds
    buffer_load_dwordx4 v3, s[12:15], s34 offen offset:2048 lds
    buffer_load_dwordx4 v3, s[12:15], s34 offen offset:3072 lds
    s_add_u32 m0, m0, 4096
    s_add_u32 s34, s34, 4096
    buffer_load_dwordx4 v3, s[12:15], s34 offen offset:0 lds
    buffer_load_dwordx4 v3, s[12:15], s34 offen offset:1024 lds
    buffer_load_dwordx4 v3, s[12:15], s34 offen offset:2048 lds
    buffer_load_dwordx4 v3, s[12:15], s34 offen offset:3072 lds
    s_add_u32 m0, m0, 4096
    s_add_u32 s34, s34, 4096
    buffer_load_dwordx4 v3, s[12:15], s34 offen offset:0 lds
    buffer_load_dwordx4 v3, s[12:15], s34 offen offset:1024 lds
    buffer_load_dwordx4 v3, s[12:15], s34 offen offset:2048 lds
    buffer_load_dwordx4 v3, s[12:15], s34 offen offset:3072 lds
    s_add_u32 m0, m0, 4096
    s_add_u32 s34, s34, 4096
    buffer_load_dwordx4 v3, s[12:15], s34 offen offset:0 lds
    buffer_load_dwordx4 v3, s[12:15], s34 offen offset:1024 lds
    buffer_load_dwordx4 v3, s[12:15], s34 offen offset:2048 lds
    buffer_load_dwordx4 v3, s[12:15], s34 offen offset:3072 lds
    s_add_u32 m0, m0, 4096
    s_add_u32 s34, s34, 4096
    buffer_load_dwordx4 v3, s[12:15], s34 offen offset:0 lds
    buffer_load_dwordx4 v3, s[12:15], s34 offen offset:1024 lds
    buffer_load_dwordx4 v3, s[12:15], s34 offen offset:2048 lds
    buffer_load_dwordx4 v3, s[12:15], s34 offen offset:3072 lds
    s_add_u32 m0, m0, 4096
    s_add_u32 s34, s34, 4096
    buffer_load_dwordx4 v3, s[12:15], s34 offen offset:0 lds
    buffer_load_dwordx4 v3, s[12:15], s34 offen offset:1024 lds
    buffer_load_dwordx4 v3, s[12:15], s34 offen offset:2048 lds
    buffer_load_dwordx4 v3, s[12:15], s34 offen offset:3072 lds
    s_add_u32 m0, m0, 4096
    s_add_u32 s34, s34, 4096
    buffer_load_dwordx4 v3, s[12:15], s34 offen offset:0 lds
    s_mul_i32 s34, s20, 40
    s_add_u32 s34, s34, s16
    s_mul_i32 s34, s34, 7168
    s_add_u32 s34, s34, 24117248
    s_mul_i32 s36, s16, 7168
    s_cmp_lg_u32 s16, 0
    s_cbranch_scc1 Ltl_p0
    v_cmp_lt_u32 vcc, 27, v2
    v_mov_b32 v4, 6720
    s_mul_i32 s32, s20, 448
    v_cndmask_b32 v4, 0, v4, vcc
    s_add_u32 s32, s32, 15138816
    v_add_u32 v4, v4, v3
    s_mov_b32 exec_hi, 0xffffff
    buffer_load_dwordx4 v[16:19], v4, s[12:15], s32 offen
    s_add_u32 s32, s32, 14336
    buffer_load_dwordx4 v[20:23], v4, s[12:15], s32 offen
    s_add_u32 s32, s32, 14336
    buffer_load_dwordx4 v[24:27], v4, s[12:15], s32 offen
    s_add_u32 s32, s32, 14336
    buffer_load_dwordx4 v[28:31], v4, s[12:15], s32 offen
    s_add_u32 s32, s32, 14336
    buffer_load_dwordx4 v[32:35], v4, s[12:15], s32 offen
    s_add_u32 s32, s32, 14336
    buffer_load_dwordx4 v[36:39], v4, s[12:15], s32 offen
    s_add_u32 s32, s32, 14336
    buffer_load_dwordx4 v[40:43], v4, s[12:15], s32 offen
    s_add_u32 s32, s32, 14336
    buffer_load_dwordx4 v[44:47], v4, s[12:15], s32 offen
    s_add_u32 s32, s32, 14336
    buffer_load_dwordx4 v[48:51], v4, s[12:15], s32 offen
    s_add_u32 s32, s32, 14336
    buffer_load_dwordx4 v[52:55], v4, s[12:15], s32 offen
    s_add_u32 s32, s32, 14336
    buffer_load_dwordx4 v[56:59], v4, s[12:15], s32 offen
    s_add_u32 s32, s32, 14336
    buffer_load_dwordx4 v[60:63], v4, s[12:15], s32 offen
    s_add_u32 s32, s32, 14336
    buffer_load_dwordx4 v[64:67], v4, s[12:15], s32 offen
    s_add_u32 s32, s32, 14336
    buffer_load_dwordx4 v[68:71], v4, s[12:15], s32 offen
    s_add_u32 s32, s32, 14336
    buffer_load_dwordx4 v[72:75], v4, s[12:15], s32 offen
    s_add_u32 s32, s32, 14336
    buffer_load_dwordx4 v[76:79], v4, s[12:15], s32 offen
    s_add_u32 s32, s32, 14336
    buffer_load_dwordx4 v[80:83], v4, s[12:15], s32 offen
    s_add_u32 s32, s32, 14336
    buffer_load_dwordx4 v[84:87], v4, s[12:15], s32 offen
    s_add_u32 s32, s32, 14336
    buffer_load_dwordx4 v[88:91], v4, s[12:15], s32 offen
    s_add_u32 s32, s32, 14336
    buffer_load_dwordx4 v[92:95], v4, s[12:15], s32 offen
    s_add_u32 s32, s32, 14336
    s_waitcnt vmcnt(18)
    v_pk_add_f32 v[16:17], v[16:17], v[20:21]
    v_pk_add_f32 v[18:19], v[18:19], v[22:23]
    s_waitcnt vmcnt(17)
    v_pk_add_f32 v[16:17], v[16:17], v[24:25]
    v_pk_add_f32 v[18:19], v[18:19], v[26:27]
    s_waitcnt vmcnt(16)
    v_pk_add_f32 v[16:17], v[16:17], v[28:29]
    v_pk_add_f32 v[18:19], v[18:19], v[30:31]
    s_waitcnt vmcnt(15)
    v_pk_add_f32 v[16:17], v[16:17], v[32:33]
    v_pk_add_f32 v[18:19], v[18:19], v[34:35]
    s_waitcnt vmcnt(14)
    v_pk_add_f32 v[16:17], v[16:17], v[36:37]
    v_pk_add_f32 v[18:19], v[18:19], v[38:39]
    s_waitcnt vmcnt(13)
    v_pk_add_f32 v[16:17], v[16:17], v[40:41]
    v_pk_add_f32 v[18:19], v[18:19], v[42:43]
    s_waitcnt vmcnt(12)
    v_pk_add_f32 v[16:17], v[16:17], v[44:45]
    v_pk_add_f32 v[18:19], v[18:19], v[46:47]
    s_waitcnt vmcnt(11)
    v_pk_add_f32 v[16:17], v[16:17], v[48:49]
    v_pk_add_f32 v[18:19], v[18:19], v[50:51]
    s_waitcnt vmcnt(10)
    v_pk_add_f32 v[16:17], v[16:17], v[52:53]
    v_pk_add_f32 v[18:19], v[18:19], v[54:55]
    s_waitcnt vmcnt(9)
    v_pk_add_f32 v[16:17], v[16:17], v[56:57]
    v_pk_add_f32 v[18:19], v[18:19], v[58:59]
    s_waitcnt vmcnt(8)
    v_pk_add_f32 v[16:17], v[16:17], v[60:61]
    v_pk_add_f32 v[18:19], v[18:19], v[62:63]
    s_waitcnt vmcnt(7)
    v_pk_add_f32 v[16:17], v[16:17], v[64:65]
    v_pk_add_f32 v[18:19], v[18:19], v[66:67]
    s_waitcnt vmcnt(6)
    v_pk_add_f32 v[16:17], v[16:17], v[68:69]
    v_pk_add_f32 v[18:19], v[18:19], v[70:71]
    s_waitcnt vmcnt(5)
    v_pk_add_f32 v[16:17], v[16:17], v[72:73]
    v_pk_add_f32 v[18:19], v[18:19], v[74:75]
    s_waitcnt vmcnt(4)
    v_pk_add_f32 v[16:17], v[16:17], v[76:77]
    v_pk_add_f32 v[18:19], v[18:19], v[78:79]
    s_waitcnt vmcnt(3)
    v_pk_add_f32 v[16:17], v[16:17], v[80:81]
    v_pk_add_f32 v[18:19], v[18:19], v[82:83]
    s_waitcnt vmcnt(2)
    v_pk_add_f32 v[16:17], v[16:17], v[84:85]
    v_pk_add_f32 v[18:19], v[18:19], v[86:87]
    s_waitcnt vmcnt(1)
    v_pk_add_f32 v[16:17], v[16:17], v[88:89]
    v_pk_add_f32 v[18:19], v[18:19], v[90:91]
    s_waitcnt vmcnt(0)
    v_pk_add_f32 v[16:17], v[16:17], v[92:93]
    v_pk_add_f32 v[18:19], v[18:19], v[94:95]
    v_add_u32 v4, 156736, v3
    ds_write_b128 v4, v[16:19]
    s_mov_b64 exec, -1
    s_waitcnt lgkmcnt(0)
Ltl_p0:
    s_waitcnt vmcnt(0)
    s_barrier
    s_barrier
    s_sleep 3
    s_add_u32 m0, s36, 0
    s_add_u32 s35, s34, 4096
    buffer_load_dwordx4 v3, s[12:15], s34 offen offset:0 lds
    buffer_load_dwordx4 v3, s[12:15], s34 offen offset:1024 lds
    buffer_load_dwordx4 v3, s[12:15], s34 offen offset:2048 lds
    buffer_load_dwordx4 v3, s[12:15], s34 offen offset:3072 lds
    s_add_u32 m0, m0, 4096
    s_add_u32 s34, s34, 28672
    buffer_load_dwordx4 v3, s[12:15], s35 offen offset:0 lds
    buffer_load_dwordx4 v3, s[12:15], s35 offen offset:1024 lds
    buffer_load_dwordx4 v3, s[12:15], s35 offen offset:2048 lds
    s_add_u32 m0, s36, 28672
    s_add_u32 s35, s34, 4096
    buffer_load_dwordx4 v3, s[12:15], s34 offen offset:0 lds
    buffer_load_dwordx4 v3, s[12:15], s34 offen offset:1024 lds
    buffer_load_dwordx4 v3, s[12:15], s34 offen offset:2048 lds
    buffer_load_dwordx4 v3, s[12:15], s34 offen offset:3072 lds
    s_add_u32 m0, m0, 4096
    s_add_u32 s34, s34, 28672
    buffer_load_dwordx4 v3, s[12:15], s35 offen offset:0 lds
    buffer_load_dwordx4 v3, s[12:15], s35 offen offset:1024 lds
    buffer_load_dwordx4 v3, s[12:15], s35 offen offset:2048 lds
    s_add_u32 m0, s36, 57344
    s_add_u32 s35, s34, 4096
    buffer_load_dwordx4 v3, s[12:15], s34 offen offset:0 lds
    buffer_load_dwordx4 v3, s[12:15], s34 offen offset:1024 lds
    buffer_load_dwordx4 v3, s[12:15], s34 offen offset:2048 lds
    buffer_load_dwordx4 v3, s[12:15], s34 offen offset:3072 lds
    s_add_u32 m0, m0, 4096
    s_add_u32 s34, s34, 28672
    buffer_load_dwordx4 v3, s[12:15], s35 offen offset:0 lds
    buffer_load_dwordx4 v3, s[12:15], s35 offen offset:1024 lds
    buffer_load_dwordx4 v3, s[12:15], s35 offen offset:2048 lds
    s_waitcnt vmcnt(14)
    s_barrier
    s_add_u32 m0, s36, 86016
    s_add_u32 s35, s34, 4096
    buffer_load_dwordx4 v3, s[12:15], s34 offen offset:0 lds
    buffer_load_dwordx4 v3, s[12:15], s34 offen offset:1024 lds
    buffer_load_dwordx4 v3, s[12:15], s34 offen offset:2048 lds
    buffer_load_dwordx4 v3, s[12:15], s34 offen offset:3072 lds
    s_add_u32 m0, m0, 4096
    s_add_u32 s34, s34, 28672
    buffer_load_dwordx4 v3, s[12:15], s35 offen offset:0 lds
    buffer_load_dwordx4 v3, s[12:15], s35 offen offset:1024 lds
    buffer_load_dwordx4 v3, s[12:15], s35 offen offset:2048 lds
    s_waitcnt vmcnt(14)
    s_barrier
    s_add_u32 m0, s36, 0
    s_add_u32 s35, s34, 4096
    buffer_load_dwordx4 v3, s[12:15], s34 offen offset:0 lds
    buffer_load_dwordx4 v3, s[12:15], s34 offen offset:1024 lds
    buffer_load_dwordx4 v3, s[12:15], s34 offen offset:2048 lds
    buffer_load_dwordx4 v3, s[12:15], s34 offen offset:3072 lds
    s_add_u32 m0, m0, 4096
    s_add_u32 s34, s34, 28672
    buffer_load_dwordx4 v3, s[12:15], s35 offen offset:0 lds
    buffer_load_dwordx4 v3, s[12:15], s35 offen offset:1024 lds
    buffer_load_dwordx4 v3, s[12:15], s35 offen offset:2048 lds
    s_waitcnt vmcnt(14)
    s_barrier
    s_add_u32 m0, s36, 28672
    s_add_u32 s35, s34, 4096
    buffer_load_dwordx4 v3, s[12:15], s34 offen offset:0 lds
    buffer_load_dwordx4 v3, s[12:15], s34 offen offset:1024 lds
    buffer_load_dwordx4 v3, s[12:15], s34 offen offset:2048 lds
    buffer_load_dwordx4 v3, s[12:15], s34 offen offset:3072 lds
    s_add_u32 m0, m0, 4096
    s_add_u32 s34, s34, 28672
    buffer_load_dwordx4 v3, s[12:15], s35 offen offset:0 lds
    buffer_load_dwordx4 v3, s[12:15], s35 offen offset:1024 lds
    buffer_load_dwordx4 v3, s[12:15], s35 offen offset:2048 lds
    s_waitcnt vmcnt(14)
    s_barrier
    s_add_u32 m0, s36, 57344
    s_add_u32 s35, s34, 4096
    buffer_load_dwordx4 v3, s[12:15], s34 offen offset:0 lds
    buffer_load_dwordx4 v3, s[12:15], s34 offen offset:1024 lds
    buffer_load_dwordx4 v3, s[12:15], s34 offen offset:2048 lds
    buffer_load_dwordx4 v3, s[12:15], s34 offen offset:3072 lds
    s_add_u32 m0, m0, 4096
    s_add_u32 s34, s34, 28672
    buffer_load_dwordx4 v3, s[12:15], s35 offen offset:0 lds
    buffer_load_dwordx4 v3, s[12:15], s35 offen offset:1024 lds
    buffer_load_dwordx4 v3, s[12:15], s35 offen offset:2048 lds
    s_waitcnt vmcnt(14)
    s_barrier
    s_add_u32 m0, s36, 86016
    s_add_u32 s35, s34, 4096
    buffer_load_dwordx4 v3, s[12:15], s34 offen offset:0 lds
    buffer_load_dwordx4 v3, s[12:15], s34 offen offset:1024 lds
    buffer_load_dwordx4 v3, s[12:15], s34 offen offset:2048 lds
    buffer_load_dwordx4 v3, s[12:15], s34 offen offset:3072 lds
    s_add_u32 m0, m0, 4096
    s_add_u32 s34, s34, 28672
    buffer_load_dwordx4 v3, s[12:15], s35 offen offset:0 lds
    buffer_load_dwordx4 v3, s[12:15], s35 offen offset:1024 lds
    buffer_load_dwordx4 v3, s[12:15], s35 offen offset:2048 lds
    s_waitcnt vmcnt(14)
    s_barrier
    s_add_u32 m0, s36, 0
    s_add_u32 s35, s34, 4096
    buffer_load_dwordx4 v3, s[12:15], s34 offen offset:0 lds
    buffer_load_dwordx4 v3, s[12:15], s34 offen offset:1024 lds
    buffer_load_dwordx4 v3, s[12:15], s34 offen offset:2048 lds
    buffer_load_dwordx4 v3, s[12:15], s34 offen offset:3072 lds
    s_add_u32 m0, m0, 4096
    s_add_u32 s34, s34, 28672
    buffer_load_dwordx4 v3, s[12:15], s35 offen offset:0 lds
    buffer_load_dwordx4 v3, s[12:15], s35 offen offset:1024 lds
    buffer_load_dwordx4 v3, s[12:15], s35 offen offset:2048 lds
    s_waitcnt vmcnt(14)
    s_barrier
    s_add_u32 m0, s36, 28672
    s_add_u32 s35, s34, 4096
    buffer_load_dwordx4 v3, s[12:15], s34 offen offset:0 lds
    buffer_load_dwordx4 v3, s[12:15], s34 offen offset:1024 lds
    buffer_load_dwordx4 v3, s[12:15], s34 offen offset:2048 lds
    buffer_load_dwordx4 v3, s[12:15], s34 offen offset:3072 lds
    s_add_u32 m0, m0, 4096
    s_add_u32 s34, s34, 28672
    buffer_load_dwordx4 v3, s[12:15], s35 offen offset:0 lds
    buffer_load_dwordx4 v3, s[12:15], s35 offen offset:1024 lds
    buffer_load_dwordx4 v3, s[12:15], s35 offen offset:2048 lds
    s_waitcnt vmcnt(14)
    s_barrier
    s_waitcnt vmcnt(7)
    s_barrier
    s_waitcnt vmcnt(0)
    s_barrier
    s_barrier
    s_mul_i32 s34, s18, 286720
    s_lshl_b32 s36, s16, 10
    s_add_u32 s34, s34, s36
    s_add_u32 s34, s34, 29884416
    s_add_u32 m0, s36, 0
    s_nop 0
    buffer_load_dwordx4 v3, s[12:15], s34 offen lds
    s_add_u32 s34, s34, 4096
    s_add_u32 m0, s36, 4096
    s_nop 0
    buffer_load_dwordx4 v3, s[12:15], s34 offen lds
    s_add_u32 s34, s34, 4096
    s_add_u32 m0, s36, 8192
    s_nop 0
    buffer_load_dwordx4 v3, s[12:15], s34 offen lds
    s_add_u32 s34, s34, 4096
    s_add_u32 m0, s36, 12288
    s_nop 0
    buffer_load_dwordx4 v3, s[12:15], s34 offen lds
    s_add_u32 s34, s34, 4096
    s_add_u32 m0, s36, 16384
    s_nop 0
    buffer_load_dwordx4 v3, s[12:15], s34 offen lds
    s_add_u32 s34, s34, 4096
    s_add_u32 m0, s36, 20480
    s_nop 0
    buffer_load_dwordx4 v3, s[12:15], s34 offen lds
    s_add_u32 s34, s34, 4096
    s_add_u32 m0, s36, 24576
    s_nop 0
    buffer_load_dwordx4 v3, s[12:15], s34 offen lds
    s_add_u32 s34, s34, 4096
    s_add_u32 m0, s36, 28672
    s_cmp_lt_u32 s16, 2
    s_cselect_b32 m0, m0, 157632
    s_cselect_b32 s35, s34, 33554432
    buffer_load_dwordx4 v3, s[12:15], s35 offen lds
    s_add_u32 s34, s34, 2048
    s_add_u32 m0, s36, 30720
    s_nop 0
    buffer_load_dwordx4 v3, s[12:15], s34 offen lds
    s_add_u32 s34, s34, 4096
    s_add_u32 m0, s36, 34816
    s_nop 0
    buffer_load_dwordx4 v3, s[12:15], s34 offen lds
    s_add_u32 s34, s34, 4096
    s_add_u32 m0, s36, 38912
    s_nop 0
    buffer_load_dwordx4 v3, s[12:15], s34 offen lds
    s_add_u32 s34, s34, 4096
    s_add_u32 m0, s36, 43008
    s_nop 0
    buffer_load_dwordx4 v3, s[12:15], s34 offen lds
    s_add_u32 s34, s34, 4096
    s_add_u32 m0, s36, 47104
    s_nop 0
    buffer_load_dwordx4 v3, s[12:15], s34 offen lds
    s_add_u32 s34, s34, 4096
    s_add_u32 m0, s36, 51200
    s_nop 0
    buffer_load_dwordx4 v3, s[12:15], s34 offen lds
    s_add_u32 s34, s34, 4096
    s_add_u32 m0, s36, 55296
    s_nop 0
    buffer_load_dwordx4 v3, s[12:15], s34 offen lds
    s_add_u32 s34, s34, 4096
    s_add_u32 m0, s36, 59392
    s_cmp_lt_u32 s16, 2
    s_cselect_b32 m0, m0, 157632
    s_cselect_b32 s35, s34, 33554432
    buffer_load_dwordx4 v3, s[12:15], s35 offen lds
    s_add_u32 s34, s34, 2048
    s_add_u32 m0, s36, 61440
    s_nop 0
    buffer_load_dwordx4 v3, s[12:15], s34 offen lds
    s_add_u32 s34, s34, 4096
    s_add_u32 m0, s36, 65536
    s_nop 0
    buffer_load_dwordx4 v3, s[12:15], s34 offen lds
    s_add_u32 s34, s34, 4096
    s_add_u32 m0, s36, 69632
    s_nop 0
    buffer_load_dwordx4 v3, s[12:15], s34 offen lds
    s_add_u32 s34, s34, 4096
    s_add_u32 m0, s36, 73728
    s_nop 0
    buffer_load_dwordx4 v3, s[12:15], s34 offen lds
    s_add_u32 s34, s34, 4096
    s_add_u32 m0, s36, 77824
    s_nop 0
    buffer_load_dwordx4 v3, s[12:15], s34 offen lds
    s_add_u32 s34, s34, 4096
    s_add_u32 m0, s36, 81920
    s_nop 0
    buffer_load_dwordx4 v3, s[12:15], s34 offen lds
    s_add_u32 s34, s34, 4096
    s_add_u32 m0, s36, 86016
    s_nop 0
    buffer_load_dwordx4 v3, s[12:15], s34 offen lds
    s_add_u32 s34, s34, 4096
    s_add_u32 m0, s36, 90112
    s_cmp_lt_u32 s16, 2
    s_cselect_b32 m0, m0, 157632
    s_cselect_b32 s35, s34, 33554432
    buffer_load_dwordx4 v3, s[12:15], s35 offen lds
    s_add_u32 s34, s34, 2048
    s_barrier
    s_sleep 3
    s_add_u32 m0, s36, 92160
    s_nop 0
    buffer_load_dwordx4 v3, s[12:15], s34 offen lds
    s_add_u32 s34, s34, 4096
    s_add_u32 m0, s36, 96256
    s_nop 0
    buffer_load_dwordx4 v3, s[12:15], s34 offen lds
    s_add_u32 s34, s34, 4096
    s_add_u32 m0, s36, 100352
    s_nop 0
    buffer_load_dwordx4 v3, s[12:15], s34 offen lds
    s_add_u32 s34, s34, 4096
    s_add_u32 m0, s36, 104448
    s_nop 0
    buffer_load_dwordx4 v3, s[12:15], s34 offen lds
    s_add_u32 s34, s34, 4096
    s_add_u32 m0, s36, 108544
    s_nop 0
    buffer_load_dwordx4 v3, s[12:15], s34 offen lds
    s_add_u32 s34, s34, 4096
    s_add_u32 m0, s36, 112640
    s_nop 0
    buffer_load_dwordx4 v3, s[12:15], s34 offen lds
    s_add_u32 s34, s34, 4096
    s_add_u32 m0, s36, 116736
    s_nop 0
    buffer_load_dwordx4 v3, s[12:15], s34 offen lds
    s_add_u32 s34, s34, 4096
    s_add_u32 m0, s36, 120832
    s_cmp_lt_u32 s16, 2
    s_cselect_b32 m0, m0, 157632
    s_cselect_b32 s35, s34, 33554432
    buffer_load_dwordx4 v3, s[12:15], s35 offen lds
    s_add_u32 s34, s34, 2048
    s_add_u32 m0, s36, 122880
    s_nop 0
    buffer_load_dwordx4 v3, s[12:15], s34 offen lds
    s_add_u32 s34, s34, 4096
    s_add_u32 m0, s36, 126976
    s_nop 0
    buffer_load_dwordx4 v3, s[12:15], s34 offen lds
    s_add_u32 s34, s34, 4096
    s_add_u32 m0, s36, 131072
    s_nop 0
    buffer_load_dwordx4 v3, s[12:15], s34 offen lds
    s_add_u32 s34, s34, 4096
    s_add_u32 m0, s36, 135168
    s_nop 0
    buffer_load_dwordx4 v3, s[12:15], s34 offen lds
    s_add_u32 s34, s34, 4096
    s_add_u32 m0, s36, 139264
    s_nop 0
    buffer_load_dwordx4 v3, s[12:15], s34 offen lds
    s_add_u32 s34, s34, 4096
    s_add_u32 m0, s36, 143360
    s_nop 0
    buffer_load_dwordx4 v3, s[12:15], s34 offen lds
    s_add_u32 s34, s34, 4096
    s_add_u32 m0, s36, 147456
    s_nop 0
    buffer_load_dwordx4 v3, s[12:15], s34 offen lds
    s_add_u32 s34, s34, 4096
    s_add_u32 m0, s36, 151552
    s_cmp_lt_u32 s16, 2
    s_cselect_b32 m0, m0, 157632
    s_cselect_b32 s35, s34, 33554432
    buffer_load_dwordx4 v3, s[12:15], s35 offen lds
    s_add_u32 s34, s34, 2048
    s_waitcnt vmcnt(32)
    s_barrier
    s_waitcnt vmcnt(24)
    s_barrier
    s_add_u32 m0, s36, 0
    s_nop 0
    buffer_load_dwordx4 v3, s[12:15], s34 offen lds
    s_add_u32 s34, s34, 4096
    s_add_u32 m0, s36, 4096
    s_nop 0
    buffer_load_dwordx4 v3, s[12:15], s34 offen lds
    s_add_u32 s34, s34, 4096
    s_add_u32 m0, s36, 8192
    s_nop 0
    buffer_load_dwordx4 v3, s[12:15], s34 offen lds
    s_add_u32 s34, s34, 4096
    s_add_u32 m0, s36, 12288
    s_nop 0
    buffer_load_dwordx4 v3, s[12:15], s34 offen lds
    s_add_u32 s34, s34, 4096
    s_add_u32 m0, s36, 16384
    s_nop 0
    buffer_load_dwordx4 v3, s[12:15], s34 offen lds
    s_add_u32 s34, s34, 4096
    s_add_u32 m0, s36, 20480
    s_nop 0
    buffer_load_dwordx4 v3, s[12:15], s34 offen lds
    s_add_u32 s34, s34, 4096
    s_add_u32 m0, s36, 24576
    s_nop 0
    buffer_load_dwordx4 v3, s[12:15], s34 offen lds
    s_add_u32 s34, s34, 4096
    s_add_u32 m0, s36, 28672
    s_cmp_lt_u32 s16, 2
    s_cselect_b32 m0, m0, 157632
    s_cselect_b32 s35, s34, 33554432
    buffer_load_dwordx4 v3, s[12:15], s35 offen lds
    s_add_u32 s34, s34, 2048
    s_waitcnt vmcnt(24)
    s_barrier
    s_add_u32 m0, s36, 30720
    s_nop 0
    buffer_load_dwordx4 v3, s[12:15], s34 offen lds
    s_add_u32 s34, s34, 4096
    s_add_u32 m0, s36, 34816
    s_nop 0
    buffer_load_dwordx4 v3, s[12:15], s34 offen lds
    s_add_u32 s34, s34, 4096
    s_add_u32 m0, s36, 38912
    s_nop 0
    buffer_load_dwordx4 v3, s[12:15], s34 offen lds
    s_add_u32 s34, s34, 4096
    s_add_u32 m0, s36, 43008
    s_nop 0
    buffer_load_dwordx4 v3, s[12:15], s34 offen lds
    s_add_u32 s34, s34, 4096
    s_add_u32 m0, s36, 47104
    s_nop 0
    buffer_load_dwordx4 v3, s[12:15], s34 offen lds
    s_add_u32 s34, s34, 4096
    s_add_u32 m0, s36, 51200
    s_nop 0
    buffer_load_dwordx4 v3, s[12:15], s34 offen lds
    s_add_u32 s34, s34, 4096
    s_add_u32 m0, s36, 55296
    s_nop 0
    buffer_load_dwordx4 v3, s[12:15], s34 offen lds
    s_add_u32 s34, s34, 4096
    s_add_u32 m0, s36, 59392
    s_cmp_lt_u32 s16, 2
    s_cselect_b32 m0, m0, 157632
    s_cselect_b32 s35, s34, 33554432
    buffer_load_dwordx4 v3, s[12:15], s35 offen lds
    s_add_u32 s34, s34, 2048
    s_waitcnt vmcnt(24)
    s_barrier
    s_add_u32 m0, s36, 61440
    s_nop 0
    buffer_load_dwordx4 v3, s[12:15], s34 offen lds
    s_add_u32 s34, s34, 4096
    s_add_u32 m0, s36, 65536
    s_nop 0
    buffer_load_dwordx4 v3, s[12:15], s34 offen lds
    s_add_u32 s34, s34, 4096
    s_add_u32 m0, s36, 69632
    s_nop 0
    buffer_load_dwordx4 v3, s[12:15], s34 offen lds
    s_add_u32 s34, s34, 4096
    s_add_u32 m0, s36, 73728
    s_nop 0
    buffer_load_dwordx4 v3, s[12:15], s34 offen lds
    s_add_u32 s34, s34, 4096
    s_add_u32 m0, s36, 77824
    s_nop 0
    buffer_load_dwordx4 v3, s[12:15], s34 offen lds
    s_add_u32 s34, s34, 4096
    s_add_u32 m0, s36, 81920
    s_nop 0
    buffer_load_dwordx4 v3, s[12:15], s34 offen lds
    s_add_u32 s34, s34, 4096
    s_add_u32 m0, s36, 86016
    s_nop 0
    buffer_load_dwordx4 v3, s[12:15], s34 offen lds
    s_add_u32 s34, s34, 4096
    s_add_u32 m0, s36, 90112
    s_cmp_lt_u32 s16, 2
    s_cselect_b32 m0, m0, 157632
    s_cselect_b32 s35, s34, 33554432
    buffer_load_dwordx4 v3, s[12:15], s35 offen lds
    s_add_u32 s34, s34, 2048
    s_waitcnt vmcnt(24)
    s_barrier
    s_add_u32 m0, s36, 92160
    s_nop 0
    buffer_load_dwordx4 v3, s[12:15], s34 offen lds
    s_add_u32 s34, s34, 4096
    s_add_u32 m0, s36, 96256
    s_nop 0
    buffer_load_dwordx4 v3, s[12:15], s34 offen lds
    s_add_u32 s34, s34, 4096
    s_add_u32 m0, s36, 100352
    s_nop 0
    buffer_load_dwordx4 v3, s[12:15], s34 offen lds
    s_add_u32 s34, s34, 4096
    s_add_u32 m0, s36, 104448
    s_nop 0
    buffer_load_dwordx4 v3, s[12:15], s34 offen lds
    s_add_u32 s34, s34, 4096
    s_add_u32 m0, s36, 108544
    s_nop 0
    buffer_load_dwordx4 v3, s[12:15], s34 offen lds
    s_add_u32 s34, s34, 4096
    s_add_u32 m0, s36, 112640
    s_nop 0
    buffer_load_dwordx4 v3, s[12:15], s34 offen lds
    s_add_u32 s34, s34, 4096
    s_add_u32 m0, s36, 116736
    s_nop 0
    buffer_load_dwordx4 v3, s[12:15], s34 offen lds
    s_add_u32 s34, s34, 4096
    s_add_u32 m0, s36, 120832
    s_cmp_lt_u32 s16, 2
    s_cselect_b32 m0, m0, 157632
    s_cselect_b32 s35, s34, 33554432
    buffer_load_dwordx4 v3, s[12:15], s35 offen lds
    s_add_u32 s34, s34, 2048
    s_waitcnt vmcnt(24)
    s_barrier
    s_waitcnt vmcnt(16)
    s_barrier
    s_waitcnt vmcnt(8)
    s_barrier
    s_waitcnt vmcnt(0)
    s_barrier
    s_endpgm
    s_barrier
    s_waitcnt vmcnt(0)
    s_barrier
    s_endpgm
Lcode_end:
.section .rodata,"a"
.p2align 6
.amdhsa_kernel sequential_preLN__softmax_full_mha__geglu_ffn__prompt_kernel
  .amdhsa_next_free_vgpr 256
  .amdhsa_next_free_sgpr 100
  .amdhsa_accum_offset 256
  .amdhsa_group_segment_fixed_size 0
  .amdhsa_kernarg_size 80
  .amdhsa_user_sgpr_count 2
  .amdhsa_user_sgpr_kernarg_segment_ptr 1
  .amdhsa_system_sgpr_workgroup_id_x 1
.end_amdhsa_kernel
```
